```python
import torch

def _softmax(x, axis=-1):
    return torch.softmax(x, dim=axis)

def _gelu(x):
    return torch.nn.functional.gelu(x, approximate='tanh')

def _silu(x):
    return torch.nn.functional.silu(x)

def _sigmoid(x):
    return torch.sigmoid(x)

def _layernorm(x, axis=-1, eps=1e-05):
    m = x.mean(dim=axis, keepdim=True)
    v = x.var(dim=axis, keepdim=True, unbiased=False)
    return (x - m) / torch.sqrt(v + eps)

def _scatter_add(tgt, idx, src, axis=0):
    return tgt.clone().index_add_(axis, idx, src)

def _segment_sum(src, seg, n):
    out = torch.zeros((n,) + src.shape[1:], dtype=src.dtype)
    return out.index_add_(0, seg, src)

def _pad(x, pw):
    flat = tuple((v for pair in reversed(pw) for v in pair))
    return torch.nn.functional.pad(x, flat)
kernel_name = 'adaLN_cond__mha_block__dense_activation_relu__prompt'

def setup_inputs():

    _w = lambda a: (lambda t: t.to(torch.bfloat16) if t.is_floating_point() else t)(torch.as_tensor(a))

    def _A_setup():
        B, S, D, H = (1, 2048, 1024, 32)
        return {'x': _w((lambda *s: torch.randn(*s, dtype=torch.bfloat16) * 0.05)(B, S, D)), 'wqkv': _w((lambda *s: torch.randn(*s, dtype=torch.bfloat16) * 0.05)(D, 3 * D)), 'wo': _w((lambda *s: torch.randn(*s, dtype=torch.bfloat16) * 0.05)(D, D))}
    _A_in = _A_setup()

    def _B_setup():
        B, S, D, Dff = (1, 2048, 1024, 3584)
        return {'x': _w((lambda *s: torch.randn(*s, dtype=torch.bfloat16) * 0.05)(B, S, D)), 'w1': _w((lambda *s: torch.randn(*s, dtype=torch.bfloat16) * 0.05)(D, Dff)), 'w2': _w((lambda *s: torch.randn(*s, dtype=torch.bfloat16) * 0.05)(Dff, D))}
    _B_in = _B_setup()
    return {'A_x': _A_in['x'], 'A_wqkv': _A_in['wqkv'], 'A_wo': _A_in['wo'], 'B_x': _B_in['x'], 'B_w1': _B_in['w1'], 'B_w2': _B_in['w2'], 'c': _w((lambda *s: torch.randn(*s, dtype=torch.bfloat16) * 0.2)(1, 1024) * 8.0), 'w_mod': _w((lambda *s: torch.randn(*s, dtype=torch.bfloat16) * 0.2)(1024, 6 * 1024) * 1024 ** (-0.5) * 8.0)}

def reference(A_x, A_wqkv, A_wo, B_x, B_w1, B_w2, c, w_mod):

    def _A_ref(x, wqkv, wo):
        B, S, D = x.shape
        H = 32
        Dh = D // H
        qkv = (lambda x, *d: x.permute(*d))((x @ wqkv).reshape(B, S, 3, H, Dh), 2, 0, 3, 1, 4)
        q, k, v = (qkv[0], qkv[1], qkv[2])
        scores = torch.einsum('bhqd,bhkd->bhqk', q, k) * Dh ** (-0.5)
        p = _softmax(scores, axis=-1)
        o = torch.einsum('bhqk,bhkd->bhqd', p, v)
        return (lambda x, *d: x.permute(*d))(o, 0, 2, 1, 3).reshape(B, S, D) @ wo

    def _B_ref(x, w1, w2):
        h = torch.einsum('bsd,df->bsf', x, w1)
        zero = torch.zeros_like(h)
        h = torch.maximum(h, zero)
        return torch.einsum('bsf,fd->bsd', h, w2)
    x = A_x
    mod = (_silu(c) @ w_mod).reshape(c.shape[0], 6, 1, -1)
    sa, ca, ga, sb, cb, gb = (mod[:, 0].clone(), mod[:, 1].clone(), mod[:, 2].clone(), mod[:, 3].clone(), mod[:, 4].clone(), mod[:, 5].clone())
    h = _layernorm(x, axis=-1) * (1 + ca) + sa
    x = x + ga * _A_ref(h, A_wqkv, A_wo)
    h = _layernorm(x, axis=-1) * (1 + cb) + sb
    x = x + gb * _B_ref(h, B_w1, B_w2)
    return x
```

```asm
; @launch kernel=mod_kernel grid=(256,1,1) block=(256,1,1) lds=1024
; @launch kernel=main_kernel grid=(256,1,1) block=(512,1,1) lds=154880
.amdgcn_target "amdgcn-amd-amdhsa--gfx950"
.text
.globl mod_kernel
.type mod_kernel,@function
  .p2align 8
mod_kernel:
  s_cmp_ge_u32 s2, 256
  s_cbranch_scc1 mod_kernel_end
  s_load_dwordx4 s[4:7], s[0:1], 48
  s_load_dwordx2 s[8:9], s[0:1], 80
  s_load_dwordx2 s[10:11], s[0:1], 0
  s_cmp_ge_u32 s2, 128
  s_cbranch_scc1 mod_kernel_aux
  s_and_b32 s24, s2, 3
  s_lshr_b32 s25, s2, 2
  v_lshrrev_b32 v1, 3, v0
  v_and_b32 v2, 7, v0
  s_lshl_b32 s26, s24, 8
  v_add_u32 v3, s26, v1
  v_lshlrev_b32 v4, 1, v3
  v_mul_u32_u24 v5, 12288, v3
  v_lshlrev_b32 v6, 4, v2
  v_add_u32 v5, v5, v6
  s_lshl_b32 s27, s25, 7
  v_add_u32 v5, s27, v5
  s_waitcnt lgkmcnt(0)
  s_mov_b32 s12, s4
  s_mov_b32 s13, s5
  s_mov_b32 s14, 0x800
  s_mov_b32 s15, 0x20000
  s_mov_b32 s16, s6
  s_mov_b32 s17, s7
  s_mov_b32 s18, 0xc00000
  s_mov_b32 s19, 0x20000
  s_mov_b32 s20, s8
  s_mov_b32 s21, s9
  s_mov_b32 s22, 0x18000
  s_mov_b32 s23, 0x20000
  buffer_load_ushort v8, v4, s[12:15], 0 offen offset:0
  buffer_load_ushort v9, v4, s[12:15], 0 offen offset:64
  buffer_load_ushort v10, v4, s[12:15], 0 offen offset:128
  buffer_load_ushort v11, v4, s[12:15], 0 offen offset:192
  buffer_load_ushort v12, v4, s[12:15], 0 offen offset:256
  buffer_load_ushort v13, v4, s[12:15], 0 offen offset:320
  buffer_load_ushort v14, v4, s[12:15], 0 offen offset:384
  buffer_load_ushort v15, v4, s[12:15], 0 offen offset:448
  s_mov_b32 s32, 0
  s_mov_b32 s33, 393216
  s_mov_b32 s34, 786432
  s_mov_b32 s35, 1179648
  s_mov_b32 s36, 1572864
  s_mov_b32 s37, 1966080
  s_mov_b32 s38, 2359296
  s_mov_b32 s39, 2752512
  buffer_load_dwordx4 v[16:19], v5, s[16:19], s32 offen
  buffer_load_dwordx4 v[20:23], v5, s[16:19], s33 offen
  buffer_load_dwordx4 v[24:27], v5, s[16:19], s34 offen
  buffer_load_dwordx4 v[28:31], v5, s[16:19], s35 offen
  buffer_load_dwordx4 v[32:35], v5, s[16:19], s36 offen
  buffer_load_dwordx4 v[36:39], v5, s[16:19], s37 offen
  buffer_load_dwordx4 v[40:43], v5, s[16:19], s38 offen
  buffer_load_dwordx4 v[44:47], v5, s[16:19], s39 offen
  v_mov_b32 v48, 0
  v_mov_b32 v49, 0
  v_mov_b32 v50, 0
  v_mov_b32 v51, 0
  v_mov_b32 v52, 0
  v_mov_b32 v53, 0
  v_mov_b32 v54, 0
  v_mov_b32 v55, 0
  s_waitcnt vmcnt(8)
  v_lshlrev_b32 v8, 16, v8
  v_mul_f32 v56, 0xbfb8aa3b, v8
  v_exp_f32 v56, v56
  s_nop 0
  v_add_f32 v56, 1.0, v56
  v_rcp_f32 v56, v56
  s_nop 0
  v_mul_f32 v8, v8, v56
  v_cvt_pk_bf16_f32 v8, v8, v8
  v_lshlrev_b32 v8, 16, v8
  v_lshlrev_b32 v9, 16, v9
  v_mul_f32 v56, 0xbfb8aa3b, v9
  v_exp_f32 v56, v56
  s_nop 0
  v_add_f32 v56, 1.0, v56
  v_rcp_f32 v56, v56
  s_nop 0
  v_mul_f32 v9, v9, v56
  v_cvt_pk_bf16_f32 v9, v9, v9
  v_lshlrev_b32 v9, 16, v9
  v_lshlrev_b32 v10, 16, v10
  v_mul_f32 v56, 0xbfb8aa3b, v10
  v_exp_f32 v56, v56
  s_nop 0
  v_add_f32 v56, 1.0, v56
  v_rcp_f32 v56, v56
  s_nop 0
  v_mul_f32 v10, v10, v56
  v_cvt_pk_bf16_f32 v10, v10, v10
  v_lshlrev_b32 v10, 16, v10
  v_lshlrev_b32 v11, 16, v11
  v_mul_f32 v56, 0xbfb8aa3b, v11
  v_exp_f32 v56, v56
  s_nop 0
  v_add_f32 v56, 1.0, v56
  v_rcp_f32 v56, v56
  s_nop 0
  v_mul_f32 v11, v11, v56
  v_cvt_pk_bf16_f32 v11, v11, v11
  v_lshlrev_b32 v11, 16, v11
  v_lshlrev_b32 v12, 16, v12
  v_mul_f32 v56, 0xbfb8aa3b, v12
  v_exp_f32 v56, v56
  s_nop 0
  v_add_f32 v56, 1.0, v56
  v_rcp_f32 v56, v56
  s_nop 0
  v_mul_f32 v12, v12, v56
  v_cvt_pk_bf16_f32 v12, v12, v12
  v_lshlrev_b32 v12, 16, v12
  v_lshlrev_b32 v13, 16, v13
  v_mul_f32 v56, 0xbfb8aa3b, v13
  v_exp_f32 v56, v56
  s_nop 0
  v_add_f32 v56, 1.0, v56
  v_rcp_f32 v56, v56
  s_nop 0
  v_mul_f32 v13, v13, v56
  v_cvt_pk_bf16_f32 v13, v13, v13
  v_lshlrev_b32 v13, 16, v13
  v_lshlrev_b32 v14, 16, v14
  v_mul_f32 v56, 0xbfb8aa3b, v14
  v_exp_f32 v56, v56
  s_nop 0
  v_add_f32 v56, 1.0, v56
  v_rcp_f32 v56, v56
  s_nop 0
  v_mul_f32 v14, v14, v56
  v_cvt_pk_bf16_f32 v14, v14, v14
  v_lshlrev_b32 v14, 16, v14
  v_lshlrev_b32 v15, 16, v15
  v_mul_f32 v56, 0xbfb8aa3b, v15
  v_exp_f32 v56, v56
  s_nop 0
  v_add_f32 v56, 1.0, v56
  v_rcp_f32 v56, v56
  s_nop 0
  v_mul_f32 v15, v15, v56
  v_cvt_pk_bf16_f32 v15, v15, v15
  v_lshlrev_b32 v15, 16, v15
  s_waitcnt vmcnt(7)
  v_lshlrev_b32 v56, 16, v16
  v_and_b32 v57, 0xffff0000, v16
  v_fmac_f32 v48, v8, v56
  v_fmac_f32 v49, v8, v57
  v_lshlrev_b32 v56, 16, v17
  v_and_b32 v57, 0xffff0000, v17
  v_fmac_f32 v50, v8, v56
  v_fmac_f32 v51, v8, v57
  v_lshlrev_b32 v56, 16, v18
  v_and_b32 v57, 0xffff0000, v18
  v_fmac_f32 v52, v8, v56
  v_fmac_f32 v53, v8, v57
  v_lshlrev_b32 v56, 16, v19
  v_and_b32 v57, 0xffff0000, v19
  v_fmac_f32 v54, v8, v56
  v_fmac_f32 v55, v8, v57
  s_waitcnt vmcnt(6)
  v_lshlrev_b32 v56, 16, v20
  v_and_b32 v57, 0xffff0000, v20
  v_fmac_f32 v48, v9, v56
  v_fmac_f32 v49, v9, v57
  v_lshlrev_b32 v56, 16, v21
  v_and_b32 v57, 0xffff0000, v21
  v_fmac_f32 v50, v9, v56
  v_fmac_f32 v51, v9, v57
  v_lshlrev_b32 v56, 16, v22
  v_and_b32 v57, 0xffff0000, v22
  v_fmac_f32 v52, v9, v56
  v_fmac_f32 v53, v9, v57
  v_lshlrev_b32 v56, 16, v23
  v_and_b32 v57, 0xffff0000, v23
  v_fmac_f32 v54, v9, v56
  v_fmac_f32 v55, v9, v57
  s_waitcnt vmcnt(5)
  v_lshlrev_b32 v56, 16, v24
  v_and_b32 v57, 0xffff0000, v24
  v_fmac_f32 v48, v10, v56
  v_fmac_f32 v49, v10, v57
  v_lshlrev_b32 v56, 16, v25
  v_and_b32 v57, 0xffff0000, v25
  v_fmac_f32 v50, v10, v56
  v_fmac_f32 v51, v10, v57
  v_lshlrev_b32 v56, 16, v26
  v_and_b32 v57, 0xffff0000, v26
  v_fmac_f32 v52, v10, v56
  v_fmac_f32 v53, v10, v57
  v_lshlrev_b32 v56, 16, v27
  v_and_b32 v57, 0xffff0000, v27
  v_fmac_f32 v54, v10, v56
  v_fmac_f32 v55, v10, v57
  s_waitcnt vmcnt(4)
  v_lshlrev_b32 v56, 16, v28
  v_and_b32 v57, 0xffff0000, v28
  v_fmac_f32 v48, v11, v56
  v_fmac_f32 v49, v11, v57
  v_lshlrev_b32 v56, 16, v29
  v_and_b32 v57, 0xffff0000, v29
  v_fmac_f32 v50, v11, v56
  v_fmac_f32 v51, v11, v57
  v_lshlrev_b32 v56, 16, v30
  v_and_b32 v57, 0xffff0000, v30
  v_fmac_f32 v52, v11, v56
  v_fmac_f32 v53, v11, v57
  v_lshlrev_b32 v56, 16, v31
  v_and_b32 v57, 0xffff0000, v31
  v_fmac_f32 v54, v11, v56
  v_fmac_f32 v55, v11, v57
  s_waitcnt vmcnt(3)
  v_lshlrev_b32 v56, 16, v32
  v_and_b32 v57, 0xffff0000, v32
  v_fmac_f32 v48, v12, v56
  v_fmac_f32 v49, v12, v57
  v_lshlrev_b32 v56, 16, v33
  v_and_b32 v57, 0xffff0000, v33
  v_fmac_f32 v50, v12, v56
  v_fmac_f32 v51, v12, v57
  v_lshlrev_b32 v56, 16, v34
  v_and_b32 v57, 0xffff0000, v34
  v_fmac_f32 v52, v12, v56
  v_fmac_f32 v53, v12, v57
  v_lshlrev_b32 v56, 16, v35
  v_and_b32 v57, 0xffff0000, v35
  v_fmac_f32 v54, v12, v56
  v_fmac_f32 v55, v12, v57
  s_waitcnt vmcnt(2)
  v_lshlrev_b32 v56, 16, v36
  v_and_b32 v57, 0xffff0000, v36
  v_fmac_f32 v48, v13, v56
  v_fmac_f32 v49, v13, v57
  v_lshlrev_b32 v56, 16, v37
  v_and_b32 v57, 0xffff0000, v37
  v_fmac_f32 v50, v13, v56
  v_fmac_f32 v51, v13, v57
  v_lshlrev_b32 v56, 16, v38
  v_and_b32 v57, 0xffff0000, v38
  v_fmac_f32 v52, v13, v56
  v_fmac_f32 v53, v13, v57
  v_lshlrev_b32 v56, 16, v39
  v_and_b32 v57, 0xffff0000, v39
  v_fmac_f32 v54, v13, v56
  v_fmac_f32 v55, v13, v57
  s_waitcnt vmcnt(1)
  v_lshlrev_b32 v56, 16, v40
  v_and_b32 v57, 0xffff0000, v40
  v_fmac_f32 v48, v14, v56
  v_fmac_f32 v49, v14, v57
  v_lshlrev_b32 v56, 16, v41
  v_and_b32 v57, 0xffff0000, v41
  v_fmac_f32 v50, v14, v56
  v_fmac_f32 v51, v14, v57
  v_lshlrev_b32 v56, 16, v42
  v_and_b32 v57, 0xffff0000, v42
  v_fmac_f32 v52, v14, v56
  v_fmac_f32 v53, v14, v57
  v_lshlrev_b32 v56, 16, v43
  v_and_b32 v57, 0xffff0000, v43
  v_fmac_f32 v54, v14, v56
  v_fmac_f32 v55, v14, v57
  s_waitcnt vmcnt(0)
  v_lshlrev_b32 v56, 16, v44
  v_and_b32 v57, 0xffff0000, v44
  v_fmac_f32 v48, v15, v56
  v_fmac_f32 v49, v15, v57
  v_lshlrev_b32 v56, 16, v45
  v_and_b32 v57, 0xffff0000, v45
  v_fmac_f32 v50, v15, v56
  v_fmac_f32 v51, v15, v57
  v_lshlrev_b32 v56, 16, v46
  v_and_b32 v57, 0xffff0000, v46
  v_fmac_f32 v52, v15, v56
  v_fmac_f32 v53, v15, v57
  v_lshlrev_b32 v56, 16, v47
  v_and_b32 v57, 0xffff0000, v47
  v_fmac_f32 v54, v15, v56
  v_fmac_f32 v55, v15, v57
  v_add_f32_dpp v48, v48, v48 row_ror:8 row_mask:0xf bank_mask:0xf
  v_add_f32_dpp v49, v49, v49 row_ror:8 row_mask:0xf bank_mask:0xf
  v_add_f32_dpp v50, v50, v50 row_ror:8 row_mask:0xf bank_mask:0xf
  v_add_f32_dpp v51, v51, v51 row_ror:8 row_mask:0xf bank_mask:0xf
  v_add_f32_dpp v52, v52, v52 row_ror:8 row_mask:0xf bank_mask:0xf
  v_add_f32_dpp v53, v53, v53 row_ror:8 row_mask:0xf bank_mask:0xf
  v_add_f32_dpp v54, v54, v54 row_ror:8 row_mask:0xf bank_mask:0xf
  v_add_f32_dpp v55, v55, v55 row_ror:8 row_mask:0xf bank_mask:0xf
  v_mov_b32 v56, v48
  s_nop 1
  v_permlane16_swap_b32 v56, v48
  v_add_f32 v48, v48, v56
  v_mov_b32 v56, v49
  s_nop 1
  v_permlane16_swap_b32 v56, v49
  v_add_f32 v49, v49, v56
  v_mov_b32 v56, v50
  s_nop 1
  v_permlane16_swap_b32 v56, v50
  v_add_f32 v50, v50, v56
  v_mov_b32 v56, v51
  s_nop 1
  v_permlane16_swap_b32 v56, v51
  v_add_f32 v51, v51, v56
  v_mov_b32 v56, v52
  s_nop 1
  v_permlane16_swap_b32 v56, v52
  v_add_f32 v52, v52, v56
  v_mov_b32 v56, v53
  s_nop 1
  v_permlane16_swap_b32 v56, v53
  v_add_f32 v53, v53, v56
  v_mov_b32 v56, v54
  s_nop 1
  v_permlane16_swap_b32 v56, v54
  v_add_f32 v54, v54, v56
  v_mov_b32 v56, v55
  s_nop 1
  v_permlane16_swap_b32 v56, v55
  v_add_f32 v55, v55, v56
  v_mov_b32 v56, v48
  s_nop 1
  v_permlane32_swap_b32 v56, v48
  v_add_f32 v48, v48, v56
  v_mov_b32 v56, v49
  s_nop 1
  v_permlane32_swap_b32 v56, v49
  v_add_f32 v49, v49, v56
  v_mov_b32 v56, v50
  s_nop 1
  v_permlane32_swap_b32 v56, v50
  v_add_f32 v50, v50, v56
  v_mov_b32 v56, v51
  s_nop 1
  v_permlane32_swap_b32 v56, v51
  v_add_f32 v51, v51, v56
  v_mov_b32 v56, v52
  s_nop 1
  v_permlane32_swap_b32 v56, v52
  v_add_f32 v52, v52, v56
  v_mov_b32 v56, v53
  s_nop 1
  v_permlane32_swap_b32 v56, v53
  v_add_f32 v53, v53, v56
  v_mov_b32 v56, v54
  s_nop 1
  v_permlane32_swap_b32 v56, v54
  v_add_f32 v54, v54, v56
  v_mov_b32 v56, v55
  s_nop 1
  v_permlane32_swap_b32 v56, v55
  v_add_f32 v55, v55, v56
  v_lshrrev_b32 v9, 6, v0
  v_lshlrev_b32 v9, 8, v9
  v_lshlrev_b32 v10, 5, v2
  v_add_u32 v9, v9, v10
  v_and_b32 v10, 63, v0
  v_cmp_gt_u32 vcc, 8, v10
  s_nop 0
  s_and_saveexec_b64 s[28:29], vcc
  ds_write_b128 v9, v[48:51]
  ds_write_b128 v9, v[52:55] offset:16
  s_mov_b64 exec, s[28:29]
  s_waitcnt lgkmcnt(0)
  s_barrier
  v_cmp_gt_u32 vcc, 64, v0
  s_nop 0
  s_and_saveexec_b64 s[28:29], vcc
  s_cbranch_execz mod_kernel_end
  v_lshlrev_b32 v9, 2, v0
  ds_read_b32 v12, v9 offset:0
  ds_read_b32 v13, v9 offset:256
  ds_read_b32 v14, v9 offset:512
  ds_read_b32 v15, v9 offset:768
  s_waitcnt lgkmcnt(0)
  v_add_f32 v12, v12, v13
  v_add_f32 v14, v14, v15
  v_add_f32 v12, v12, v14
  s_mul_i32 s26, s24, 24576
  s_lshl_b32 s27, s25, 8
  s_add_u32 s26, s26, s27
  buffer_store_dword v12, v9, s[20:23], s26 offen
  s_endpgm
mod_kernel_aux:
  s_waitcnt lgkmcnt(0)
  s_sub_u32 s24, s2, 128
  s_mov_b32 s12, s10
  s_mov_b32 s13, s11
  s_mov_b32 s14, 0x400000
  s_mov_b32 s15, 0x20000
  s_lshl_b32 s25, s24, 15
  v_lshlrev_b32 v1, 7, v0
  buffer_load_dword v2, v1, s[12:15], s25 offen
  s_add_u32 s16, s8, 0x2f00000
  s_addc_u32 s17, s9, 0
  s_mov_b32 s18, 281088
  s_mov_b32 s19, 0x20000
  s_lshl_b32 s25, s24, 12
  v_lshlrev_b32 v3, 4, v0
  v_mov_b32 v4, 0
  v_mov_b32 v5, 0
  v_mov_b32 v6, 0
  v_mov_b32 v7, 0
  buffer_store_dwordx4 v[4:7], v3, s[16:19], s25 offen
mod_kernel_end:
  s_endpgm
.globl main_kernel
.type main_kernel,@function
  .p2align 8
main_kernel:
  s_cmp_ge_u32 s2, 256
  s_cbranch_scc1 main_kernel_end
  s_load_dwordx4 s[68:71], s[0:1], 0
  s_load_dwordx4 s[72:75], s[0:1], 32
  s_load_dwordx2 s[76:77], s[0:1], 16
  s_load_dwordx2 s[78:79], s[0:1], 64
  s_load_dwordx2 s[66:67], s[0:1], 80
  v_lshrrev_b32 v1, 6, v0
  v_and_b32 v2, 63, v0
  v_readfirstlane_b32 s24, v1
  s_nop 0
  s_cmp_lg_u32 s24, 0
  s_cbranch_scc1 main_kernel_noinit
  v_lshlrev_b32 v3, 2, v2
  v_add_u32 v3, 138240, v3
  v_mov_b32 v4, 0
  ds_write_b32 v3, v4
  s_waitcnt lgkmcnt(0)
main_kernel_noinit:
  s_waitcnt lgkmcnt(0)
  s_add_u32 s28, s66, 0x2f00000
  s_addc_u32 s29, s67, 0
  s_mov_b32 s30, 0x44a00
  s_mov_b32 s31, 0x20000
  s_cmp_ge_u32 s24, 4
  s_cbranch_scc1 main_kernel_qkv_l
  s_lshl_b32 s36, s2, 3
  s_lshl_b32 s37, s24, 1
  s_add_u32 s36, s36, s37
  s_lshl_b32 s36, s36, 11
  v_lshlrev_b32 v3, 4, v2
  v_add_u32 v3, s36, v3
  s_mov_b32 s12, s68
  s_mov_b32 s13, s69
  s_mov_b32 s14, 0x400000
  s_mov_b32 s15, 0x20000
  s_add_u32 s16, s66, 0x100000
  s_addc_u32 s17, s67, 0
  s_mov_b32 s18, 0x400000
  s_mov_b32 s19, 0x20000
  s_mov_b32 s20, s66
  s_mov_b32 s21, s67
  s_mov_b32 s22, 0x18000
  s_mov_b32 s23, 0x20000
  s_add_u32 s56, s66, 0x20000
  s_addc_u32 s57, s67, 0
  s_mov_b32 s58, 0x6000
  s_mov_b32 s59, 0x20000
  v_lshlrev_b32 v5, 5, v0
  s_mov_b32 s37, 0
  buffer_load_dwordx4 v[64:67], v5, s[20:23], s37 offen
  buffer_load_dwordx4 v[68:71], v5, s[20:23], s37 offen offset:16
  s_mov_b32 s37, 24576
  buffer_load_dwordx4 v[72:75], v5, s[20:23], s37 offen
  buffer_load_dwordx4 v[76:79], v5, s[20:23], s37 offen offset:16
  s_mov_b32 s37, 49152
  buffer_load_dwordx4 v[80:83], v5, s[20:23], s37 offen
  buffer_load_dwordx4 v[84:87], v5, s[20:23], s37 offen offset:16
  s_mov_b32 s37, 73728
  buffer_load_dwordx4 v[88:91], v5, s[20:23], s37 offen
  buffer_load_dwordx4 v[92:95], v5, s[20:23], s37 offen offset:16
  buffer_load_dwordx4 v[8:11], v3, s[12:15], 0 offen offset:0
  buffer_load_dwordx4 v[12:15], v3, s[12:15], 0 offen offset:1024
  buffer_load_dwordx4 v[16:19], v3, s[12:15], 0 offen offset:2048
  buffer_load_dwordx4 v[20:23], v3, s[12:15], 0 offen offset:3072
  s_waitcnt vmcnt(4)
  v_add_f32 v64, v64, v72
  v_add_f32 v80, v80, v88
  v_add_f32 v64, v64, v80
  v_cvt_pk_bf16_f32 v64, v64, v64
  v_lshlrev_b32 v64, 16, v64
  v_add_f32 v65, v65, v73
  v_add_f32 v81, v81, v89
  v_add_f32 v65, v65, v81
  v_cvt_pk_bf16_f32 v65, v65, v65
  v_lshlrev_b32 v65, 16, v65
  v_add_f32 v66, v66, v74
  v_add_f32 v82, v82, v90
  v_add_f32 v66, v66, v82
  v_cvt_pk_bf16_f32 v66, v66, v66
  v_lshlrev_b32 v66, 16, v66
  v_add_f32 v67, v67, v75
  v_add_f32 v83, v83, v91
  v_add_f32 v67, v67, v83
  v_cvt_pk_bf16_f32 v67, v67, v67
  v_lshlrev_b32 v67, 16, v67
  v_add_f32 v68, v68, v76
  v_add_f32 v84, v84, v92
  v_add_f32 v68, v68, v84
  v_cvt_pk_bf16_f32 v68, v68, v68
  v_lshlrev_b32 v68, 16, v68
  v_add_f32 v69, v69, v77
  v_add_f32 v85, v85, v93
  v_add_f32 v69, v69, v85
  v_cvt_pk_bf16_f32 v69, v69, v69
  v_lshlrev_b32 v69, 16, v69
  v_add_f32 v70, v70, v78
  v_add_f32 v86, v86, v94
  v_add_f32 v70, v70, v86
  v_cvt_pk_bf16_f32 v70, v70, v70
  v_lshlrev_b32 v70, 16, v70
  v_add_f32 v71, v71, v79
  v_add_f32 v87, v87, v95
  v_add_f32 v71, v71, v87
  v_cvt_pk_bf16_f32 v71, v71, v71
  v_lshlrev_b32 v71, 16, v71
  v_cmp_le_u32 vcc, 128, v0
  v_add_f32 v72, 1.0, v64
  v_cvt_pk_bf16_f32 v72, v72, v72
  v_lshlrev_b32 v72, 16, v72
  v_cndmask_b32 v64, v64, v72, vcc
  v_add_f32 v72, 1.0, v65
  v_cvt_pk_bf16_f32 v72, v72, v72
  v_lshlrev_b32 v72, 16, v72
  v_cndmask_b32 v65, v65, v72, vcc
  v_add_f32 v72, 1.0, v66
  v_cvt_pk_bf16_f32 v72, v72, v72
  v_lshlrev_b32 v72, 16, v72
  v_cndmask_b32 v66, v66, v72, vcc
  v_add_f32 v72, 1.0, v67
  v_cvt_pk_bf16_f32 v72, v72, v72
  v_lshlrev_b32 v72, 16, v72
  v_cndmask_b32 v67, v67, v72, vcc
  v_add_f32 v72, 1.0, v68
  v_cvt_pk_bf16_f32 v72, v72, v72
  v_lshlrev_b32 v72, 16, v72
  v_cndmask_b32 v68, v68, v72, vcc
  v_add_f32 v72, 1.0, v69
  v_cvt_pk_bf16_f32 v72, v72, v72
  v_lshlrev_b32 v72, 16, v72
  v_cndmask_b32 v69, v69, v72, vcc
  v_add_f32 v72, 1.0, v70
  v_cvt_pk_bf16_f32 v72, v72, v72
  v_lshlrev_b32 v72, 16, v72
  v_cndmask_b32 v70, v70, v72, vcc
  v_add_f32 v72, 1.0, v71
  v_cvt_pk_bf16_f32 v72, v72, v72
  v_lshlrev_b32 v72, 16, v72
  v_cndmask_b32 v71, v71, v72, vcc
  v_add_u32 v5, 125952, v5
  ds_write_b128 v5, v[64:67]
  ds_write_b128 v5, v[68:71] offset:16
  s_waitcnt lgkmcnt(0)
  s_barrier
  v_lshlrev_b32 v5, 5, v2
  v_add_u32 v5, 125952, v5
  ds_read_b128 v[32:35], v5 offset:0
  ds_read_b128 v[48:51], v5 offset:4096
  ds_read_b128 v[36:39], v5 offset:16
  ds_read_b128 v[52:55], v5 offset:4112
  ds_read_b128 v[40:43], v5 offset:2048
  ds_read_b128 v[56:59], v5 offset:6144
  ds_read_b128 v[44:47], v5 offset:2064
  ds_read_b128 v[60:63], v5 offset:6160
  s_waitcnt vmcnt(0)
  v_lshlrev_b32 v64, 16, v8
  v_and_b32 v65, 0xffff0000, v8
  v_lshlrev_b32 v66, 16, v9
  v_and_b32 v67, 0xffff0000, v9
  v_lshlrev_b32 v68, 16, v10
  v_and_b32 v69, 0xffff0000, v10
  v_lshlrev_b32 v70, 16, v11
  v_and_b32 v71, 0xffff0000, v11
  v_lshlrev_b32 v72, 16, v12
  v_and_b32 v73, 0xffff0000, v12
  v_lshlrev_b32 v74, 16, v13
  v_and_b32 v75, 0xffff0000, v13
  v_lshlrev_b32 v76, 16, v14
  v_and_b32 v77, 0xffff0000, v14
  v_lshlrev_b32 v78, 16, v15
  v_and_b32 v79, 0xffff0000, v15
  v_lshlrev_b32 v80, 16, v16
  v_and_b32 v81, 0xffff0000, v16
  v_lshlrev_b32 v82, 16, v17
  v_and_b32 v83, 0xffff0000, v17
  v_lshlrev_b32 v84, 16, v18
  v_and_b32 v85, 0xffff0000, v18
  v_lshlrev_b32 v86, 16, v19
  v_and_b32 v87, 0xffff0000, v19
  v_lshlrev_b32 v88, 16, v20
  v_and_b32 v89, 0xffff0000, v20
  v_lshlrev_b32 v90, 16, v21
  v_and_b32 v91, 0xffff0000, v21
  v_lshlrev_b32 v92, 16, v22
  v_and_b32 v93, 0xffff0000, v22
  v_lshlrev_b32 v94, 16, v23
  v_and_b32 v95, 0xffff0000, v23
  v_add_f32 v104, v64, v65
  v_add_f32 v105, v80, v81
  v_add_f32 v104, v104, v66
  v_add_f32 v105, v105, v82
  v_add_f32 v104, v104, v67
  v_add_f32 v105, v105, v83
  v_add_f32 v104, v104, v68
  v_add_f32 v105, v105, v84
  v_add_f32 v104, v104, v69
  v_add_f32 v105, v105, v85
  v_add_f32 v104, v104, v70
  v_add_f32 v105, v105, v86
  v_add_f32 v104, v104, v71
  v_add_f32 v105, v105, v87
  v_add_f32 v104, v104, v72
  v_add_f32 v105, v105, v88
  v_add_f32 v104, v104, v73
  v_add_f32 v105, v105, v89
  v_add_f32 v104, v104, v74
  v_add_f32 v105, v105, v90
  v_add_f32 v104, v104, v75
  v_add_f32 v105, v105, v91
  v_add_f32 v104, v104, v76
  v_add_f32 v105, v105, v92
  v_add_f32 v104, v104, v77
  v_add_f32 v105, v105, v93
  v_add_f32 v104, v104, v78
  v_add_f32 v105, v105, v94
  v_add_f32 v104, v104, v79
  v_add_f32 v105, v105, v95
  s_nop 0
  v_add_f32_dpp v104, v104, v104 row_ror:1 row_mask:0xf bank_mask:0xf
  v_add_f32_dpp v105, v105, v105 row_ror:1 row_mask:0xf bank_mask:0xf
  s_nop 0
  v_add_f32_dpp v104, v104, v104 row_ror:2 row_mask:0xf bank_mask:0xf
  v_add_f32_dpp v105, v105, v105 row_ror:2 row_mask:0xf bank_mask:0xf
  s_nop 0
  v_add_f32_dpp v104, v104, v104 row_ror:4 row_mask:0xf bank_mask:0xf
  v_add_f32_dpp v105, v105, v105 row_ror:4 row_mask:0xf bank_mask:0xf
  s_nop 0
  v_add_f32_dpp v104, v104, v104 row_ror:8 row_mask:0xf bank_mask:0xf
  v_add_f32_dpp v105, v105, v105 row_ror:8 row_mask:0xf bank_mask:0xf
  v_mov_b32 v106, v104
  s_nop 1
  v_permlane16_swap_b32 v106, v104
  v_add_f32 v104, v104, v106
  v_mov_b32 v106, v105
  s_nop 1
  v_permlane16_swap_b32 v106, v105
  v_add_f32 v105, v105, v106
  v_mov_b32 v106, v104
  s_nop 1
  v_permlane32_swap_b32 v106, v104
  v_add_f32 v104, v104, v106
  v_mov_b32 v106, v105
  s_nop 1
  v_permlane32_swap_b32 v106, v105
  v_add_f32 v105, v105, v106
  v_mul_f32 v104, 0x3a800000, v104
  v_mul_f32 v105, 0x3a800000, v105
  v_sub_f32 v64, v64, v104
  v_sub_f32 v80, v80, v105
  v_sub_f32 v65, v65, v104
  v_sub_f32 v81, v81, v105
  v_sub_f32 v66, v66, v104
  v_sub_f32 v82, v82, v105
  v_sub_f32 v67, v67, v104
  v_sub_f32 v83, v83, v105
  v_sub_f32 v68, v68, v104
  v_sub_f32 v84, v84, v105
  v_sub_f32 v69, v69, v104
  v_sub_f32 v85, v85, v105
  v_sub_f32 v70, v70, v104
  v_sub_f32 v86, v86, v105
  v_sub_f32 v71, v71, v104
  v_sub_f32 v87, v87, v105
  v_sub_f32 v72, v72, v104
  v_sub_f32 v88, v88, v105
  v_sub_f32 v73, v73, v104
  v_sub_f32 v89, v89, v105
  v_sub_f32 v74, v74, v104
  v_sub_f32 v90, v90, v105
  v_sub_f32 v75, v75, v104
  v_sub_f32 v91, v91, v105
  v_sub_f32 v76, v76, v104
  v_sub_f32 v92, v92, v105
  v_sub_f32 v77, v77, v104
  v_sub_f32 v93, v93, v105
  v_sub_f32 v78, v78, v104
  v_sub_f32 v94, v94, v105
  v_sub_f32 v79, v79, v104
  v_sub_f32 v95, v95, v105
  v_mul_f32 v107, v64, v64
  v_mul_f32 v108, v80, v80
  v_fmac_f32 v107, v65, v65
  v_fmac_f32 v108, v81, v81
  v_fmac_f32 v107, v66, v66
  v_fmac_f32 v108, v82, v82
  v_fmac_f32 v107, v67, v67
  v_fmac_f32 v108, v83, v83
  v_fmac_f32 v107, v68, v68
  v_fmac_f32 v108, v84, v84
  v_fmac_f32 v107, v69, v69
  v_fmac_f32 v108, v85, v85
  v_fmac_f32 v107, v70, v70
  v_fmac_f32 v108, v86, v86
  v_fmac_f32 v107, v71, v71
  v_fmac_f32 v108, v87, v87
  v_fmac_f32 v107, v72, v72
  v_fmac_f32 v108, v88, v88
  v_fmac_f32 v107, v73, v73
  v_fmac_f32 v108, v89, v89
  v_fmac_f32 v107, v74, v74
  v_fmac_f32 v108, v90, v90
  v_fmac_f32 v107, v75, v75
  v_fmac_f32 v108, v91, v91
  v_fmac_f32 v107, v76, v76
  v_fmac_f32 v108, v92, v92
  v_fmac_f32 v107, v77, v77
  v_fmac_f32 v108, v93, v93
  v_fmac_f32 v107, v78, v78
  v_fmac_f32 v108, v94, v94
  v_fmac_f32 v107, v79, v79
  v_fmac_f32 v108, v95, v95
  s_nop 0
  v_add_f32_dpp v107, v107, v107 row_ror:1 row_mask:0xf bank_mask:0xf
  v_add_f32_dpp v108, v108, v108 row_ror:1 row_mask:0xf bank_mask:0xf
  s_nop 0
  v_add_f32_dpp v107, v107, v107 row_ror:2 row_mask:0xf bank_mask:0xf
  v_add_f32_dpp v108, v108, v108 row_ror:2 row_mask:0xf bank_mask:0xf
  s_nop 0
  v_add_f32_dpp v107, v107, v107 row_ror:4 row_mask:0xf bank_mask:0xf
  v_add_f32_dpp v108, v108, v108 row_ror:4 row_mask:0xf bank_mask:0xf
  s_nop 0
  v_add_f32_dpp v107, v107, v107 row_ror:8 row_mask:0xf bank_mask:0xf
  v_add_f32_dpp v108, v108, v108 row_ror:8 row_mask:0xf bank_mask:0xf
  v_mov_b32 v106, v107
  s_nop 1
  v_permlane16_swap_b32 v106, v107
  v_add_f32 v107, v107, v106
  v_mov_b32 v106, v108
  s_nop 1
  v_permlane16_swap_b32 v106, v108
  v_add_f32 v108, v108, v106
  v_mov_b32 v106, v107
  s_nop 1
  v_permlane32_swap_b32 v106, v107
  v_add_f32 v107, v107, v106
  v_mov_b32 v106, v108
  s_nop 1
  v_permlane32_swap_b32 v106, v108
  v_add_f32 v108, v108, v106
  v_mov_b32 v109, 0x3727c5ac
  v_fmac_f32 v109, 0x3a800000, v107
  v_rsq_f32 v109, v109
  v_mov_b32 v110, 0x3727c5ac
  v_fmac_f32 v110, 0x3a800000, v108
  v_rsq_f32 v110, v110
  s_waitcnt lgkmcnt(0)
  v_mul_f32 v64, v64, v109
  v_fma_f32 v64, v64, v48, v32
  v_mul_f32 v65, v65, v109
  v_fma_f32 v65, v65, v49, v33
  v_mul_f32 v66, v66, v109
  v_fma_f32 v66, v66, v50, v34
  v_mul_f32 v67, v67, v109
  v_fma_f32 v67, v67, v51, v35
  v_mul_f32 v68, v68, v109
  v_fma_f32 v68, v68, v52, v36
  v_mul_f32 v69, v69, v109
  v_fma_f32 v69, v69, v53, v37
  v_mul_f32 v70, v70, v109
  v_fma_f32 v70, v70, v54, v38
  v_mul_f32 v71, v71, v109
  v_fma_f32 v71, v71, v55, v39
  v_mul_f32 v72, v72, v109
  v_fma_f32 v72, v72, v56, v40
  v_mul_f32 v73, v73, v109
  v_fma_f32 v73, v73, v57, v41
  v_mul_f32 v74, v74, v109
  v_fma_f32 v74, v74, v58, v42
  v_mul_f32 v75, v75, v109
  v_fma_f32 v75, v75, v59, v43
  v_mul_f32 v76, v76, v109
  v_fma_f32 v76, v76, v60, v44
  v_mul_f32 v77, v77, v109
  v_fma_f32 v77, v77, v61, v45
  v_mul_f32 v78, v78, v109
  v_fma_f32 v78, v78, v62, v46
  v_mul_f32 v79, v79, v109
  v_fma_f32 v79, v79, v63, v47
  v_cvt_pk_bf16_f32 v112, v64, v65
  v_cvt_pk_bf16_f32 v113, v66, v67
  v_cvt_pk_bf16_f32 v114, v68, v69
  v_cvt_pk_bf16_f32 v115, v70, v71
  v_cvt_pk_bf16_f32 v116, v72, v73
  v_cvt_pk_bf16_f32 v117, v74, v75
  v_cvt_pk_bf16_f32 v118, v76, v77
  v_cvt_pk_bf16_f32 v119, v78, v79
  buffer_store_dwordx4 v[112:115], v3, s[16:19], 0 offen offset:0 sc1
  buffer_store_dwordx4 v[116:119], v3, s[16:19], 0 offen offset:1024 sc1
  v_mul_f32 v80, v80, v110
  v_fma_f32 v80, v80, v48, v32
  v_mul_f32 v81, v81, v110
  v_fma_f32 v81, v81, v49, v33
  v_mul_f32 v82, v82, v110
  v_fma_f32 v82, v82, v50, v34
  v_mul_f32 v83, v83, v110
  v_fma_f32 v83, v83, v51, v35
  v_mul_f32 v84, v84, v110
  v_fma_f32 v84, v84, v52, v36
  v_mul_f32 v85, v85, v110
  v_fma_f32 v85, v85, v53, v37
  v_mul_f32 v86, v86, v110
  v_fma_f32 v86, v86, v54, v38
  v_mul_f32 v87, v87, v110
  v_fma_f32 v87, v87, v55, v39
  v_mul_f32 v88, v88, v110
  v_fma_f32 v88, v88, v56, v40
  v_mul_f32 v89, v89, v110
  v_fma_f32 v89, v89, v57, v41
  v_mul_f32 v90, v90, v110
  v_fma_f32 v90, v90, v58, v42
  v_mul_f32 v91, v91, v110
  v_fma_f32 v91, v91, v59, v43
  v_mul_f32 v92, v92, v110
  v_fma_f32 v92, v92, v60, v44
  v_mul_f32 v93, v93, v110
  v_fma_f32 v93, v93, v61, v45
  v_mul_f32 v94, v94, v110
  v_fma_f32 v94, v94, v62, v46
  v_mul_f32 v95, v95, v110
  v_fma_f32 v95, v95, v63, v47
  v_cvt_pk_bf16_f32 v120, v80, v81
  v_cvt_pk_bf16_f32 v121, v82, v83
  v_cvt_pk_bf16_f32 v122, v84, v85
  v_cvt_pk_bf16_f32 v123, v86, v87
  v_cvt_pk_bf16_f32 v124, v88, v89
  v_cvt_pk_bf16_f32 v125, v90, v91
  v_cvt_pk_bf16_f32 v126, v92, v93
  v_cvt_pk_bf16_f32 v127, v94, v95
  buffer_store_dwordx4 v[120:123], v3, s[16:19], 0 offen offset:2048 sc1
  buffer_store_dwordx4 v[124:127], v3, s[16:19], 0 offen offset:3072 sc1
  s_lshr_b32 s35, s2, 4
  s_add_u32 s35, s35, 72
  s_waitcnt vmcnt(0)
  v_mov_b32 v6, 138260
  v_mov_b32 v7, 1
  s_mov_b64 exec, 1
  ds_add_rtn_u32 v7, v6, v7
  s_waitcnt lgkmcnt(0)
  v_readfirstlane_b32 s32, v7
  s_mov_b64 exec, -1
  s_cmp_lg_u32 s32, 3
  s_cbranch_scc1 main_kernel_sigh
  s_lshr_b32 s33, s2, 4
  s_lshl_b32 s33, s33, 9
  s_and_b32 s34, s2, 15
  s_lshl_b32 s34, s34, 2
  s_add_u32 s33, s33, s34
  s_add_u32 s33, s33, 42496
  v_lshlrev_b32 v6, 7, v2
  v_add_u32 v6, s33, v6
  v_mov_b32 v7, 1
  s_mov_b64 exec, 0xf
  buffer_store_dword v7, v6, s[28:31], 0 offen sc1
main_kernel_sigh:
  s_mov_b64 exec, -1
main_kernel_qkv_c:
  s_and_b32 s36, s2, 7
  s_lshr_b32 s37, s2, 3
  s_and_b32 s38, s36, 3
  s_lshr_b32 s39, s36, 2
  s_and_b32 s40, s37, 3
  s_lshr_b32 s41, s37, 2
  s_mul_i32 s38, s38, 4
  s_add_u32 s26, s38, s40
  s_mul_i32 s39, s39, 8
  s_add_u32 s25, s39, s41
  s_lshr_b32 s42, s24, 1
  s_and_b32 s43, s24, 1
  v_and_b32 v3, 15, v2
  v_lshrrev_b32 v4, 4, v2
  s_lshl_b32 s44, s25, 7
  s_lshl_b32 s45, s42, 6
  s_add_u32 s44, s44, s45
  s_mul_i32 s46, s26, 192
  s_mul_i32 s45, s43, 96
  s_add_u32 s46, s46, s45
  s_add_u32 s20, s66, 0x20000
  s_addc_u32 s21, s67, 0
  s_mov_b32 s22, 0x6000
  s_mov_b32 s23, 0x20000
  s_add_u32 s12, s66, 0x500000
  s_addc_u32 s13, s67, 0
  s_mov_b32 s14, 0xc00000
  s_mov_b32 s15, 0x20000
  v_lshrrev_b32 v5, 1, v3
  v_xor_b32 v5, v5, v4
  v_and_b32 v5, 7, v5
  v_lshlrev_b32 v5, 4, v5
  s_lshl_b32 s47, s42, 6
  v_add_u32 v6, s47, v3
  v_lshlrev_b32 v6, 7, v6
  v_add_u32 v184, v5, v6
  v_xor_b32 v185, 64, v184
  v_lshrrev_b32 v5, 2, v3
  v_and_b32 v6, 3, v2
  v_lshlrev_b32 v7, 3, v4
  v_add_u32 v7, v7, v5
  v_mul_u32_u24 v7, 384, v7
  v_lshlrev_b32 v6, 3, v6
  v_add_u32 v7, v7, v6
  v_add_u32 v7, 16384, v7
  v_lshrrev_b32 v5, 1, v5
  v_and_b32 v6, 1, v4
  v_lshlrev_b32 v6, 1, v6
  v_or_b32 v5, v5, v6
  s_mul_i32 s47, s43, 6
  s_add_u32 s48, s47, 0
  v_xor_b32 v6, s48, v5
  v_lshlrev_b32 v6, 5, v6
  v_add_u32 v186, v7, v6
  s_add_u32 s48, s47, 1
  v_xor_b32 v6, s48, v5
  v_lshlrev_b32 v6, 5, v6
  v_add_u32 v187, v7, v6
  s_add_u32 s48, s47, 2
  v_xor_b32 v6, s48, v5
  v_lshlrev_b32 v6, 5, v6
  v_add_u32 v188, v7, v6
  s_add_u32 s48, s47, 3
  v_xor_b32 v6, s48, v5
  v_lshlrev_b32 v6, 5, v6
  v_add_u32 v189, v7, v6
  s_add_u32 s48, s47, 4
  v_xor_b32 v6, s48, v5
  v_lshlrev_b32 v6, 5, v6
  v_add_u32 v190, v7, v6
  s_add_u32 s48, s47, 5
  v_xor_b32 v6, s48, v5
  v_lshlrev_b32 v6, 5, v6
  v_add_u32 v191, v7, v6
  v_mov_b32 v8, 0
  v_mov_b32 v9, 0
  v_mov_b32 v10, 0
  v_mov_b32 v11, 0
  v_mov_b32 v12, 0
  v_mov_b32 v13, 0
  v_mov_b32 v14, 0
  v_mov_b32 v15, 0
  v_mov_b32 v16, 0
  v_mov_b32 v17, 0
  v_mov_b32 v18, 0
  v_mov_b32 v19, 0
  v_mov_b32 v20, 0
  v_mov_b32 v21, 0
  v_mov_b32 v22, 0
  v_mov_b32 v23, 0
  v_mov_b32 v24, 0
  v_mov_b32 v25, 0
  v_mov_b32 v26, 0
  v_mov_b32 v27, 0
  v_mov_b32 v28, 0
  v_mov_b32 v29, 0
  v_mov_b32 v30, 0
  v_mov_b32 v31, 0
  v_mov_b32 v32, 0
  v_mov_b32 v33, 0
  v_mov_b32 v34, 0
  v_mov_b32 v35, 0
  v_mov_b32 v36, 0
  v_mov_b32 v37, 0
  v_mov_b32 v38, 0
  v_mov_b32 v39, 0
  v_mov_b32 v40, 0
  v_mov_b32 v41, 0
  v_mov_b32 v42, 0
  v_mov_b32 v43, 0
  v_mov_b32 v44, 0
  v_mov_b32 v45, 0
  v_mov_b32 v46, 0
  v_mov_b32 v47, 0
  v_mov_b32 v48, 0
  v_mov_b32 v49, 0
  v_mov_b32 v50, 0
  v_mov_b32 v51, 0
  v_mov_b32 v52, 0
  v_mov_b32 v53, 0
  v_mov_b32 v54, 0
  v_mov_b32 v55, 0
  v_mov_b32 v56, 0
  v_mov_b32 v57, 0
  v_mov_b32 v58, 0
  v_mov_b32 v59, 0
  v_mov_b32 v60, 0
  v_mov_b32 v61, 0
  v_mov_b32 v62, 0
  v_mov_b32 v63, 0
  v_mov_b32 v64, 0
  v_mov_b32 v65, 0
  v_mov_b32 v66, 0
  v_mov_b32 v67, 0
  v_mov_b32 v68, 0
  v_mov_b32 v69, 0
  v_mov_b32 v70, 0
  v_mov_b32 v71, 0
  v_mov_b32 v72, 0
  v_mov_b32 v73, 0
  v_mov_b32 v74, 0
  v_mov_b32 v75, 0
  v_mov_b32 v76, 0
  v_mov_b32 v77, 0
  v_mov_b32 v78, 0
  v_mov_b32 v79, 0
  v_mov_b32 v80, 0
  v_mov_b32 v81, 0
  v_mov_b32 v82, 0
  v_mov_b32 v83, 0
  v_mov_b32 v84, 0
  v_mov_b32 v85, 0
  v_mov_b32 v86, 0
  v_mov_b32 v87, 0
  v_mov_b32 v88, 0
  v_mov_b32 v89, 0
  v_mov_b32 v90, 0
  v_mov_b32 v91, 0
  v_mov_b32 v92, 0
  v_mov_b32 v93, 0
  v_mov_b32 v94, 0
  v_mov_b32 v95, 0
  v_mov_b32 v96, 0
  v_mov_b32 v97, 0
  v_mov_b32 v98, 0
  v_mov_b32 v99, 0
  v_mov_b32 v100, 0
  v_mov_b32 v101, 0
  v_mov_b32 v102, 0
  v_mov_b32 v103, 0
  s_mov_b32 s49, 0
  s_mov_b32 s54, 40960
  s_mov_b32 s55, 0xfffec000
  s_barrier
  ds_read_b128 v[104:107], v184 offset:0
  ds_read_b64_tr_b16 v[120:121], v186 offset:0
  ds_read_b64_tr_b16 v[122:123], v186 offset:1536
  ds_read_b128 v[108:111], v184 offset:2048
  ds_read_b128 v[112:115], v184 offset:4096
  ds_read_b128 v[116:119], v184 offset:6144
  ds_read_b64_tr_b16 v[124:125], v187 offset:0
  ds_read_b64_tr_b16 v[126:127], v187 offset:1536
  ds_read_b64_tr_b16 v[128:129], v188 offset:0
  ds_read_b64_tr_b16 v[130:131], v188 offset:1536
  ds_read_b64_tr_b16 v[132:133], v189 offset:0
  ds_read_b64_tr_b16 v[134:135], v189 offset:1536
  ds_read_b64_tr_b16 v[136:137], v190 offset:0
  ds_read_b64_tr_b16 v[138:139], v190 offset:1536
  ds_read_b64_tr_b16 v[140:141], v191 offset:0
  ds_read_b64_tr_b16 v[142:143], v191 offset:1536
  s_mov_b32 s50, 15
.p2align 6
main_kernel_qkv_cloop:
  s_waitcnt lgkmcnt(0)
  v_mfma_f32_16x16x32_bf16 v[8:11], v[120:123], v[104:107], v[8:11]
  s_add_u32 s49, s49, 1
  ds_read_b128 v[144:147], v185 offset:0
  v_mfma_f32_16x16x32_bf16 v[12:15], v[124:127], v[104:107], v[12:15]
  s_cmp_eq_u32 s49, 3
  ds_read_b64_tr_b16 v[160:161], v186 offset:12288
  v_mfma_f32_16x16x32_bf16 v[16:19], v[128:131], v[104:107], v[16:19]
  s_cselect_b32 s51, s55, s54
  ds_read_b64_tr_b16 v[162:163], v186 offset:13824
  v_mfma_f32_16x16x32_bf16 v[20:23], v[132:135], v[104:107], v[20:23]
  s_cselect_b32 s49, 0, s49
  ds_read_b128 v[148:151], v185 offset:2048
  v_mfma_f32_16x16x32_bf16 v[24:27], v[136:139], v[104:107], v[24:27]
  ds_read_b128 v[152:155], v185 offset:4096
  v_mfma_f32_16x16x32_bf16 v[28:31], v[140:143], v[104:107], v[28:31]
  ds_read_b128 v[156:159], v185 offset:6144
  v_mfma_f32_16x16x32_bf16 v[32:35], v[120:123], v[108:111], v[32:35]
  ds_read_b64_tr_b16 v[164:165], v187 offset:12288
  v_mfma_f32_16x16x32_bf16 v[36:39], v[124:127], v[108:111], v[36:39]
  ds_read_b64_tr_b16 v[166:167], v187 offset:13824
  v_mfma_f32_16x16x32_bf16 v[40:43], v[128:131], v[108:111], v[40:43]
  ds_read_b64_tr_b16 v[168:169], v188 offset:12288
  v_mfma_f32_16x16x32_bf16 v[44:47], v[132:135], v[108:111], v[44:47]
  ds_read_b64_tr_b16 v[170:171], v188 offset:13824
  v_mfma_f32_16x16x32_bf16 v[48:51], v[136:139], v[108:111], v[48:51]
  ds_read_b64_tr_b16 v[172:173], v189 offset:12288
  v_mfma_f32_16x16x32_bf16 v[52:55], v[140:143], v[108:111], v[52:55]
  ds_read_b64_tr_b16 v[174:175], v189 offset:13824
  v_mfma_f32_16x16x32_bf16 v[56:59], v[120:123], v[112:115], v[56:59]
  ds_read_b64_tr_b16 v[176:177], v190 offset:12288
  v_mfma_f32_16x16x32_bf16 v[60:63], v[124:127], v[112:115], v[60:63]
  ds_read_b64_tr_b16 v[178:179], v190 offset:13824
  v_mfma_f32_16x16x32_bf16 v[64:67], v[128:131], v[112:115], v[64:67]
  ds_read_b64_tr_b16 v[180:181], v191 offset:12288
  v_mfma_f32_16x16x32_bf16 v[68:71], v[132:135], v[112:115], v[68:71]
  ds_read_b64_tr_b16 v[182:183], v191 offset:13824
  v_mfma_f32_16x16x32_bf16 v[72:75], v[136:139], v[112:115], v[72:75]
  v_add_u32 v184, s51, v184
  v_mfma_f32_16x16x32_bf16 v[76:79], v[140:143], v[112:115], v[76:79]
  v_add_u32 v185, s51, v185
  v_mfma_f32_16x16x32_bf16 v[80:83], v[120:123], v[116:119], v[80:83]
  v_add_u32 v186, s51, v186
  v_mfma_f32_16x16x32_bf16 v[84:87], v[124:127], v[116:119], v[84:87]
  v_add_u32 v187, s51, v187
  v_mfma_f32_16x16x32_bf16 v[88:91], v[128:131], v[116:119], v[88:91]
  v_add_u32 v188, s51, v188
  v_mfma_f32_16x16x32_bf16 v[92:95], v[132:135], v[116:119], v[92:95]
  v_add_u32 v189, s51, v189
  v_mfma_f32_16x16x32_bf16 v[96:99], v[136:139], v[116:119], v[96:99]
  v_add_u32 v190, s51, v190
  v_mfma_f32_16x16x32_bf16 v[100:103], v[140:143], v[116:119], v[100:103]
  v_add_u32 v191, s51, v191
  s_waitcnt lgkmcnt(0)
  s_barrier
  v_mfma_f32_16x16x32_bf16 v[8:11], v[160:163], v[144:147], v[8:11]
  ds_read_b128 v[104:107], v184 offset:0
  v_mfma_f32_16x16x32_bf16 v[12:15], v[164:167], v[144:147], v[12:15]
  s_sub_u32 s50, s50, 1
  ds_read_b64_tr_b16 v[120:121], v186 offset:0
  v_mfma_f32_16x16x32_bf16 v[16:19], v[168:171], v[144:147], v[16:19]
  s_cmp_lg_u32 s50, 0
  ds_read_b64_tr_b16 v[122:123], v186 offset:1536
  v_mfma_f32_16x16x32_bf16 v[20:23], v[172:175], v[144:147], v[20:23]
  ds_read_b128 v[108:111], v184 offset:2048
  v_mfma_f32_16x16x32_bf16 v[24:27], v[176:179], v[144:147], v[24:27]
  ds_read_b128 v[112:115], v184 offset:4096
  v_mfma_f32_16x16x32_bf16 v[28:31], v[180:183], v[144:147], v[28:31]
  ds_read_b128 v[116:119], v184 offset:6144
  v_mfma_f32_16x16x32_bf16 v[32:35], v[160:163], v[148:151], v[32:35]
  ds_read_b64_tr_b16 v[124:125], v187 offset:0
  v_mfma_f32_16x16x32_bf16 v[36:39], v[164:167], v[148:151], v[36:39]
  ds_read_b64_tr_b16 v[126:127], v187 offset:1536
  v_mfma_f32_16x16x32_bf16 v[40:43], v[168:171], v[148:151], v[40:43]
  ds_read_b64_tr_b16 v[128:129], v188 offset:0
  v_mfma_f32_16x16x32_bf16 v[44:47], v[172:175], v[148:151], v[44:47]
  ds_read_b64_tr_b16 v[130:131], v188 offset:1536
  v_mfma_f32_16x16x32_bf16 v[48:51], v[176:179], v[148:151], v[48:51]
  ds_read_b64_tr_b16 v[132:133], v189 offset:0
  v_mfma_f32_16x16x32_bf16 v[52:55], v[180:183], v[148:151], v[52:55]
  ds_read_b64_tr_b16 v[134:135], v189 offset:1536
  v_mfma_f32_16x16x32_bf16 v[56:59], v[160:163], v[152:155], v[56:59]
  ds_read_b64_tr_b16 v[136:137], v190 offset:0
  v_mfma_f32_16x16x32_bf16 v[60:63], v[164:167], v[152:155], v[60:63]
  ds_read_b64_tr_b16 v[138:139], v190 offset:1536
  v_mfma_f32_16x16x32_bf16 v[64:67], v[168:171], v[152:155], v[64:67]
  ds_read_b64_tr_b16 v[140:141], v191 offset:0
  v_mfma_f32_16x16x32_bf16 v[68:71], v[172:175], v[152:155], v[68:71]
  ds_read_b64_tr_b16 v[142:143], v191 offset:1536
  v_mfma_f32_16x16x32_bf16 v[72:75], v[176:179], v[152:155], v[72:75]
  v_mfma_f32_16x16x32_bf16 v[76:79], v[180:183], v[152:155], v[76:79]
  v_mfma_f32_16x16x32_bf16 v[80:83], v[160:163], v[156:159], v[80:83]
  v_mfma_f32_16x16x32_bf16 v[84:87], v[164:167], v[156:159], v[84:87]
  v_mfma_f32_16x16x32_bf16 v[88:91], v[168:171], v[156:159], v[88:91]
  v_mfma_f32_16x16x32_bf16 v[92:95], v[172:175], v[156:159], v[92:95]
  v_mfma_f32_16x16x32_bf16 v[96:99], v[176:179], v[156:159], v[96:99]
  v_mfma_f32_16x16x32_bf16 v[100:103], v[180:183], v[156:159], v[100:103]
  s_cbranch_scc1 main_kernel_qkv_cloop
  s_waitcnt lgkmcnt(0)
  v_mfma_f32_16x16x32_bf16 v[8:11], v[120:123], v[104:107], v[8:11]
  ds_read_b128 v[144:147], v185 offset:0
  v_mfma_f32_16x16x32_bf16 v[12:15], v[124:127], v[104:107], v[12:15]
  ds_read_b64_tr_b16 v[160:161], v186 offset:12288
  v_mfma_f32_16x16x32_bf16 v[16:19], v[128:131], v[104:107], v[16:19]
  ds_read_b64_tr_b16 v[162:163], v186 offset:13824
  v_mfma_f32_16x16x32_bf16 v[20:23], v[132:135], v[104:107], v[20:23]
  ds_read_b128 v[148:151], v185 offset:2048
  v_mfma_f32_16x16x32_bf16 v[24:27], v[136:139], v[104:107], v[24:27]
  ds_read_b128 v[152:155], v185 offset:4096
  v_mfma_f32_16x16x32_bf16 v[28:31], v[140:143], v[104:107], v[28:31]
  ds_read_b128 v[156:159], v185 offset:6144
  v_mfma_f32_16x16x32_bf16 v[32:35], v[120:123], v[108:111], v[32:35]
  ds_read_b64_tr_b16 v[164:165], v187 offset:12288
  v_mfma_f32_16x16x32_bf16 v[36:39], v[124:127], v[108:111], v[36:39]
  ds_read_b64_tr_b16 v[166:167], v187 offset:13824
  v_mfma_f32_16x16x32_bf16 v[40:43], v[128:131], v[108:111], v[40:43]
  ds_read_b64_tr_b16 v[168:169], v188 offset:12288
  v_mfma_f32_16x16x32_bf16 v[44:47], v[132:135], v[108:111], v[44:47]
  ds_read_b64_tr_b16 v[170:171], v188 offset:13824
  v_mfma_f32_16x16x32_bf16 v[48:51], v[136:139], v[108:111], v[48:51]
  ds_read_b64_tr_b16 v[172:173], v189 offset:12288
  v_mfma_f32_16x16x32_bf16 v[52:55], v[140:143], v[108:111], v[52:55]
  ds_read_b64_tr_b16 v[174:175], v189 offset:13824
  v_mfma_f32_16x16x32_bf16 v[56:59], v[120:123], v[112:115], v[56:59]
  ds_read_b64_tr_b16 v[176:177], v190 offset:12288
  v_mfma_f32_16x16x32_bf16 v[60:63], v[124:127], v[112:115], v[60:63]
  ds_read_b64_tr_b16 v[178:179], v190 offset:13824
  v_mfma_f32_16x16x32_bf16 v[64:67], v[128:131], v[112:115], v[64:67]
  ds_read_b64_tr_b16 v[180:181], v191 offset:12288
  v_mfma_f32_16x16x32_bf16 v[68:71], v[132:135], v[112:115], v[68:71]
  ds_read_b64_tr_b16 v[182:183], v191 offset:13824
  v_mfma_f32_16x16x32_bf16 v[72:75], v[136:139], v[112:115], v[72:75]
  v_mfma_f32_16x16x32_bf16 v[76:79], v[140:143], v[112:115], v[76:79]
  v_mfma_f32_16x16x32_bf16 v[80:83], v[120:123], v[116:119], v[80:83]
  v_mfma_f32_16x16x32_bf16 v[84:87], v[124:127], v[116:119], v[84:87]
  v_mfma_f32_16x16x32_bf16 v[88:91], v[128:131], v[116:119], v[88:91]
  v_mfma_f32_16x16x32_bf16 v[92:95], v[132:135], v[116:119], v[92:95]
  v_mfma_f32_16x16x32_bf16 v[96:99], v[136:139], v[116:119], v[96:99]
  v_mfma_f32_16x16x32_bf16 v[100:103], v[140:143], v[116:119], v[100:103]
  s_waitcnt lgkmcnt(0)
  v_mfma_f32_16x16x32_bf16 v[8:11], v[160:163], v[144:147], v[8:11]
  v_mfma_f32_16x16x32_bf16 v[12:15], v[164:167], v[144:147], v[12:15]
  v_mfma_f32_16x16x32_bf16 v[16:19], v[168:171], v[144:147], v[16:19]
  v_mfma_f32_16x16x32_bf16 v[20:23], v[172:175], v[144:147], v[20:23]
  v_mfma_f32_16x16x32_bf16 v[24:27], v[176:179], v[144:147], v[24:27]
  v_mfma_f32_16x16x32_bf16 v[28:31], v[180:183], v[144:147], v[28:31]
  v_mfma_f32_16x16x32_bf16 v[32:35], v[160:163], v[148:151], v[32:35]
  v_mfma_f32_16x16x32_bf16 v[36:39], v[164:167], v[148:151], v[36:39]
  v_mfma_f32_16x16x32_bf16 v[40:43], v[168:171], v[148:151], v[40:43]
  v_mfma_f32_16x16x32_bf16 v[44:47], v[172:175], v[148:151], v[44:47]
  v_mfma_f32_16x16x32_bf16 v[48:51], v[176:179], v[148:151], v[48:51]
  v_mfma_f32_16x16x32_bf16 v[52:55], v[180:183], v[148:151], v[52:55]
  v_mfma_f32_16x16x32_bf16 v[56:59], v[160:163], v[152:155], v[56:59]
  v_mfma_f32_16x16x32_bf16 v[60:63], v[164:167], v[152:155], v[60:63]
  v_mfma_f32_16x16x32_bf16 v[64:67], v[168:171], v[152:155], v[64:67]
  v_mfma_f32_16x16x32_bf16 v[68:71], v[172:175], v[152:155], v[68:71]
  v_mfma_f32_16x16x32_bf16 v[72:75], v[176:179], v[152:155], v[72:75]
  v_mfma_f32_16x16x32_bf16 v[76:79], v[180:183], v[152:155], v[76:79]
  v_mfma_f32_16x16x32_bf16 v[80:83], v[160:163], v[156:159], v[80:83]
  v_mfma_f32_16x16x32_bf16 v[84:87], v[164:167], v[156:159], v[84:87]
  v_mfma_f32_16x16x32_bf16 v[88:91], v[168:171], v[156:159], v[88:91]
  v_mfma_f32_16x16x32_bf16 v[92:95], v[172:175], v[156:159], v[92:95]
  v_mfma_f32_16x16x32_bf16 v[96:99], v[176:179], v[156:159], v[96:99]
  v_mfma_f32_16x16x32_bf16 v[100:103], v[180:183], v[156:159], v[100:103]
  v_and_b32 v5, 1, v4
  v_lshlrev_b32 v5, 5, v5
  v_lshrrev_b32 v6, 1, v4
  v_lshlrev_b32 v6, 4, v6
  v_add_u32 v5, v5, v6
  v_lshlrev_b32 v6, 6, v3
  v_add_u32 v5, v5, v6
  s_add_u32 s52, s46, 0
  s_cmp_lt_u32 s52, 1024
  s_cselect_b32 s53, 0x3e8293ee, 1.0
  s_lshl_b32 s52, s52, 12
  s_lshl_b32 s54, s44, 6
  s_add_u32 s52, s52, s54
  s_cmp_eq_u32 s53, 1.0
  s_cbranch_scc1 main_kernel_qkv_nosc0
  v_mov_b32 v6, s53
  v_pk_mul_f32 v[8:9], v[8:9], v[6:7] op_sel_hi:[1,0]
  v_pk_mul_f32 v[10:11], v[10:11], v[6:7] op_sel_hi:[1,0]
  v_pk_mul_f32 v[12:13], v[12:13], v[6:7] op_sel_hi:[1,0]
  v_pk_mul_f32 v[14:15], v[14:15], v[6:7] op_sel_hi:[1,0]
  v_pk_mul_f32 v[32:33], v[32:33], v[6:7] op_sel_hi:[1,0]
  v_pk_mul_f32 v[34:35], v[34:35], v[6:7] op_sel_hi:[1,0]
  v_pk_mul_f32 v[36:37], v[36:37], v[6:7] op_sel_hi:[1,0]
  v_pk_mul_f32 v[38:39], v[38:39], v[6:7] op_sel_hi:[1,0]
  v_pk_mul_f32 v[56:57], v[56:57], v[6:7] op_sel_hi:[1,0]
  v_pk_mul_f32 v[58:59], v[58:59], v[6:7] op_sel_hi:[1,0]
  v_pk_mul_f32 v[60:61], v[60:61], v[6:7] op_sel_hi:[1,0]
  v_pk_mul_f32 v[62:63], v[62:63], v[6:7] op_sel_hi:[1,0]
  v_pk_mul_f32 v[80:81], v[80:81], v[6:7] op_sel_hi:[1,0]
  v_pk_mul_f32 v[82:83], v[82:83], v[6:7] op_sel_hi:[1,0]
  v_pk_mul_f32 v[84:85], v[84:85], v[6:7] op_sel_hi:[1,0]
  v_pk_mul_f32 v[86:87], v[86:87], v[6:7] op_sel_hi:[1,0]
main_kernel_qkv_nosc0:
  v_cvt_pk_bf16_f32 v104, v8, v9
  v_cvt_pk_bf16_f32 v105, v10, v11
  v_cvt_pk_bf16_f32 v106, v12, v13
  v_cvt_pk_bf16_f32 v107, v14, v15
  s_nop 0
  v_permlane16_swap_b32 v104, v106
  v_permlane16_swap_b32 v105, v107
  buffer_store_dwordx4 v[104:107], v5, s[12:15], s52 offen offset:0 sc1
  v_cvt_pk_bf16_f32 v108, v32, v33
  v_cvt_pk_bf16_f32 v109, v34, v35
  v_cvt_pk_bf16_f32 v110, v36, v37
  v_cvt_pk_bf16_f32 v111, v38, v39
  s_nop 0
  v_permlane16_swap_b32 v108, v110
  v_permlane16_swap_b32 v109, v111
  buffer_store_dwordx4 v[108:111], v5, s[12:15], s52 offen offset:1024 sc1
  v_cvt_pk_bf16_f32 v112, v56, v57
  v_cvt_pk_bf16_f32 v113, v58, v59
  v_cvt_pk_bf16_f32 v114, v60, v61
  v_cvt_pk_bf16_f32 v115, v62, v63
  s_nop 0
  v_permlane16_swap_b32 v112, v114
  v_permlane16_swap_b32 v113, v115
  buffer_store_dwordx4 v[112:115], v5, s[12:15], s52 offen offset:2048 sc1
  v_cvt_pk_bf16_f32 v116, v80, v81
  v_cvt_pk_bf16_f32 v117, v82, v83
  v_cvt_pk_bf16_f32 v118, v84, v85
  v_cvt_pk_bf16_f32 v119, v86, v87
  s_nop 0
  v_permlane16_swap_b32 v116, v118
  v_permlane16_swap_b32 v117, v119
  buffer_store_dwordx4 v[116:119], v5, s[12:15], s52 offen offset:3072 sc1
  s_add_u32 s52, s46, 32
  s_cmp_lt_u32 s52, 1024
  s_cselect_b32 s53, 0x3e8293ee, 1.0
  s_lshl_b32 s52, s52, 12
  s_lshl_b32 s54, s44, 6
  s_add_u32 s52, s52, s54
  s_cmp_eq_u32 s53, 1.0
  s_cbranch_scc1 main_kernel_qkv_nosc1
  v_mov_b32 v6, s53
  v_pk_mul_f32 v[16:17], v[16:17], v[6:7] op_sel_hi:[1,0]
  v_pk_mul_f32 v[18:19], v[18:19], v[6:7] op_sel_hi:[1,0]
  v_pk_mul_f32 v[20:21], v[20:21], v[6:7] op_sel_hi:[1,0]
  v_pk_mul_f32 v[22:23], v[22:23], v[6:7] op_sel_hi:[1,0]
  v_pk_mul_f32 v[40:41], v[40:41], v[6:7] op_sel_hi:[1,0]
  v_pk_mul_f32 v[42:43], v[42:43], v[6:7] op_sel_hi:[1,0]
  v_pk_mul_f32 v[44:45], v[44:45], v[6:7] op_sel_hi:[1,0]
  v_pk_mul_f32 v[46:47], v[46:47], v[6:7] op_sel_hi:[1,0]
  v_pk_mul_f32 v[64:65], v[64:65], v[6:7] op_sel_hi:[1,0]
  v_pk_mul_f32 v[66:67], v[66:67], v[6:7] op_sel_hi:[1,0]
  v_pk_mul_f32 v[68:69], v[68:69], v[6:7] op_sel_hi:[1,0]
  v_pk_mul_f32 v[70:71], v[70:71], v[6:7] op_sel_hi:[1,0]
  v_pk_mul_f32 v[88:89], v[88:89], v[6:7] op_sel_hi:[1,0]
  v_pk_mul_f32 v[90:91], v[90:91], v[6:7] op_sel_hi:[1,0]
  v_pk_mul_f32 v[92:93], v[92:93], v[6:7] op_sel_hi:[1,0]
  v_pk_mul_f32 v[94:95], v[94:95], v[6:7] op_sel_hi:[1,0]
main_kernel_qkv_nosc1:
  v_cvt_pk_bf16_f32 v120, v16, v17
  v_cvt_pk_bf16_f32 v121, v18, v19
  v_cvt_pk_bf16_f32 v122, v20, v21
  v_cvt_pk_bf16_f32 v123, v22, v23
  s_nop 0
  v_permlane16_swap_b32 v120, v122
  v_permlane16_swap_b32 v121, v123
  buffer_store_dwordx4 v[120:123], v5, s[12:15], s52 offen offset:0 sc1
  v_cvt_pk_bf16_f32 v124, v40, v41
  v_cvt_pk_bf16_f32 v125, v42, v43
  v_cvt_pk_bf16_f32 v126, v44, v45
  v_cvt_pk_bf16_f32 v127, v46, v47
  s_nop 0
  v_permlane16_swap_b32 v124, v126
  v_permlane16_swap_b32 v125, v127
  buffer_store_dwordx4 v[124:127], v5, s[12:15], s52 offen offset:1024 sc1
  v_cvt_pk_bf16_f32 v128, v64, v65
  v_cvt_pk_bf16_f32 v129, v66, v67
  v_cvt_pk_bf16_f32 v130, v68, v69
  v_cvt_pk_bf16_f32 v131, v70, v71
  s_nop 0
  v_permlane16_swap_b32 v128, v130
  v_permlane16_swap_b32 v129, v131
  buffer_store_dwordx4 v[128:131], v5, s[12:15], s52 offen offset:2048 sc1
  v_cvt_pk_bf16_f32 v132, v88, v89
  v_cvt_pk_bf16_f32 v133, v90, v91
  v_cvt_pk_bf16_f32 v134, v92, v93
  v_cvt_pk_bf16_f32 v135, v94, v95
  s_nop 0
  v_permlane16_swap_b32 v132, v134
  v_permlane16_swap_b32 v133, v135
  buffer_store_dwordx4 v[132:135], v5, s[12:15], s52 offen offset:3072 sc1
  s_add_u32 s52, s46, 64
  s_cmp_lt_u32 s52, 1024
  s_cselect_b32 s53, 0x3e8293ee, 1.0
  s_lshl_b32 s52, s52, 12
  s_lshl_b32 s54, s44, 6
  s_add_u32 s52, s52, s54
  s_cmp_eq_u32 s53, 1.0
  s_cbranch_scc1 main_kernel_qkv_nosc2
  v_mov_b32 v6, s53
  v_pk_mul_f32 v[24:25], v[24:25], v[6:7] op_sel_hi:[1,0]
  v_pk_mul_f32 v[26:27], v[26:27], v[6:7] op_sel_hi:[1,0]
  v_pk_mul_f32 v[28:29], v[28:29], v[6:7] op_sel_hi:[1,0]
  v_pk_mul_f32 v[30:31], v[30:31], v[6:7] op_sel_hi:[1,0]
  v_pk_mul_f32 v[48:49], v[48:49], v[6:7] op_sel_hi:[1,0]
  v_pk_mul_f32 v[50:51], v[50:51], v[6:7] op_sel_hi:[1,0]
  v_pk_mul_f32 v[52:53], v[52:53], v[6:7] op_sel_hi:[1,0]
  v_pk_mul_f32 v[54:55], v[54:55], v[6:7] op_sel_hi:[1,0]
  v_pk_mul_f32 v[72:73], v[72:73], v[6:7] op_sel_hi:[1,0]
  v_pk_mul_f32 v[74:75], v[74:75], v[6:7] op_sel_hi:[1,0]
  v_pk_mul_f32 v[76:77], v[76:77], v[6:7] op_sel_hi:[1,0]
  v_pk_mul_f32 v[78:79], v[78:79], v[6:7] op_sel_hi:[1,0]
  v_pk_mul_f32 v[96:97], v[96:97], v[6:7] op_sel_hi:[1,0]
  v_pk_mul_f32 v[98:99], v[98:99], v[6:7] op_sel_hi:[1,0]
  v_pk_mul_f32 v[100:101], v[100:101], v[6:7] op_sel_hi:[1,0]
  v_pk_mul_f32 v[102:103], v[102:103], v[6:7] op_sel_hi:[1,0]
main_kernel_qkv_nosc2:
  v_cvt_pk_bf16_f32 v104, v24, v25
  v_cvt_pk_bf16_f32 v105, v26, v27
  v_cvt_pk_bf16_f32 v106, v28, v29
  v_cvt_pk_bf16_f32 v107, v30, v31
  s_nop 0
  v_permlane16_swap_b32 v104, v106
  v_permlane16_swap_b32 v105, v107
  buffer_store_dwordx4 v[104:107], v5, s[12:15], s52 offen offset:0 sc1
  v_cvt_pk_bf16_f32 v108, v48, v49
  v_cvt_pk_bf16_f32 v109, v50, v51
  v_cvt_pk_bf16_f32 v110, v52, v53
  v_cvt_pk_bf16_f32 v111, v54, v55
  s_nop 0
  v_permlane16_swap_b32 v108, v110
  v_permlane16_swap_b32 v109, v111
  buffer_store_dwordx4 v[108:111], v5, s[12:15], s52 offen offset:1024 sc1
  v_cvt_pk_bf16_f32 v112, v72, v73
  v_cvt_pk_bf16_f32 v113, v74, v75
  v_cvt_pk_bf16_f32 v114, v76, v77
  v_cvt_pk_bf16_f32 v115, v78, v79
  s_nop 0
  v_permlane16_swap_b32 v112, v114
  v_permlane16_swap_b32 v113, v115
  buffer_store_dwordx4 v[112:115], v5, s[12:15], s52 offen offset:2048 sc1
  v_cvt_pk_bf16_f32 v116, v96, v97
  v_cvt_pk_bf16_f32 v117, v98, v99
  v_cvt_pk_bf16_f32 v118, v100, v101
  v_cvt_pk_bf16_f32 v119, v102, v103
  s_nop 0
  v_permlane16_swap_b32 v116, v118
  v_permlane16_swap_b32 v117, v119
  buffer_store_dwordx4 v[116:119], v5, s[12:15], s52 offen offset:3072 sc1
  s_add_u32 s35, s26, 0
  s_waitcnt vmcnt(0)
  v_mov_b32 v6, 138240
  v_mov_b32 v7, 1
  s_mov_b64 exec, 1
  ds_add_rtn_u32 v7, v6, v7
  s_waitcnt lgkmcnt(0)
  v_readfirstlane_b32 s32, v7
  s_mov_b64 exec, -1
  s_cmp_lg_u32 s32, 3
  s_cbranch_scc1 main_kernel_sigqkv
  s_mul_i32 s33, s26, 6
  v_add_u32 v6, s33, v2
  v_lshrrev_b32 v7, 5, v6
  v_and_b32 v6, 31, v6
  v_lshlrev_b32 v6, 8, v6
  v_lshlrev_b32 v7, 6, v7
  v_add_u32 v6, v6, v7
  s_lshl_b32 s33, s25, 2
  s_add_u32 s33, s33, 75264
  v_add_u32 v6, s33, v6
  v_mov_b32 v7, 1
  s_mov_b64 exec, 0x3f
  buffer_store_dword v7, v6, s[28:31], 0 offen sc1
main_kernel_sigqkv:
  s_mov_b64 exec, -1
  s_branch main_kernel_att_c
main_kernel_qkv_l:
  s_and_b32 s36, s2, 7
  s_lshr_b32 s37, s2, 3
  s_and_b32 s38, s36, 3
  s_lshr_b32 s39, s36, 2
  s_and_b32 s40, s37, 3
  s_lshr_b32 s41, s37, 2
  s_mul_i32 s38, s38, 4
  s_add_u32 s26, s38, s40
  s_mul_i32 s39, s39, 8
  s_add_u32 s25, s39, s41
  s_add_u32 s4, s66, 0x100000
  s_addc_u32 s5, s67, 0
  s_mov_b32 s6, 0x400000
  s_mov_b32 s7, 0x20000
  s_mov_b32 s8, s70
  s_mov_b32 s9, s71
  s_mov_b32 s10, 0x600000
  s_mov_b32 s11, 0x20000
  s_sub_u32 s42, s24, 4
  s_lshl_b32 s43, s25, 7
  s_mul_i32 s44, s42, 32
  s_add_u32 s43, s43, s44
  v_lshrrev_b32 v3, 3, v2
  v_add_u32 v3, s43, v3
  s_mov_b32 s45, 2048
  v_mul_lo_u32 v3, s45, v3
  v_and_b32 v4, 7, v2
  v_lshrrev_b32 v5, 4, v2
  v_xor_b32 v6, 0, v5
  v_xor_b32 v6, v6, v4
  v_lshlrev_b32 v6, 4, v6
  v_add_u32 v6, v6, v3
  v_add_u32 v8, 0, v6
  v_xor_b32 v6, 4, v5
  v_xor_b32 v6, v6, v4
  v_lshlrev_b32 v6, 4, v6
  v_add_u32 v6, v6, v3
  v_add_u32 v9, 16384, v6
  v_xor_b32 v6, 0, v5
  v_xor_b32 v6, v6, v4
  v_lshlrev_b32 v6, 4, v6
  v_add_u32 v6, v6, v3
  v_add_u32 v10, 32768, v6
  v_xor_b32 v6, 4, v5
  v_xor_b32 v6, v6, v4
  v_lshlrev_b32 v6, 4, v6
  v_add_u32 v6, v6, v3
  v_add_u32 v11, 49152, v6
  s_mul_i32 s43, s42, 98304
  s_mul_i32 s44, s26, 384
  s_add_u32 s43, s43, s44
  v_add_u32 v3, 0, v2
  v_mul_u32_u24 v4, 2731, v3
  v_lshrrev_b32 v4, 16, v4
  v_mul_u32_u24 v5, 24, v4
  v_sub_u32 v3, v3, v5
  v_and_b32 v5, 2, v4
  v_lshrrev_b32 v6, 1, v4
  v_and_b32 v6, 4, v6
  v_or_b32 v5, v5, v6
  v_xor_b32 v3, v3, v5
  v_lshlrev_b32 v3, 4, v3
  s_mov_b32 s45, 6144
  v_mul_lo_u32 v4, s45, v4
  v_add_u32 v3, v3, v4
  v_add_u32 v12, s43, v3
  v_add_u32 v3, 64, v2
  v_mul_u32_u24 v4, 2731, v3
  v_lshrrev_b32 v4, 16, v4
  v_mul_u32_u24 v5, 24, v4
  v_sub_u32 v3, v3, v5
  v_and_b32 v5, 2, v4
  v_lshrrev_b32 v6, 1, v4
  v_and_b32 v6, 4, v6
  v_or_b32 v5, v5, v6
  v_xor_b32 v3, v3, v5
  v_lshlrev_b32 v3, 4, v3
  s_mov_b32 s45, 6144
  v_mul_lo_u32 v4, s45, v4
  v_add_u32 v3, v3, v4
  v_add_u32 v13, s43, v3
  v_add_u32 v3, 128, v2
  v_mul_u32_u24 v4, 2731, v3
  v_lshrrev_b32 v4, 16, v4
  v_mul_u32_u24 v5, 24, v4
  v_sub_u32 v3, v3, v5
  v_and_b32 v5, 2, v4
  v_lshrrev_b32 v6, 1, v4
  v_and_b32 v6, 4, v6
  v_or_b32 v5, v5, v6
  v_xor_b32 v3, v3, v5
  v_lshlrev_b32 v3, 4, v3
  s_mov_b32 s45, 6144
  v_mul_lo_u32 v4, s45, v4
  v_add_u32 v3, v3, v4
  v_add_u32 v14, s43, v3
  v_add_u32 v3, 192, v2
  v_mul_u32_u24 v4, 2731, v3
  v_lshrrev_b32 v4, 16, v4
  v_mul_u32_u24 v5, 24, v4
  v_sub_u32 v3, v3, v5
  v_and_b32 v5, 2, v4
  v_lshrrev_b32 v6, 1, v4
  v_and_b32 v6, 4, v6
  v_or_b32 v5, v5, v6
  v_xor_b32 v3, v3, v5
  v_lshlrev_b32 v3, 4, v3
  s_mov_b32 s45, 6144
  v_mul_lo_u32 v4, s45, v4
  v_add_u32 v3, v3, v4
  v_add_u32 v15, s43, v3
  v_add_u32 v3, 256, v2
  v_mul_u32_u24 v4, 2731, v3
  v_lshrrev_b32 v4, 16, v4
  v_mul_u32_u24 v5, 24, v4
  v_sub_u32 v3, v3, v5
  v_and_b32 v5, 2, v4
  v_lshrrev_b32 v6, 1, v4
  v_and_b32 v6, 4, v6
  v_or_b32 v5, v5, v6
  v_xor_b32 v3, v3, v5
  v_lshlrev_b32 v3, 4, v3
  s_mov_b32 s45, 6144
  v_mul_lo_u32 v4, s45, v4
  v_add_u32 v3, v3, v4
  v_add_u32 v16, s43, v3
  v_add_u32 v3, 320, v2
  v_mul_u32_u24 v4, 2731, v3
  v_lshrrev_b32 v4, 16, v4
  v_mul_u32_u24 v5, 24, v4
  v_sub_u32 v3, v3, v5
  v_and_b32 v5, 2, v4
  v_lshrrev_b32 v6, 1, v4
  v_and_b32 v6, 4, v6
  v_or_b32 v5, v5, v6
  v_xor_b32 v3, v3, v5
  v_lshlrev_b32 v3, 4, v3
  s_mov_b32 s45, 6144
  v_mul_lo_u32 v4, s45, v4
  v_add_u32 v3, v3, v4
  v_add_u32 v17, s43, v3
  s_mul_i32 s46, s42, 4096
  s_mul_i32 s47, s42, 6144
  s_add_u32 s47, s47, 16384
  s_mov_b32 s62, 0
  s_mov_b32 s63, 0
  s_add_u32 s35, s25, 72
  s_cmp_eq_u32 s24, 4
  s_cbranch_scc1 main_kernel_qkv_w4a
  s_add_u32 s52, s47, 0
  s_add_u32 s49, s63, 0
  s_add_u32 m0, s52, 0
  s_nop 0
  buffer_load_dwordx4 v12, s[8:11], s49 offen lds
  s_add_u32 m0, s52, 1024
  s_nop 0
  buffer_load_dwordx4 v13, s[8:11], s49 offen lds
  s_add_u32 m0, s52, 2048
  s_nop 0
  buffer_load_dwordx4 v14, s[8:11], s49 offen lds
  s_add_u32 m0, s52, 3072
  s_nop 0
  buffer_load_dwordx4 v15, s[8:11], s49 offen lds
  s_add_u32 m0, s52, 4096
  s_nop 0
  buffer_load_dwordx4 v16, s[8:11], s49 offen lds
  s_add_u32 m0, s52, 5120
  s_nop 0
  buffer_load_dwordx4 v17, s[8:11], s49 offen lds
  s_add_u32 s52, s47, 40960
  s_add_u32 s49, s63, 393216
  s_add_u32 m0, s52, 0
  s_nop 0
  buffer_load_dwordx4 v12, s[8:11], s49 offen lds
  s_add_u32 m0, s52, 1024
  s_nop 0
  buffer_load_dwordx4 v13, s[8:11], s49 offen lds
  s_add_u32 m0, s52, 2048
  s_nop 0
  buffer_load_dwordx4 v14, s[8:11], s49 offen lds
  s_add_u32 m0, s52, 3072
  s_nop 0
  buffer_load_dwordx4 v15, s[8:11], s49 offen lds
  s_add_u32 m0, s52, 4096
  s_nop 0
  buffer_load_dwordx4 v16, s[8:11], s49 offen lds
  s_add_u32 m0, s52, 5120
  s_nop 0
  buffer_load_dwordx4 v17, s[8:11], s49 offen lds
main_kernel_qkv_w4a:
  s_cmp_eq_u32 s24, 4
  s_cbranch_scc1 main_kernel_qkv_nowqpf
  s_mul_i32 s43, s2, 3
  s_add_u32 s43, s43, s24
  s_sub_u32 s43, s43, 5
  s_lshl_b32 s43, s43, 13
  v_lshlrev_b32 v3, 7, v2
  buffer_load_dword v253, v3, s[8:11], s43 offen
main_kernel_qkv_nowqpf:
  s_barrier
  s_cmp_lg_u32 s24, 4
  s_cbranch_scc1 main_kernel_dwqkv
  s_lshl_b32 s34, s25, 2
  s_lshr_b32 s33, s26, 2
  s_add_u32 s34, s34, s33
  s_lshl_b32 s34, s34, 7
  s_add_u32 s34, s34, 42496
  v_lshlrev_b32 v6, 2, v2
  v_add_u32 v6, s34, v6
  s_mov_b32 s33, 0
  s_mov_b64 exec, 0xffff
main_kernel_pollqkv:
  buffer_load_dword v7, v6, s[28:31], 0 offen sc1
  s_waitcnt vmcnt(0)
  v_cmp_ne_u32 vcc, 1, v7
  s_nop 0
  s_cmp_eq_u64 vcc, 0
  s_cbranch_scc1 main_kernel_pollxqkv
  s_add_u32 s33, s33, 1
  s_cmp_ge_u32 s33, 400000
  s_cbranch_scc1 main_kernel_pollxqkv
  s_sleep 2
  s_branch main_kernel_pollqkv
main_kernel_pollxqkv:
  s_mov_b64 exec, -1
  v_mov_b32 v6, 138284
  v_mov_b32 v7, 1
  ds_write_b32 v6, v7
  s_waitcnt lgkmcnt(0)
  s_branch main_kernel_dwxqkv
main_kernel_dwqkv:
  v_mov_b32 v6, 138284
  s_mov_b32 s33, 0
main_kernel_dwlqkv:
  ds_read_b32 v7, v6
  s_waitcnt lgkmcnt(0)
  v_readfirstlane_b32 s34, v7
  s_nop 0
  s_cmp_lg_u32 s34, 0
  s_cbranch_scc1 main_kernel_dwxqkv
  s_add_u32 s33, s33, 1
  s_cmp_ge_u32 s33, 1600000
  s_cbranch_scc1 main_kernel_dwxqkv
  s_sleep 1
  s_branch main_kernel_dwlqkv
main_kernel_dwxqkv:
  s_cmp_lg_u32 s24, 4
  s_cbranch_scc1 main_kernel_qkv_w4b
  s_add_u32 s52, s47, 0
  s_add_u32 s49, s63, 0
  s_add_u32 m0, s52, 0
  s_nop 0
  buffer_load_dwordx4 v12, s[8:11], s49 offen lds
  s_add_u32 m0, s52, 1024
  s_nop 0
  buffer_load_dwordx4 v13, s[8:11], s49 offen lds
  s_add_u32 m0, s52, 2048
  s_nop 0
  buffer_load_dwordx4 v14, s[8:11], s49 offen lds
  s_add_u32 m0, s52, 3072
  s_nop 0
  buffer_load_dwordx4 v15, s[8:11], s49 offen lds
  s_add_u32 m0, s52, 4096
  s_nop 0
  buffer_load_dwordx4 v16, s[8:11], s49 offen lds
  s_add_u32 m0, s52, 5120
  s_nop 0
  buffer_load_dwordx4 v17, s[8:11], s49 offen lds
  s_add_u32 s52, s47, 40960
  s_add_u32 s49, s63, 393216
  s_add_u32 m0, s52, 0
  s_nop 0
  buffer_load_dwordx4 v12, s[8:11], s49 offen lds
  s_add_u32 m0, s52, 1024
  s_nop 0
  buffer_load_dwordx4 v13, s[8:11], s49 offen lds
  s_add_u32 m0, s52, 2048
  s_nop 0
  buffer_load_dwordx4 v14, s[8:11], s49 offen lds
  s_add_u32 m0, s52, 3072
  s_nop 0
  buffer_load_dwordx4 v15, s[8:11], s49 offen lds
  s_add_u32 m0, s52, 4096
  s_nop 0
  buffer_load_dwordx4 v16, s[8:11], s49 offen lds
  s_add_u32 m0, s52, 5120
  s_nop 0
  buffer_load_dwordx4 v17, s[8:11], s49 offen lds
main_kernel_qkv_w4b:
  s_add_u32 s51, s46, 0
  s_add_u32 s48, s62, 0
  s_add_u32 m0, s51, 0
  s_nop 0
  buffer_load_dwordx4 v8, s[4:7], s48 offen sc1 lds
  s_add_u32 m0, s51, 1024
  s_nop 0
  buffer_load_dwordx4 v9, s[4:7], s48 offen sc1 lds
  s_add_u32 m0, s51, 2048
  s_nop 0
  buffer_load_dwordx4 v10, s[4:7], s48 offen sc1 lds
  s_add_u32 m0, s51, 3072
  s_nop 0
  buffer_load_dwordx4 v11, s[4:7], s48 offen sc1 lds
  s_add_u32 s51, s46, 40960
  s_add_u32 s48, s62, 128
  s_add_u32 m0, s51, 0
  s_nop 0
  buffer_load_dwordx4 v8, s[4:7], s48 offen sc1 lds
  s_add_u32 m0, s51, 1024
  s_nop 0
  buffer_load_dwordx4 v9, s[4:7], s48 offen sc1 lds
  s_add_u32 m0, s51, 2048
  s_nop 0
  buffer_load_dwordx4 v10, s[4:7], s48 offen sc1 lds
  s_add_u32 m0, s51, 3072
  s_nop 0
  buffer_load_dwordx4 v11, s[4:7], s48 offen sc1 lds
  s_add_u32 s48, s62, 256
  s_add_u32 s49, s63, 786432
  s_mov_b32 s50, 81920
  s_waitcnt vmcnt(4)
  s_barrier
  s_add_u32 s51, s50, s46
  s_add_u32 s52, s50, s47
  s_add_u32 m0, s51, 0
  s_nop 0
  buffer_load_dwordx4 v8, s[4:7], s48 offen sc1 lds
  s_add_u32 m0, s51, 1024
  s_nop 0
  buffer_load_dwordx4 v9, s[4:7], s48 offen sc1 lds
  s_add_u32 m0, s51, 2048
  s_nop 0
  buffer_load_dwordx4 v10, s[4:7], s48 offen sc1 lds
  s_add_u32 m0, s51, 3072
  s_nop 0
  buffer_load_dwordx4 v11, s[4:7], s48 offen sc1 lds
  s_add_u32 m0, s52, 0
  s_nop 0
  buffer_load_dwordx4 v12, s[8:11], s49 offen lds
  s_add_u32 m0, s52, 1024
  s_nop 0
  buffer_load_dwordx4 v13, s[8:11], s49 offen lds
  s_add_u32 m0, s52, 2048
  s_nop 0
  buffer_load_dwordx4 v14, s[8:11], s49 offen lds
  s_add_u32 m0, s52, 3072
  s_nop 0
  buffer_load_dwordx4 v15, s[8:11], s49 offen lds
  s_add_u32 m0, s52, 4096
  s_nop 0
  buffer_load_dwordx4 v16, s[8:11], s49 offen lds
  s_add_u32 m0, s52, 5120
  s_nop 0
  buffer_load_dwordx4 v17, s[8:11], s49 offen lds
  s_add_u32 s48, s48, 128
  s_add_u32 s49, s49, 393216
  s_add_u32 s50, s50, 40960
  s_cmp_eq_u32 s50, 122880
  s_cselect_b32 s50, 0, s50
  s_waitcnt vmcnt(10)
  s_barrier
  s_add_u32 s51, s50, s46
  s_add_u32 s52, s50, s47
  s_add_u32 m0, s51, 0
  s_nop 0
  buffer_load_dwordx4 v8, s[4:7], s48 offen sc1 lds
  s_add_u32 m0, s51, 1024
  s_nop 0
  buffer_load_dwordx4 v9, s[4:7], s48 offen sc1 lds
  s_add_u32 m0, s51, 2048
  s_nop 0
  buffer_load_dwordx4 v10, s[4:7], s48 offen sc1 lds
  s_add_u32 m0, s51, 3072
  s_nop 0
  buffer_load_dwordx4 v11, s[4:7], s48 offen sc1 lds
  s_add_u32 m0, s52, 0
  s_nop 0
  buffer_load_dwordx4 v12, s[8:11], s49 offen lds
  s_add_u32 m0, s52, 1024
  s_nop 0
  buffer_load_dwordx4 v13, s[8:11], s49 offen lds
  s_add_u32 m0, s52, 2048
  s_nop 0
  buffer_load_dwordx4 v14, s[8:11], s49 offen lds
  s_add_u32 m0, s52, 3072
  s_nop 0
  buffer_load_dwordx4 v15, s[8:11], s49 offen lds
  s_add_u32 m0, s52, 4096
  s_nop 0
  buffer_load_dwordx4 v16, s[8:11], s49 offen lds
  s_add_u32 m0, s52, 5120
  s_nop 0
  buffer_load_dwordx4 v17, s[8:11], s49 offen lds
  s_add_u32 s48, s48, 128
  s_add_u32 s49, s49, 393216
  s_add_u32 s50, s50, 40960
  s_cmp_eq_u32 s50, 122880
  s_cselect_b32 s50, 0, s50
  s_mov_b32 s53, 12
main_kernel_qkv_lloop:
  s_waitcnt vmcnt(10)
  s_barrier
  s_add_u32 s51, s50, s46
  s_add_u32 s52, s50, s47
  s_add_u32 m0, s51, 0
  s_nop 0
  buffer_load_dwordx4 v8, s[4:7], s48 offen sc1 lds
  s_add_u32 m0, s51, 1024
  s_nop 0
  buffer_load_dwordx4 v9, s[4:7], s48 offen sc1 lds
  s_add_u32 m0, s51, 2048
  s_nop 0
  buffer_load_dwordx4 v10, s[4:7], s48 offen sc1 lds
  s_add_u32 m0, s51, 3072
  s_nop 0
  buffer_load_dwordx4 v11, s[4:7], s48 offen sc1 lds
  s_add_u32 m0, s52, 0
  s_nop 0
  buffer_load_dwordx4 v12, s[8:11], s49 offen lds
  s_add_u32 m0, s52, 1024
  s_nop 0
  buffer_load_dwordx4 v13, s[8:11], s49 offen lds
  s_add_u32 m0, s52, 2048
  s_nop 0
  buffer_load_dwordx4 v14, s[8:11], s49 offen lds
  s_add_u32 m0, s52, 3072
  s_nop 0
  buffer_load_dwordx4 v15, s[8:11], s49 offen lds
  s_add_u32 m0, s52, 4096
  s_nop 0
  buffer_load_dwordx4 v16, s[8:11], s49 offen lds
  s_add_u32 m0, s52, 5120
  s_nop 0
  buffer_load_dwordx4 v17, s[8:11], s49 offen lds
  s_add_u32 s48, s48, 128
  s_add_u32 s49, s49, 393216
  s_add_u32 s50, s50, 40960
  s_cmp_eq_u32 s50, 122880
  s_cselect_b32 s50, 0, s50
  s_sub_u32 s53, s53, 1
  s_cmp_lg_u32 s53, 0
  s_cbranch_scc1 main_kernel_qkv_lloop
  s_waitcnt vmcnt(10)
  s_barrier
  s_load_dwordx4 s[36:39], s[0:1], 48
  s_and_b32 s58, s2, 3
  s_lshr_b32 s59, s2, 2
  s_add_u32 s59, s59, 32
  s_mov_b32 s64, s58
  s_mov_b32 s65, s59
  v_subrev_u32 v3, 256, v0
  v_lshrrev_b32 v6, 3, v3
  v_and_b32 v7, 7, v3
  v_mov_b32 v22, v7
  s_lshl_b32 s43, s58, 8
  v_add_u32 v6, s43, v6
  v_lshlrev_b32 v4, 1, v6
  v_mul_u32_u24 v5, 12288, v6
  v_lshlrev_b32 v6, 4, v7
  v_add_u32 v5, v5, v6
  s_lshl_b32 s43, s59, 7
  v_add_u32 v5, s43, v5
  s_waitcnt lgkmcnt(0)
  s_mov_b32 s52, s36
  s_mov_b32 s53, s37
  s_mov_b32 s54, 0x800
  s_mov_b32 s55, 0x20000
  s_mov_b32 s60, s38
  s_mov_b32 s61, s39
  s_mov_b32 s62, 0xc00000
  s_mov_b32 s63, 0x20000
  buffer_load_ushort v24, v4, s[52:55], 0 offen offset:0
  buffer_load_ushort v25, v4, s[52:55], 0 offen offset:64
  buffer_load_ushort v26, v4, s[52:55], 0 offen offset:128
  buffer_load_ushort v27, v4, s[52:55], 0 offen offset:192
  buffer_load_ushort v28, v4, s[52:55], 0 offen offset:256
  buffer_load_ushort v29, v4, s[52:55], 0 offen offset:320
  buffer_load_ushort v30, v4, s[52:55], 0 offen offset:384
  buffer_load_ushort v31, v4, s[52:55], 0 offen offset:448
  s_mov_b32 s43, 0
  buffer_load_dwordx4 v[32:35], v5, s[60:63], s43 offen
  s_mov_b32 s43, 393216
  buffer_load_dwordx4 v[36:39], v5, s[60:63], s43 offen
  s_mov_b32 s43, 786432
  buffer_load_dwordx4 v[40:43], v5, s[60:63], s43 offen
  s_mov_b32 s43, 1179648
  buffer_load_dwordx4 v[44:47], v5, s[60:63], s43 offen
  s_mov_b32 s43, 1572864
  buffer_load_dwordx4 v[48:51], v5, s[60:63], s43 offen
  s_mov_b32 s43, 1966080
  buffer_load_dwordx4 v[52:55], v5, s[60:63], s43 offen
  s_mov_b32 s43, 2359296
  buffer_load_dwordx4 v[56:59], v5, s[60:63], s43 offen
  s_mov_b32 s43, 2752512
  buffer_load_dwordx4 v[60:63], v5, s[60:63], s43 offen
  s_waitcnt vmcnt(16)
  s_barrier
  v_mov_b32 v64, 0
  v_mov_b32 v65, 0
  v_mov_b32 v66, 0
  v_mov_b32 v67, 0
  v_mov_b32 v68, 0
  v_mov_b32 v69, 0
  v_mov_b32 v70, 0
  v_mov_b32 v71, 0
  s_waitcnt vmcnt(8)
  v_lshlrev_b32 v24, 16, v24
  v_mul_f32 v72, 0xbfb8aa3b, v24
  v_exp_f32 v72, v72
  s_nop 0
  v_add_f32 v72, 1.0, v72
  v_rcp_f32 v72, v72
  s_nop 0
  v_mul_f32 v24, v24, v72
  v_cvt_pk_bf16_f32 v24, v24, v24
  v_lshlrev_b32 v24, 16, v24
  v_lshlrev_b32 v25, 16, v25
  v_mul_f32 v72, 0xbfb8aa3b, v25
  v_exp_f32 v72, v72
  s_nop 0
  v_add_f32 v72, 1.0, v72
  v_rcp_f32 v72, v72
  s_nop 0
  v_mul_f32 v25, v25, v72
  v_cvt_pk_bf16_f32 v25, v25, v25
  v_lshlrev_b32 v25, 16, v25
  v_lshlrev_b32 v26, 16, v26
  v_mul_f32 v72, 0xbfb8aa3b, v26
  v_exp_f32 v72, v72
  s_nop 0
  v_add_f32 v72, 1.0, v72
  v_rcp_f32 v72, v72
  s_nop 0
  v_mul_f32 v26, v26, v72
  v_cvt_pk_bf16_f32 v26, v26, v26
  v_lshlrev_b32 v26, 16, v26
  v_lshlrev_b32 v27, 16, v27
  v_mul_f32 v72, 0xbfb8aa3b, v27
  v_exp_f32 v72, v72
  s_nop 0
  v_add_f32 v72, 1.0, v72
  v_rcp_f32 v72, v72
  s_nop 0
  v_mul_f32 v27, v27, v72
  v_cvt_pk_bf16_f32 v27, v27, v27
  v_lshlrev_b32 v27, 16, v27
  v_lshlrev_b32 v28, 16, v28
  v_mul_f32 v72, 0xbfb8aa3b, v28
  v_exp_f32 v72, v72
  s_nop 0
  v_add_f32 v72, 1.0, v72
  v_rcp_f32 v72, v72
  s_nop 0
  v_mul_f32 v28, v28, v72
  v_cvt_pk_bf16_f32 v28, v28, v28
  v_lshlrev_b32 v28, 16, v28
  v_lshlrev_b32 v29, 16, v29
  v_mul_f32 v72, 0xbfb8aa3b, v29
  v_exp_f32 v72, v72
  s_nop 0
  v_add_f32 v72, 1.0, v72
  v_rcp_f32 v72, v72
  s_nop 0
  v_mul_f32 v29, v29, v72
  v_cvt_pk_bf16_f32 v29, v29, v29
  v_lshlrev_b32 v29, 16, v29
  v_lshlrev_b32 v30, 16, v30
  v_mul_f32 v72, 0xbfb8aa3b, v30
  v_exp_f32 v72, v72
  s_nop 0
  v_add_f32 v72, 1.0, v72
  v_rcp_f32 v72, v72
  s_nop 0
  v_mul_f32 v30, v30, v72
  v_cvt_pk_bf16_f32 v30, v30, v30
  v_lshlrev_b32 v30, 16, v30
  v_lshlrev_b32 v31, 16, v31
  v_mul_f32 v72, 0xbfb8aa3b, v31
  v_exp_f32 v72, v72
  s_nop 0
  v_add_f32 v72, 1.0, v72
  v_rcp_f32 v72, v72
  s_nop 0
  v_mul_f32 v31, v31, v72
  v_cvt_pk_bf16_f32 v31, v31, v31
  v_lshlrev_b32 v31, 16, v31
  s_waitcnt vmcnt(7)
  v_lshlrev_b32 v72, 16, v32
  v_and_b32 v73, 0xffff0000, v32
  v_fmac_f32 v64, v24, v72
  v_fmac_f32 v65, v24, v73
  v_lshlrev_b32 v72, 16, v33
  v_and_b32 v73, 0xffff0000, v33
  v_fmac_f32 v66, v24, v72
  v_fmac_f32 v67, v24, v73
  v_lshlrev_b32 v72, 16, v34
  v_and_b32 v73, 0xffff0000, v34
  v_fmac_f32 v68, v24, v72
  v_fmac_f32 v69, v24, v73
  v_lshlrev_b32 v72, 16, v35
  v_and_b32 v73, 0xffff0000, v35
  v_fmac_f32 v70, v24, v72
  v_fmac_f32 v71, v24, v73
  s_waitcnt vmcnt(6)
  v_lshlrev_b32 v72, 16, v36
  v_and_b32 v73, 0xffff0000, v36
  v_fmac_f32 v64, v25, v72
  v_fmac_f32 v65, v25, v73
  v_lshlrev_b32 v72, 16, v37
  v_and_b32 v73, 0xffff0000, v37
  v_fmac_f32 v66, v25, v72
  v_fmac_f32 v67, v25, v73
  v_lshlrev_b32 v72, 16, v38
  v_and_b32 v73, 0xffff0000, v38
  v_fmac_f32 v68, v25, v72
  v_fmac_f32 v69, v25, v73
  v_lshlrev_b32 v72, 16, v39
  v_and_b32 v73, 0xffff0000, v39
  v_fmac_f32 v70, v25, v72
  v_fmac_f32 v71, v25, v73
  s_waitcnt vmcnt(5)
  v_lshlrev_b32 v72, 16, v40
  v_and_b32 v73, 0xffff0000, v40
  v_fmac_f32 v64, v26, v72
  v_fmac_f32 v65, v26, v73
  v_lshlrev_b32 v72, 16, v41
  v_and_b32 v73, 0xffff0000, v41
  v_fmac_f32 v66, v26, v72
  v_fmac_f32 v67, v26, v73
  v_lshlrev_b32 v72, 16, v42
  v_and_b32 v73, 0xffff0000, v42
  v_fmac_f32 v68, v26, v72
  v_fmac_f32 v69, v26, v73
  v_lshlrev_b32 v72, 16, v43
  v_and_b32 v73, 0xffff0000, v43
  v_fmac_f32 v70, v26, v72
  v_fmac_f32 v71, v26, v73
  s_waitcnt vmcnt(4)
  v_lshlrev_b32 v72, 16, v44
  v_and_b32 v73, 0xffff0000, v44
  v_fmac_f32 v64, v27, v72
  v_fmac_f32 v65, v27, v73
  v_lshlrev_b32 v72, 16, v45
  v_and_b32 v73, 0xffff0000, v45
  v_fmac_f32 v66, v27, v72
  v_fmac_f32 v67, v27, v73
  v_lshlrev_b32 v72, 16, v46
  v_and_b32 v73, 0xffff0000, v46
  v_fmac_f32 v68, v27, v72
  v_fmac_f32 v69, v27, v73
  v_lshlrev_b32 v72, 16, v47
  v_and_b32 v73, 0xffff0000, v47
  v_fmac_f32 v70, v27, v72
  v_fmac_f32 v71, v27, v73
  s_waitcnt vmcnt(3)
  v_lshlrev_b32 v72, 16, v48
  v_and_b32 v73, 0xffff0000, v48
  v_fmac_f32 v64, v28, v72
  v_fmac_f32 v65, v28, v73
  v_lshlrev_b32 v72, 16, v49
  v_and_b32 v73, 0xffff0000, v49
  v_fmac_f32 v66, v28, v72
  v_fmac_f32 v67, v28, v73
  v_lshlrev_b32 v72, 16, v50
  v_and_b32 v73, 0xffff0000, v50
  v_fmac_f32 v68, v28, v72
  v_fmac_f32 v69, v28, v73
  v_lshlrev_b32 v72, 16, v51
  v_and_b32 v73, 0xffff0000, v51
  v_fmac_f32 v70, v28, v72
  v_fmac_f32 v71, v28, v73
  s_waitcnt vmcnt(2)
  v_lshlrev_b32 v72, 16, v52
  v_and_b32 v73, 0xffff0000, v52
  v_fmac_f32 v64, v29, v72
  v_fmac_f32 v65, v29, v73
  v_lshlrev_b32 v72, 16, v53
  v_and_b32 v73, 0xffff0000, v53
  v_fmac_f32 v66, v29, v72
  v_fmac_f32 v67, v29, v73
  v_lshlrev_b32 v72, 16, v54
  v_and_b32 v73, 0xffff0000, v54
  v_fmac_f32 v68, v29, v72
  v_fmac_f32 v69, v29, v73
  v_lshlrev_b32 v72, 16, v55
  v_and_b32 v73, 0xffff0000, v55
  v_fmac_f32 v70, v29, v72
  v_fmac_f32 v71, v29, v73
  s_waitcnt vmcnt(1)
  v_lshlrev_b32 v72, 16, v56
  v_and_b32 v73, 0xffff0000, v56
  v_fmac_f32 v64, v30, v72
  v_fmac_f32 v65, v30, v73
  v_lshlrev_b32 v72, 16, v57
  v_and_b32 v73, 0xffff0000, v57
  v_fmac_f32 v66, v30, v72
  v_fmac_f32 v67, v30, v73
  v_lshlrev_b32 v72, 16, v58
  v_and_b32 v73, 0xffff0000, v58
  v_fmac_f32 v68, v30, v72
  v_fmac_f32 v69, v30, v73
  v_lshlrev_b32 v72, 16, v59
  v_and_b32 v73, 0xffff0000, v59
  v_fmac_f32 v70, v30, v72
  v_fmac_f32 v71, v30, v73
  s_waitcnt vmcnt(0)
  v_lshlrev_b32 v72, 16, v60
  v_and_b32 v73, 0xffff0000, v60
  v_fmac_f32 v64, v31, v72
  v_fmac_f32 v65, v31, v73
  v_lshlrev_b32 v72, 16, v61
  v_and_b32 v73, 0xffff0000, v61
  v_fmac_f32 v66, v31, v72
  v_fmac_f32 v67, v31, v73
  v_lshlrev_b32 v72, 16, v62
  v_and_b32 v73, 0xffff0000, v62
  v_fmac_f32 v68, v31, v72
  v_fmac_f32 v69, v31, v73
  v_lshlrev_b32 v72, 16, v63
  v_and_b32 v73, 0xffff0000, v63
  v_fmac_f32 v70, v31, v72
  v_fmac_f32 v71, v31, v73
  v_add_f32_dpp v64, v64, v64 row_ror:8 row_mask:0xf bank_mask:0xf
  v_add_f32_dpp v65, v65, v65 row_ror:8 row_mask:0xf bank_mask:0xf
  v_add_f32_dpp v66, v66, v66 row_ror:8 row_mask:0xf bank_mask:0xf
  v_add_f32_dpp v67, v67, v67 row_ror:8 row_mask:0xf bank_mask:0xf
  v_add_f32_dpp v68, v68, v68 row_ror:8 row_mask:0xf bank_mask:0xf
  v_add_f32_dpp v69, v69, v69 row_ror:8 row_mask:0xf bank_mask:0xf
  v_add_f32_dpp v70, v70, v70 row_ror:8 row_mask:0xf bank_mask:0xf
  v_add_f32_dpp v71, v71, v71 row_ror:8 row_mask:0xf bank_mask:0xf
  v_mov_b32 v72, v64
  s_nop 1
  v_permlane16_swap_b32 v72, v64
  v_add_f32 v64, v64, v72
  v_mov_b32 v72, v65
  s_nop 1
  v_permlane16_swap_b32 v72, v65
  v_add_f32 v65, v65, v72
  v_mov_b32 v72, v66
  s_nop 1
  v_permlane16_swap_b32 v72, v66
  v_add_f32 v66, v66, v72
  v_mov_b32 v72, v67
  s_nop 1
  v_permlane16_swap_b32 v72, v67
  v_add_f32 v67, v67, v72
  v_mov_b32 v72, v68
  s_nop 1
  v_permlane16_swap_b32 v72, v68
  v_add_f32 v68, v68, v72
  v_mov_b32 v72, v69
  s_nop 1
  v_permlane16_swap_b32 v72, v69
  v_add_f32 v69, v69, v72
  v_mov_b32 v72, v70
  s_nop 1
  v_permlane16_swap_b32 v72, v70
  v_add_f32 v70, v70, v72
  v_mov_b32 v72, v71
  s_nop 1
  v_permlane16_swap_b32 v72, v71
  v_add_f32 v71, v71, v72
  v_mov_b32 v72, v64
  s_nop 1
  v_permlane32_swap_b32 v72, v64
  v_add_f32 v64, v64, v72
  v_mov_b32 v72, v65
  s_nop 1
  v_permlane32_swap_b32 v72, v65
  v_add_f32 v65, v65, v72
  v_mov_b32 v72, v66
  s_nop 1
  v_permlane32_swap_b32 v72, v66
  v_add_f32 v66, v66, v72
  v_mov_b32 v72, v67
  s_nop 1
  v_permlane32_swap_b32 v72, v67
  v_add_f32 v67, v67, v72
  v_mov_b32 v72, v68
  s_nop 1
  v_permlane32_swap_b32 v72, v68
  v_add_f32 v68, v68, v72
  v_mov_b32 v72, v69
  s_nop 1
  v_permlane32_swap_b32 v72, v69
  v_add_f32 v69, v69, v72
  v_mov_b32 v72, v70
  s_nop 1
  v_permlane32_swap_b32 v72, v70
  v_add_f32 v70, v70, v72
  v_mov_b32 v72, v71
  s_nop 1
  v_permlane32_swap_b32 v72, v71
  v_add_f32 v71, v71, v72
  s_sub_u32 s43, s24, 4
  s_lshl_b32 s43, s43, 8
  v_lshlrev_b32 v9, 5, v22
  v_add_u32 v9, s43, v9
  v_add_u32 v9, 139264, v9
  s_mov_b64 exec, 0xff
  ds_write_b128 v9, v[64:67]
  ds_write_b128 v9, v[68:71] offset:16
  s_waitcnt lgkmcnt(0)
  v_mov_b32 v6, 138264
  v_mov_b32 v8, 1
  s_mov_b64 exec, 1
  ds_add_rtn_u32 v8, v6, v8
  s_waitcnt lgkmcnt(0)
  v_readfirstlane_b32 s43, v8
  s_mov_b64 exec, -1
  s_cmp_lg_u32 s43, 3
  s_cbranch_scc1 main_kernel_qkv_mrx
  v_lshlrev_b32 v9, 2, v2
  v_add_u32 v10, 139264, v9
  ds_read_b32 v12, v10 offset:0
  ds_read_b32 v13, v10 offset:256
  ds_read_b32 v14, v10 offset:512
  ds_read_b32 v15, v10 offset:768
  s_waitcnt lgkmcnt(0)
  v_add_f32 v12, v12, v13
  v_add_f32 v14, v14, v15
  v_add_f32 v12, v12, v14
  s_mov_b32 s52, s66
  s_mov_b32 s53, s67
  s_mov_b32 s54, 0x18000
  s_mov_b32 s55, 0x20000
  s_mul_i32 s43, s64, 24576
  s_lshl_b32 s44, s65, 8
  s_add_u32 s43, s43, s44
  buffer_store_dword v12, v9, s[52:55], s43 offen sc1
  s_waitcnt vmcnt(0)
  s_add_u32 s60, s66, 0x20000
  s_addc_u32 s61, s67, 0
  s_mov_b32 s62, 0x6000
  s_mov_b32 s63, 0x20000
  s_sub_u32 s45, s65, 32
  s_add_u32 s45, s45, 88
  s_lshl_b32 s45, s45, 8
  v_mov_b32 v6, s45
  v_mov_b32 v8, 1
  s_mov_b64 exec, 1
  buffer_atomic_add v8, v6, s[28:31], 0 offen sc0 sc1
  s_waitcnt vmcnt(0)
  v_readfirstlane_b32 s45, v8
  s_mov_b64 exec, -1
  s_cmp_lg_u32 s45, 3
  s_cbranch_scc1 main_kernel_qkv_mrx
  s_add_u32 s45, s44, 0
  s_nop 0
  buffer_load_dword v12, v9, s[52:55], s45 offen sc1
  s_add_u32 s45, s44, 24576
  buffer_load_dword v13, v9, s[52:55], s45 offen sc1
  s_add_u32 s45, s44, 49152
  buffer_load_dword v14, v9, s[52:55], s45 offen sc1
  s_add_u32 s45, s44, 73728
  buffer_load_dword v15, v9, s[52:55], s45 offen sc1
  s_waitcnt vmcnt(0)
  v_add_f32 v12, v12, v13
  v_add_f32 v14, v14, v15
  v_add_f32 v12, v12, v14
  v_cvt_pk_bf16_f32 v12, v12, v12
  v_lshlrev_b32 v12, 16, v12
  buffer_store_dword v12, v9, s[60:63], s44 offen sc1
  s_waitcnt vmcnt(0)
  v_mov_b32 v6, 38912
  v_mov_b32 v8, 1
  s_mov_b64 exec, 1
  buffer_atomic_add v8, v6, s[28:31], 0 offen sc0 sc1
  s_waitcnt vmcnt(0)
  v_readfirstlane_b32 s45, v8
  s_mov_b64 exec, -1
  s_cmp_lg_u32 s45, 63
  s_cbranch_scc1 main_kernel_qkv_mrx
  v_lshlrev_b32 v6, 7, v2
  v_add_u32 v6, 271872, v6
  v_mov_b32 v8, 1
  s_mov_b64 exec, 0xff
  buffer_store_dword v8, v6, s[28:31], 0 offen sc1
  s_mov_b64 exec, -1
main_kernel_qkv_mrx:
  s_branch main_kernel_att_l
main_kernel_att_c:
main_kernel_att_l:
  s_and_b32 s36, s2, 7
  s_lshr_b32 s37, s2, 3
  s_lshl_b32 s36, s36, 2
  s_lshr_b32 s38, s37, 3
  s_add_u32 s25, s36, s38
  s_and_b32 s26, s37, 7
  s_and_b32 s34, s24, 3
  s_lshr_b32 s27, s24, 2
  s_mov_b32 s57, s34
  s_lshl_b32 s40, s25, 17
  s_add_u32 s32, s66, 0x500000
  s_addc_u32 s33, s67, 0
  s_add_u32 s32, s32, s40
  s_addc_u32 s33, s33, 0
  s_mov_b32 s4, s32
  s_mov_b32 s5, s33
  s_mov_b32 s6, 0x20000
  s_mov_b32 s7, 0x20000
  s_add_u32 s8, s32, 0x400000
  s_addc_u32 s9, s33, 0
  s_mov_b32 s10, 0x20000
  s_mov_b32 s11, 0x20000
  s_add_u32 s12, s32, 0x800000
  s_addc_u32 s13, s33, 0
  s_mov_b32 s14, 0x20000
  s_mov_b32 s15, 0x20000
  s_add_u32 s16, s66, 0x1100000
  s_addc_u32 s17, s67, 0
  s_mov_b32 s18, 0x400000
  s_mov_b32 s19, 0x20000
  v_and_b32 v220, 31, v2
  v_lshrrev_b32 v219, 5, v2
  s_lshl_b32 s39, s26, 8
  s_lshl_b32 s40, s57, 6
  s_add_u32 s39, s39, s40
  v_lshrrev_b32 v221, 2, v2
  s_lshl_b32 s40, s57, 5
  v_add_u32 v221, s40, v221
  v_lshlrev_b32 v221, 6, v221
  v_and_b32 v222, 3, v2
  v_lshrrev_b32 v223, 4, v2
  v_xor_b32 v222, v222, v223
  v_lshlrev_b32 v222, 4, v222
  v_add_u32 v217, v221, v222
  v_lshlrev_b32 v218, 4, v2
  s_lshl_b32 s40, s57, 11
  v_add_u32 v218, s40, v218
  s_lshl_b32 s41, s57, 11
  s_mul_i32 s40, s27, 16384
  s_add_u32 s41, s41, s40
  s_mul_i32 s45, s27, 65536
  s_mul_i32 s40, s27, 16384
  v_lshrrev_b32 v221, 2, v220
  v_and_b32 v221, 3, v221
  v_xor_b32 v221, v221, v219
  v_lshlrev_b32 v221, 4, v221
  v_lshlrev_b32 v222, 6, v220
  v_add_u32 v224, v221, v222
  v_add_u32 v212, s40, v224
  v_xor_b32 v213, 32, v212
  v_and_b32 v221, 15, v2
  v_lshrrev_b32 v221, 2, v221
  v_lshlrev_b32 v222, 2, v219
  v_add_u32 v221, v221, v222
  v_lshlrev_b32 v221, 6, v221
  v_lshrrev_b32 v222, 4, v2
  v_and_b32 v222, 1, v222
  v_lshlrev_b32 v222, 5, v222
  v_add_u32 v221, v221, v222
  v_and_b32 v222, 3, v2
  v_lshlrev_b32 v222, 3, v222
  v_add_u32 v221, v221, v222
  v_add_u32 v221, 8192, v221
  v_add_u32 v214, s40, v221
  v_add_u32 v212, 32768, v212
  v_add_u32 v213, 32768, v213
  v_add_u32 v214, 32768, v214
  v_add_u32 v224, 32768, v224
  v_and_b32 v221, 4, v2
  v_cmp_eq_u32 vcc, 0, v221
  v_mov_b32 v222, 0x3f803f80
  s_nop 0
  v_cndmask_b32 v112, 0, v222, vcc
  v_cndmask_b32 v114, v222, 0, vcc
  v_mov_b32 v113, v112
  v_mov_b32 v115, v114
  v_and_b32 v221, 2, v2
  v_cmp_eq_u32 vcc, 0, v221
  v_mov_b32 v222, 0xeeeeeeee
  v_mov_b32 v223, 0x44444444
  v_cndmask_b32 v239, v222, v223, vcc
  v_mov_b32 v72, 0
  v_mov_b32 v73, 0
  v_mov_b32 v74, 0
  v_mov_b32 v75, 0
  v_mov_b32 v76, 0
  v_mov_b32 v77, 0
  v_mov_b32 v78, 0
  v_mov_b32 v79, 0
  v_mov_b32 v80, 0
  v_mov_b32 v81, 0
  v_mov_b32 v82, 0
  v_mov_b32 v83, 0
  v_mov_b32 v84, 0
  v_mov_b32 v85, 0
  v_mov_b32 v86, 0
  v_mov_b32 v87, 0
  v_mov_b32 v88, 0
  v_mov_b32 v89, 0
  v_mov_b32 v90, 0
  v_mov_b32 v91, 0
  v_mov_b32 v92, 0
  v_mov_b32 v93, 0
  v_mov_b32 v94, 0
  v_mov_b32 v95, 0
  v_mov_b32 v96, 0
  v_mov_b32 v97, 0
  v_mov_b32 v98, 0
  v_mov_b32 v99, 0
  v_mov_b32 v100, 0
  v_mov_b32 v101, 0
  v_mov_b32 v102, 0
  v_mov_b32 v103, 0
  v_mov_b32 v104, 0
  v_mov_b32 v105, 0
  v_mov_b32 v106, 0
  v_mov_b32 v107, 0
  v_mov_b32 v108, 0
  v_mov_b32 v109, 0
  v_mov_b32 v110, 0
  v_mov_b32 v111, 0
  v_mov_b32 v32, 0
  v_mov_b32 v33, 0
  v_mov_b32 v34, 0
  v_mov_b32 v35, 0
  v_mov_b32 v36, 0
  v_mov_b32 v37, 0
  v_mov_b32 v38, 0
  v_mov_b32 v39, 0
  v_mov_b32 v196, 0
  v_mov_b32 v197, 0
  v_mov_b32 v198, 0
  v_mov_b32 v199, 0
  v_mov_b32 v200, 0
  v_mov_b32 v201, 0
  v_mov_b32 v202, 0
  v_mov_b32 v203, 0
  v_mov_b32 v204, 0
  v_mov_b32 v205, 0
  v_mov_b32 v206, 0
  v_mov_b32 v207, 0
  v_mov_b32 v208, 0
  v_mov_b32 v209, 0
  v_mov_b32 v210, 0
  v_mov_b32 v211, 0
  s_cmp_lg_u32 s24, 4
  s_cbranch_scc1 main_kernel_att_nodep
  s_lshl_b32 s35, s25, 8
  s_add_u32 s35, s35, 75264
  v_lshlrev_b32 v6, 2, v2
  v_add_u32 v6, s35, v6
  s_mov_b32 s33, 0
  s_mov_b32 exec_lo, -1
  s_mov_b32 exec_hi, 0xffff
main_kernel_pollatt:
  buffer_load_dword v7, v6, s[28:31], 0 offen sc1
  s_waitcnt vmcnt(0)
  v_cmp_ne_u32 vcc, 1, v7
  s_nop 0
  s_cmp_eq_u64 vcc, 0
  s_cbranch_scc1 main_kernel_pollxatt
  s_add_u32 s33, s33, 1
  s_cmp_ge_u32 s33, 400000
  s_cbranch_scc1 main_kernel_pollxatt
  s_sleep 2
  s_branch main_kernel_pollatt
main_kernel_pollxatt:
  s_mov_b64 exec, -1
main_kernel_att_nodep:
  s_barrier
  v_mov_b32 v221, 138404
  v_mov_b32 v222, 0
  ds_write_b32 v221, v222
  v_add_u32 v221, s39, v220
  v_lshlrev_b32 v221, 6, v221
  v_lshlrev_b32 v222, 4, v219
  v_add_u32 v221, v221, v222
  buffer_load_dwordx4 v[8:11], v221, s[4:7], 0 offen offset:0 sc1
  buffer_load_dwordx4 v[12:15], v221, s[4:7], 0 offen offset:32 sc1
  buffer_load_dwordx4 v[16:19], v221, s[4:7], 0 offen offset:2048 sc1
  buffer_load_dwordx4 v[20:23], v221, s[4:7], 0 offen offset:2080 sc1
  s_mov_b32 s42, 0
  s_mov_b32 s44, 32768
  s_add_u32 s43, s44, s41
  s_add_u32 s46, s42, s45
  s_mov_b32 m0, s43
  s_nop 0
  buffer_load_dwordx4 v217, s[8:11], s46 offen sc1 lds
  s_add_u32 m0, s43, 8192
  s_nop 0
  buffer_load_dwordx4 v218, s[12:15], s46 offen sc1 lds
  s_add_u32 s46, s46, 1024
  s_add_u32 m0, s43, 1024
  s_nop 0
  buffer_load_dwordx4 v217, s[8:11], s46 offen sc1 lds
  s_add_u32 m0, s43, 9216
  s_nop 0
  buffer_load_dwordx4 v218, s[12:15], s46 offen sc1 lds
  s_add_u32 s42, s42, 8192
  s_mov_b32 s44, 65536
  s_add_u32 s43, s44, s41
  s_add_u32 s46, s42, s45
  s_mov_b32 m0, s43
  s_nop 0
  buffer_load_dwordx4 v217, s[8:11], s46 offen sc1 lds
  s_add_u32 m0, s43, 8192
  s_nop 0
  buffer_load_dwordx4 v218, s[12:15], s46 offen sc1 lds
  s_add_u32 s46, s46, 1024
  s_add_u32 m0, s43, 1024
  s_nop 0
  buffer_load_dwordx4 v217, s[8:11], s46 offen sc1 lds
  s_add_u32 m0, s43, 9216
  s_nop 0
  buffer_load_dwordx4 v218, s[12:15], s46 offen sc1 lds
  s_add_u32 s42, s42, 8192
  s_waitcnt vmcnt(4)
  s_barrier
  v_xor_b32 v225, 32, v224
  ds_read_b128 v[24:27], v224 offset:0
  ds_read_b128 v[28:31], v225 offset:0
  s_waitcnt lgkmcnt(0)
  v_mfma_f32_32x32x16_bf16 v[148:163], v[24:27], v[8:11], 0
  v_mfma_f32_32x32x16_bf16 v[148:163], v[28:31], v[12:15], v[148:163]
  v_mfma_f32_32x32x16_bf16 v[164:179], v[24:27], v[16:19], 0
  v_mfma_f32_32x32x16_bf16 v[164:179], v[28:31], v[20:23], v[164:179]
  ds_read_b128 v[24:27], v212 offset:0
  ds_read_b128 v[28:31], v213 offset:0
  s_nop 7
  v_max3_f32 v221, v148, v149, v150
  v_max3_f32 v221, v221, v151, v152
  v_max3_f32 v221, v221, v153, v154
  v_max3_f32 v221, v221, v155, v156
  v_max3_f32 v221, v221, v157, v158
  v_max3_f32 v221, v221, v159, v160
  v_max3_f32 v221, v221, v161, v162
  v_max_f32 v221, v221, v163
  v_mov_b32 v222, v221
  s_nop 1
  v_permlane32_swap_b32 v222, v221
  v_max_f32 v221, v221, v222
  v_add_f32 v221, 0x42200000, v221
  v_sub_f32 v40, 0, v221
  v_sub_f32 v41, 0, v221
  v_sub_f32 v42, 0, v221
  v_sub_f32 v43, 0, v221
  v_sub_f32 v44, 0, v221
  v_sub_f32 v45, 0, v221
  v_sub_f32 v46, 0, v221
  v_sub_f32 v47, 0, v221
  v_sub_f32 v48, 0, v221
  v_sub_f32 v49, 0, v221
  v_sub_f32 v50, 0, v221
  v_sub_f32 v51, 0, v221
  v_sub_f32 v52, 0, v221
  v_sub_f32 v53, 0, v221
  v_sub_f32 v54, 0, v221
  v_sub_f32 v55, 0, v221
  v_max3_f32 v221, v164, v165, v166
  v_max3_f32 v221, v221, v167, v168
  v_max3_f32 v221, v221, v169, v170
  v_max3_f32 v221, v221, v171, v172
  v_max3_f32 v221, v221, v173, v174
  v_max3_f32 v221, v221, v175, v176
  v_max3_f32 v221, v221, v177, v178
  v_max_f32 v221, v221, v179
  v_mov_b32 v222, v221
  s_nop 1
  v_permlane32_swap_b32 v222, v221
  v_max_f32 v221, v221, v222
  v_add_f32 v221, 0x42200000, v221
  v_sub_f32 v56, 0, v221
  v_sub_f32 v57, 0, v221
  v_sub_f32 v58, 0, v221
  v_sub_f32 v59, 0, v221
  v_sub_f32 v60, 0, v221
  v_sub_f32 v61, 0, v221
  v_sub_f32 v62, 0, v221
  v_sub_f32 v63, 0, v221
  v_sub_f32 v64, 0, v221
  v_sub_f32 v65, 0, v221
  v_sub_f32 v66, 0, v221
  v_sub_f32 v67, 0, v221
  v_sub_f32 v68, 0, v221
  v_sub_f32 v69, 0, v221
  v_sub_f32 v70, 0, v221
  v_sub_f32 v71, 0, v221
  s_waitcnt lgkmcnt(0)
  v_mfma_f32_32x32x16_bf16 v[116:131], v[24:27], v[8:11], v[40:55]
  v_mfma_f32_32x32x16_bf16 v[116:131], v[28:31], v[12:15], v[116:131]
  v_mfma_f32_32x32x16_bf16 v[132:147], v[24:27], v[16:19], v[56:71]
  v_mfma_f32_32x32x16_bf16 v[132:147], v[28:31], v[20:23], v[132:147]
  ds_read_b128 v[24:27], v212 offset:2048
  ds_read_b128 v[28:31], v213 offset:2048
  v_add_u32 v215, 32768, v212
  v_add_u32 v216, 32768, v213
  s_mov_b32 s47, 2
  s_mov_b32 s48, 32768
  s_mov_b32 s49, 0xfffe8000
  s_mov_b32 s50, 98304
  s_waitcnt lgkmcnt(0)
  s_lshl_b32 s56, s2, 3
  s_add_u32 s56, s56, s24
  s_mul_i32 s58, s56, 52429
  s_lshr_b32 s58, s58, 18
  s_mul_i32 s58, s58, 5
  s_sub_u32 s58, s56, s58
  s_sub_u32 s58, 7, s58
  s_mov_b32 s44, 8
.p2align 6
main_kernel_att_floop:
  s_waitcnt lgkmcnt(4)
  v_mfma_f32_32x32x16_bf16 v[148:163], v[24:27], v[8:11], v[40:55]
  v_exp_f32 v116, v116
  v_exp_f32 v117, v117
  v_exp_f32 v118, v118
  v_exp_f32 v119, v119
  v_mfma_f32_32x32x16_bf16 v[164:179], v[24:27], v[16:19], v[56:71]
  v_exp_f32 v120, v120
  v_exp_f32 v121, v121
  v_cvt_pk_bf16_f32 v180, v116, v117
  v_cvt_pk_bf16_f32 v181, v118, v119
  v_exp_f32 v122, v122
  v_mfma_f32_32x32x16_bf16 v[148:163], v[28:31], v[12:15], v[148:163]
  v_exp_f32 v123, v123
  v_cvt_pk_bf16_f32 v182, v120, v121
  v_exp_f32 v124, v124
  v_exp_f32 v125, v125
  v_cvt_pk_bf16_f32 v183, v122, v123
  v_mfma_f32_32x32x16_bf16 v[164:179], v[28:31], v[20:23], v[164:179]
  ds_read_b128 v[24:27], v212 offset:4096
  ds_read_b128 v[28:31], v213 offset:4096
  v_exp_f32 v126, v126
  v_exp_f32 v127, v127
  v_exp_f32 v128, v128
  v_exp_f32 v129, v129
  s_waitcnt lgkmcnt(2)
  v_mfma_f32_32x32x16_bf16 v[72:87], v[32:35], v[196:199], v[72:87]
  v_cvt_pk_bf16_f32 v184, v124, v125
  v_cvt_pk_bf16_f32 v185, v126, v127
  v_exp_f32 v130, v130
  v_exp_f32 v131, v131
  v_cvt_pk_bf16_f32 v186, v128, v129
  v_cvt_pk_bf16_f32 v187, v130, v131
  v_exp_f32 v132, v132
  v_exp_f32 v133, v133
  v_mfma_f32_32x32x16_bf16 v[88:103], v[32:35], v[204:207], v[88:103]
  v_exp_f32 v134, v134
  v_exp_f32 v135, v135
  v_cvt_pk_bf16_f32 v188, v132, v133
  v_cvt_pk_bf16_f32 v189, v134, v135
  v_exp_f32 v136, v136
  v_exp_f32 v137, v137
  v_exp_f32 v138, v138
  v_mfma_f32_32x32x16_bf16 v[72:87], v[36:39], v[200:203], v[72:87]
  v_exp_f32 v139, v139
  v_cvt_pk_bf16_f32 v190, v136, v137
  v_exp_f32 v140, v140
  v_exp_f32 v141, v141
  v_cvt_pk_bf16_f32 v191, v138, v139
  v_smfmac_f32_16x16x64_bf16 v[104:107], v[112:115], v[196:203], v239
  v_exp_f32 v142, v142
  v_exp_f32 v143, v143
  v_mfma_f32_32x32x16_bf16 v[88:103], v[36:39], v[208:211], v[88:103]
  ds_read_b64_tr_b16 v[32:33], v214 offset:0
  ds_read_b64_tr_b16 v[34:35], v214 offset:512
  ds_read_b64_tr_b16 v[36:37], v214 offset:1024
  ds_read_b64_tr_b16 v[38:39], v214 offset:1536
  v_exp_f32 v144, v144
  v_exp_f32 v145, v145
  v_cvt_pk_bf16_f32 v192, v140, v141
  v_cvt_pk_bf16_f32 v193, v142, v143
  v_exp_f32 v146, v146
  v_smfmac_f32_16x16x64_bf16 v[108:111], v[112:115], v[204:211], v239
  v_exp_f32 v147, v147
  v_cvt_pk_bf16_f32 v194, v144, v145
  v_cvt_pk_bf16_f32 v195, v146, v147
  s_waitcnt lgkmcnt(4)
  v_mfma_f32_32x32x16_bf16 v[116:131], v[24:27], v[8:11], v[40:55]
  v_exp_f32 v148, v148
  v_exp_f32 v149, v149
  v_exp_f32 v150, v150
  v_exp_f32 v151, v151
  v_mfma_f32_32x32x16_bf16 v[132:147], v[24:27], v[16:19], v[56:71]
  v_exp_f32 v152, v152
  v_exp_f32 v153, v153
  v_cvt_pk_bf16_f32 v196, v148, v149
  v_cvt_pk_bf16_f32 v197, v150, v151
  v_exp_f32 v154, v154
  v_mfma_f32_32x32x16_bf16 v[116:131], v[28:31], v[12:15], v[116:131]
  v_exp_f32 v155, v155
  v_cvt_pk_bf16_f32 v198, v152, v153
  v_exp_f32 v156, v156
  v_exp_f32 v157, v157
  v_cvt_pk_bf16_f32 v199, v154, v155
  v_mfma_f32_32x32x16_bf16 v[132:147], v[28:31], v[20:23], v[132:147]
  ds_read_b128 v[24:27], v212 offset:6144
  ds_read_b128 v[28:31], v213 offset:6144
  v_exp_f32 v158, v158
  v_exp_f32 v159, v159
  v_exp_f32 v160, v160
  v_exp_f32 v161, v161
  s_waitcnt lgkmcnt(2)
  v_mfma_f32_32x32x16_bf16 v[72:87], v[32:35], v[180:183], v[72:87]
  v_cvt_pk_bf16_f32 v200, v156, v157
  v_cvt_pk_bf16_f32 v201, v158, v159
  v_exp_f32 v162, v162
  v_exp_f32 v163, v163
  v_cvt_pk_bf16_f32 v202, v160, v161
  v_cvt_pk_bf16_f32 v203, v162, v163
  v_exp_f32 v164, v164
  v_exp_f32 v165, v165
  v_mfma_f32_32x32x16_bf16 v[88:103], v[32:35], v[188:191], v[88:103]
  v_exp_f32 v166, v166
  v_exp_f32 v167, v167
  v_cvt_pk_bf16_f32 v204, v164, v165
  v_cvt_pk_bf16_f32 v205, v166, v167
  v_exp_f32 v168, v168
  v_exp_f32 v169, v169
  v_exp_f32 v170, v170
  v_mfma_f32_32x32x16_bf16 v[72:87], v[36:39], v[184:187], v[72:87]
  v_exp_f32 v171, v171
  v_cvt_pk_bf16_f32 v206, v168, v169
  v_exp_f32 v172, v172
  v_exp_f32 v173, v173
  v_cvt_pk_bf16_f32 v207, v170, v171
  v_smfmac_f32_16x16x64_bf16 v[104:107], v[112:115], v[180:187], v239
  v_exp_f32 v174, v174
  v_exp_f32 v175, v175
  v_mfma_f32_32x32x16_bf16 v[88:103], v[36:39], v[192:195], v[88:103]
  ds_read_b64_tr_b16 v[32:33], v214 offset:2048
  ds_read_b64_tr_b16 v[34:35], v214 offset:2560
  ds_read_b64_tr_b16 v[36:37], v214 offset:3072
  ds_read_b64_tr_b16 v[38:39], v214 offset:3584
  v_exp_f32 v176, v176
  v_exp_f32 v177, v177
  v_cvt_pk_bf16_f32 v208, v172, v173
  v_cvt_pk_bf16_f32 v209, v174, v175
  v_exp_f32 v178, v178
  v_smfmac_f32_16x16x64_bf16 v[108:111], v[112:115], v[188:195], v239
  v_exp_f32 v179, v179
  v_cvt_pk_bf16_f32 v210, v176, v177
  v_cvt_pk_bf16_f32 v211, v178, v179
  s_cmp_ge_u32 s42, 65536
  s_cbranch_scc1 main_kernel_att_nodma
  s_cmp_lg_u32 s27, 0
  s_cbranch_scc1 main_kernel_att_yw
  s_lshl_b32 s43, s57, 11
  s_add_u32 s43, s43, s50
  s_add_u32 s46, s42, 0
  s_add_u32 m0, s43, 0
  s_nop 0
  buffer_load_dwordx4 v217, s[8:11], s46 offen sc1 lds
  s_add_u32 m0, s43, 8192
  s_nop 0
  buffer_load_dwordx4 v218, s[12:15], s46 offen sc1 lds
  s_add_u32 s46, s46, 1024
  s_add_u32 m0, s43, 1024
  s_nop 0
  buffer_load_dwordx4 v217, s[8:11], s46 offen sc1 lds
  s_add_u32 m0, s43, 9216
  s_nop 0
  buffer_load_dwordx4 v218, s[12:15], s46 offen sc1 lds
  s_add_u32 s46, s42, 65536
  s_add_u32 m0, s43, 16384
  s_nop 0
  buffer_load_dwordx4 v217, s[8:11], s46 offen sc1 lds
  s_add_u32 m0, s43, 24576
  s_nop 0
  buffer_load_dwordx4 v218, s[12:15], s46 offen sc1 lds
  s_add_u32 s46, s46, 1024
  s_add_u32 m0, s43, 17408
  s_nop 0
  buffer_load_dwordx4 v217, s[8:11], s46 offen sc1 lds
  s_add_u32 m0, s43, 25600
  s_nop 0
  buffer_load_dwordx4 v218, s[12:15], s46 offen sc1 lds
  s_waitcnt vmcnt(8)
  s_branch main_kernel_att_yb
main_kernel_att_yw:
  s_cmp_lg_u32 s44, 8
  s_cbranch_scc1 main_kernel_att_yb
  s_waitcnt vmcnt(0)
main_kernel_att_yb:
  s_barrier
  s_add_u32 s42, s42, 8192
  s_add_u32 s50, s50, 32768
  s_cmp_eq_u32 s50, 131072
  s_cselect_b32 s50, 0, s50
  s_cmp_lg_u32 s44, s58
  s_cbranch_scc1 main_kernel_att_cont
  s_mov_b32 s60, s76
  s_mov_b32 s61, s77
  s_mov_b32 s62, 2097152
  s_mov_b32 s63, 0x20000
  s_mov_b32 s52, s56
  s_cmp_lt_u32 s56, 256
  s_cbranch_scc1 main_kernel_att_pfgo
  s_mov_b32 s60, s72
  s_mov_b32 s61, s73
  s_mov_b32 s62, 7340032
  s_mov_b32 s63, 0x20000
  s_sub_u32 s52, s56, 256
  s_cmp_lt_u32 s56, 1152
  s_cbranch_scc1 main_kernel_att_pfgo
  s_mov_b32 s60, s74
  s_mov_b32 s61, s75
  s_mov_b32 s62, 7340032
  s_mov_b32 s63, 0x20000
  s_sub_u32 s52, s56, 1152
main_kernel_att_pfgo:
  s_lshl_b32 s52, s52, 13
  v_lshlrev_b32 v221, 7, v2
  buffer_load_dword v230, v221, s[60:63], s52 offen
  s_branch main_kernel_att_cont
main_kernel_att_nodma:
  s_waitcnt vmcnt(0)
  s_barrier
main_kernel_att_cont:
  s_waitcnt lgkmcnt(4)
  v_mfma_f32_32x32x16_bf16 v[148:163], v[24:27], v[8:11], v[40:55]
  v_exp_f32 v116, v116
  v_exp_f32 v117, v117
  v_exp_f32 v118, v118
  v_exp_f32 v119, v119
  v_mfma_f32_32x32x16_bf16 v[164:179], v[24:27], v[16:19], v[56:71]
  v_exp_f32 v120, v120
  v_exp_f32 v121, v121
  v_cvt_pk_bf16_f32 v180, v116, v117
  v_cvt_pk_bf16_f32 v181, v118, v119
  v_exp_f32 v122, v122
  v_mfma_f32_32x32x16_bf16 v[148:163], v[28:31], v[12:15], v[148:163]
  v_exp_f32 v123, v123
  v_cvt_pk_bf16_f32 v182, v120, v121
  v_exp_f32 v124, v124
  v_exp_f32 v125, v125
  v_cvt_pk_bf16_f32 v183, v122, v123
  v_mfma_f32_32x32x16_bf16 v[164:179], v[28:31], v[20:23], v[164:179]
  ds_read_b128 v[24:27], v215 offset:0
  ds_read_b128 v[28:31], v216 offset:0
  v_exp_f32 v126, v126
  v_exp_f32 v127, v127
  v_exp_f32 v128, v128
  v_exp_f32 v129, v129
  s_waitcnt lgkmcnt(2)
  v_mfma_f32_32x32x16_bf16 v[72:87], v[32:35], v[196:199], v[72:87]
  v_cvt_pk_bf16_f32 v184, v124, v125
  v_cvt_pk_bf16_f32 v185, v126, v127
  v_exp_f32 v130, v130
  v_exp_f32 v131, v131
  v_cvt_pk_bf16_f32 v186, v128, v129
  v_cvt_pk_bf16_f32 v187, v130, v131
  v_exp_f32 v132, v132
  v_exp_f32 v133, v133
  v_mfma_f32_32x32x16_bf16 v[88:103], v[32:35], v[204:207], v[88:103]
  v_exp_f32 v134, v134
  v_exp_f32 v135, v135
  v_cvt_pk_bf16_f32 v188, v132, v133
  v_cvt_pk_bf16_f32 v189, v134, v135
  v_exp_f32 v136, v136
  v_exp_f32 v137, v137
  v_exp_f32 v138, v138
  v_mfma_f32_32x32x16_bf16 v[72:87], v[36:39], v[200:203], v[72:87]
  v_exp_f32 v139, v139
  v_cvt_pk_bf16_f32 v190, v136, v137
  v_exp_f32 v140, v140
  v_exp_f32 v141, v141
  v_cvt_pk_bf16_f32 v191, v138, v139
  v_smfmac_f32_16x16x64_bf16 v[104:107], v[112:115], v[196:203], v239
  v_exp_f32 v142, v142
  v_exp_f32 v143, v143
  v_mfma_f32_32x32x16_bf16 v[88:103], v[36:39], v[208:211], v[88:103]
  ds_read_b64_tr_b16 v[32:33], v214 offset:4096
  ds_read_b64_tr_b16 v[34:35], v214 offset:4608
  ds_read_b64_tr_b16 v[36:37], v214 offset:5120
  ds_read_b64_tr_b16 v[38:39], v214 offset:5632
  v_exp_f32 v144, v144
  v_exp_f32 v145, v145
  v_cvt_pk_bf16_f32 v192, v140, v141
  v_cvt_pk_bf16_f32 v193, v142, v143
  v_exp_f32 v146, v146
  v_smfmac_f32_16x16x64_bf16 v[108:111], v[112:115], v[204:211], v239
  v_exp_f32 v147, v147
  v_cvt_pk_bf16_f32 v194, v144, v145
  v_cvt_pk_bf16_f32 v195, v146, v147
  s_waitcnt lgkmcnt(4)
  v_mfma_f32_32x32x16_bf16 v[116:131], v[24:27], v[8:11], v[40:55]
  v_exp_f32 v148, v148
  v_exp_f32 v149, v149
  v_exp_f32 v150, v150
  v_exp_f32 v151, v151
  v_mfma_f32_32x32x16_bf16 v[132:147], v[24:27], v[16:19], v[56:71]
  v_exp_f32 v152, v152
  v_exp_f32 v153, v153
  v_cvt_pk_bf16_f32 v196, v148, v149
  v_cvt_pk_bf16_f32 v197, v150, v151
  v_exp_f32 v154, v154
  v_mfma_f32_32x32x16_bf16 v[116:131], v[28:31], v[12:15], v[116:131]
  v_exp_f32 v155, v155
  v_cvt_pk_bf16_f32 v198, v152, v153
  v_exp_f32 v156, v156
  v_exp_f32 v157, v157
  v_cvt_pk_bf16_f32 v199, v154, v155
  v_mfma_f32_32x32x16_bf16 v[132:147], v[28:31], v[20:23], v[132:147]
  ds_read_b128 v[24:27], v215 offset:2048
  ds_read_b128 v[28:31], v216 offset:2048
  v_exp_f32 v158, v158
  v_exp_f32 v159, v159
  v_exp_f32 v160, v160
  v_exp_f32 v161, v161
  s_waitcnt lgkmcnt(2)
  v_mfma_f32_32x32x16_bf16 v[72:87], v[32:35], v[180:183], v[72:87]
  v_cvt_pk_bf16_f32 v200, v156, v157
  v_cvt_pk_bf16_f32 v201, v158, v159
  v_exp_f32 v162, v162
  v_exp_f32 v163, v163
  v_cvt_pk_bf16_f32 v202, v160, v161
  v_cvt_pk_bf16_f32 v203, v162, v163
  v_exp_f32 v164, v164
  v_exp_f32 v165, v165
  v_mfma_f32_32x32x16_bf16 v[88:103], v[32:35], v[188:191], v[88:103]
  v_exp_f32 v166, v166
  v_exp_f32 v167, v167
  v_cvt_pk_bf16_f32 v204, v164, v165
  v_cvt_pk_bf16_f32 v205, v166, v167
  v_exp_f32 v168, v168
  v_exp_f32 v169, v169
  v_exp_f32 v170, v170
  v_mfma_f32_32x32x16_bf16 v[72:87], v[36:39], v[184:187], v[72:87]
  v_exp_f32 v171, v171
  v_cvt_pk_bf16_f32 v206, v168, v169
  v_exp_f32 v172, v172
  v_exp_f32 v173, v173
  v_cvt_pk_bf16_f32 v207, v170, v171
  v_smfmac_f32_16x16x64_bf16 v[104:107], v[112:115], v[180:187], v239
  v_exp_f32 v174, v174
  v_exp_f32 v175, v175
  v_mfma_f32_32x32x16_bf16 v[88:103], v[36:39], v[192:195], v[88:103]
  ds_read_b64_tr_b16 v[32:33], v214 offset:6144
  ds_read_b64_tr_b16 v[34:35], v214 offset:6656
  ds_read_b64_tr_b16 v[36:37], v214 offset:7168
  ds_read_b64_tr_b16 v[38:39], v214 offset:7680
  v_exp_f32 v176, v176
  v_exp_f32 v177, v177
  v_cvt_pk_bf16_f32 v208, v172, v173
  v_cvt_pk_bf16_f32 v209, v174, v175
  v_exp_f32 v178, v178
  v_smfmac_f32_16x16x64_bf16 v[108:111], v[112:115], v[188:195], v239
  v_exp_f32 v179, v179
  v_cvt_pk_bf16_f32 v210, v176, v177
  v_cvt_pk_bf16_f32 v211, v178, v179
  v_sub_u32 v221, v215, v212
  v_add_u32 v214, v214, v221
  v_mov_b32 v212, v215
  v_mov_b32 v213, v216
  s_add_u32 s47, s47, 1
  s_cmp_eq_u32 s47, 4
  s_cselect_b32 s51, s49, s48
  s_cselect_b32 s47, 0, s47
  v_add_u32 v215, s51, v215
  v_add_u32 v216, s51, v216
  s_sub_u32 s44, s44, 1
  s_cmp_lg_u32 s44, 0
  s_cbranch_scc1 main_kernel_att_floop
  s_waitcnt lgkmcnt(0)
  v_mfma_f32_32x32x16_bf16 v[72:87], v[32:35], v[196:199], v[72:87]
  v_mfma_f32_32x32x16_bf16 v[72:87], v[36:39], v[200:203], v[72:87]
  v_smfmac_f32_16x16x64_bf16 v[104:107], v[112:115], v[196:203], v239
  v_mfma_f32_32x32x16_bf16 v[88:103], v[32:35], v[204:207], v[88:103]
  v_mfma_f32_32x32x16_bf16 v[88:103], v[36:39], v[208:211], v[88:103]
  v_smfmac_f32_16x16x64_bf16 v[108:111], v[112:115], v[204:211], v239
  s_nop 8
  v_add_f32 v104, v104, v106
  s_nop 1
  v_add_f32 v108, v108, v110
  v_add_f32 v223, abs(v72), abs(v73)
  v_add_f32 v224, abs(v88), abs(v89)
  v_add_f32 v223, v223, abs(v74)
  v_add_f32 v224, v224, abs(v90)
  v_add_f32 v223, v223, abs(v75)
  v_add_f32 v224, v224, abs(v91)
  v_add_f32 v223, v223, abs(v76)
  v_add_f32 v224, v224, abs(v92)
  v_add_f32 v223, v223, abs(v77)
  v_add_f32 v224, v224, abs(v93)
  v_add_f32 v223, v223, abs(v78)
  v_add_f32 v224, v224, abs(v94)
  v_add_f32 v223, v223, abs(v79)
  v_add_f32 v224, v224, abs(v95)
  v_add_f32 v223, v223, abs(v80)
  v_add_f32 v224, v224, abs(v96)
  v_add_f32 v223, v223, abs(v81)
  v_add_f32 v224, v224, abs(v97)
  v_add_f32 v223, v223, abs(v82)
  v_add_f32 v224, v224, abs(v98)
  v_add_f32 v223, v223, abs(v83)
  v_add_f32 v224, v224, abs(v99)
  v_add_f32 v223, v223, abs(v84)
  v_add_f32 v224, v224, abs(v100)
  v_add_f32 v223, v223, abs(v85)
  v_add_f32 v224, v224, abs(v101)
  v_add_f32 v223, v223, abs(v86)
  v_add_f32 v224, v224, abs(v102)
  v_add_f32 v223, v223, abs(v87)
  v_add_f32 v224, v224, abs(v103)
  v_add_f32 v223, v223, v224
  v_mov_b32 v222, 0x7e800000
  v_cmp_nlt_f32 vcc, v223, v222
  s_nop 0
  s_mov_b64 s[46:47], vcc
  v_add_f32 v223, v104, v108
  v_mov_b32 v222, 0x7b000000
  v_cmp_nlt_f32 vcc, v223, v222
  s_nop 0
  s_or_b64 s[46:47], s[46:47], vcc
  s_cmp_eq_u64 s[46:47], 0
  s_cbranch_scc1 main_kernel_att_okwave
  v_mov_b32 v222, 138404
  v_mov_b32 v223, 1
  ds_write_b32 v222, v223
main_kernel_att_okwave:
  s_mul_i32 s52, s24, 4352
  s_add_u32 s52, s52, 98304
  v_lshlrev_b32 v221, 4, v2
  v_add_u32 v221, s52, v221
  v_lshlrev_b32 v222, 2, v2
  v_add_u32 v222, s52, v222
  s_cmp_eq_u32 s27, 0
  s_cbranch_scc1 main_kernel_att_snd0
  ds_write_b128 v221, v[72:75] offset:0
  ds_write_b128 v221, v[76:79] offset:1024
  ds_write_b128 v221, v[80:83] offset:2048
  ds_write_b128 v221, v[84:87] offset:3072
  ds_write_b32 v222, v104 offset:4096
  s_branch main_kernel_att_snd1
main_kernel_att_snd0:
  ds_write_b128 v221, v[88:91] offset:0
  ds_write_b128 v221, v[92:95] offset:1024
  ds_write_b128 v221, v[96:99] offset:2048
  ds_write_b128 v221, v[100:103] offset:3072
  ds_write_b32 v222, v108 offset:4096
main_kernel_att_snd1:
  s_xor_b32 s52, s24, 4
  s_mul_i32 s52, s52, 4352
  s_add_u32 s52, s52, 98304
  v_lshlrev_b32 v221, 4, v2
  v_add_u32 v221, s52, v221
  v_lshlrev_b32 v222, 2, v2
  v_add_u32 v222, s52, v222
  v_mov_b32 v224, 138404
  s_waitcnt lgkmcnt(0)
  s_barrier
  ds_read_b32 v223, v224
  s_cmp_eq_u32 s27, 0
  s_cbranch_scc1 main_kernel_att_rcv0
  ds_read_b128 v[72:75], v221 offset:0
  ds_read_b128 v[76:79], v221 offset:1024
  ds_read_b128 v[80:83], v221 offset:2048
  ds_read_b128 v[84:87], v221 offset:3072
  ds_read_b32 v104, v222 offset:4096
  s_branch main_kernel_att_rcv1
main_kernel_att_rcv0:
  ds_read_b128 v[88:91], v221 offset:0
  ds_read_b128 v[92:95], v221 offset:1024
  ds_read_b128 v[96:99], v221 offset:2048
  ds_read_b128 v[100:103], v221 offset:3072
  ds_read_b32 v108, v222 offset:4096
main_kernel_att_rcv1:
  s_waitcnt lgkmcnt(5)
  v_readfirstlane_b32 s46, v223
  s_nop 0
  s_cmp_lg_u32 s46, 0
  s_cbranch_scc1 main_kernel_att_safe
  s_waitcnt lgkmcnt(0)
  v_add_f32 v104, v104, v108
  v_rcp_f32 v221, v104
  v_pk_add_f32 v[72:73], v[72:73], v[88:89]
  v_pk_add_f32 v[74:75], v[74:75], v[90:91]
  v_pk_add_f32 v[76:77], v[76:77], v[92:93]
  v_pk_add_f32 v[78:79], v[78:79], v[94:95]
  v_pk_add_f32 v[80:81], v[80:81], v[96:97]
  v_pk_add_f32 v[82:83], v[82:83], v[98:99]
  v_pk_add_f32 v[84:85], v[84:85], v[100:101]
  v_pk_add_f32 v[86:87], v[86:87], v[102:103]
  v_mov_b32 v222, v221
  v_pk_mul_f32 v[72:73], v[72:73], v[222:223] op_sel_hi:[1,0]
  v_pk_mul_f32 v[74:75], v[74:75], v[222:223] op_sel_hi:[1,0]
  v_pk_mul_f32 v[76:77], v[76:77], v[222:223] op_sel_hi:[1,0]
  v_pk_mul_f32 v[78:79], v[78:79], v[222:223] op_sel_hi:[1,0]
  v_pk_mul_f32 v[80:81], v[80:81], v[222:223] op_sel_hi:[1,0]
  v_pk_mul_f32 v[82:83], v[82:83], v[222:223] op_sel_hi:[1,0]
  v_pk_mul_f32 v[84:85], v[84:85], v[222:223] op_sel_hi:[1,0]
  v_pk_mul_f32 v[86:87], v[86:87], v[222:223] op_sel_hi:[1,0]
main_kernel_att_store:
  v_cvt_pk_bf16_f32 v180, v72, v73
  v_cvt_pk_bf16_f32 v181, v74, v75
  v_cvt_pk_bf16_f32 v182, v76, v77
  v_cvt_pk_bf16_f32 v183, v78, v79
  v_cvt_pk_bf16_f32 v184, v80, v81
  v_cvt_pk_bf16_f32 v185, v82, v83
  v_cvt_pk_bf16_f32 v186, v84, v85
  v_cvt_pk_bf16_f32 v187, v86, v87
  v_permlane32_swap_b32 v180, v182
  v_permlane32_swap_b32 v181, v183
  v_permlane32_swap_b32 v184, v186
  v_permlane32_swap_b32 v185, v187
  s_nop 0
  v_permlane16_swap_b32 v180, v184
  v_permlane16_swap_b32 v181, v185
  v_permlane16_swap_b32 v182, v186
  v_permlane16_swap_b32 v183, v187
  s_lshl_b32 s40, s27, 5
  s_add_u32 s40, s40, s39
  v_and_b32 v221, 15, v2
  v_add_u32 v221, s40, v221
  v_lshlrev_b32 v221, 11, v221
  v_lshrrev_b32 v222, 4, v2
  v_and_b32 v223, 1, v222
  v_lshlrev_b32 v223, 5, v223
  v_lshrrev_b32 v222, 1, v222
  v_lshlrev_b32 v222, 4, v222
  v_add_u32 v221, v221, v222
  v_add_u32 v221, v221, v223
  s_lshl_b32 s40, s25, 6
  s_add_u32 s41, s40, 32768
  buffer_store_dwordx4 v[180:183], v221, s[16:19], s40 offen sc1
  buffer_store_dwordx4 v[184:187], v221, s[16:19], s41 offen sc1
  s_add_u32 s35, s26, 16
  s_waitcnt vmcnt(0)
  v_mov_b32 v6, 138244
  v_mov_b32 v7, 1
  s_mov_b64 exec, 1
  ds_add_rtn_u32 v7, v6, v7
  s_waitcnt lgkmcnt(0)
  v_readfirstlane_b32 s32, v7
  s_mov_b64 exec, -1
  s_cmp_lg_u32 s32, 7
  s_cbranch_scc1 main_kernel_sigatt
  s_lshl_b32 s33, s26, 8
  s_lshl_b32 s34, s25, 2
  s_add_u32 s33, s33, s34
  s_add_u32 s33, s33, 140800
  v_lshlrev_b32 v6, 7, v2
  v_add_u32 v6, s33, v6
  v_mov_b32 v7, 1
  s_mov_b64 exec, 0x3
  buffer_store_dword v7, v6, s[28:31], 0 offen sc1
main_kernel_sigatt:
  s_mov_b64 exec, -1
  s_cmp_ge_u32 s24, 4
  s_cbranch_scc1 main_kernel_wo_l
  s_branch main_kernel_wo_c
main_kernel_att_safe:
  s_waitcnt vmcnt(0) lgkmcnt(0)
  s_barrier
  v_mov_b32 v72, 0
  v_mov_b32 v73, 0
  v_mov_b32 v74, 0
  v_mov_b32 v75, 0
  v_mov_b32 v76, 0
  v_mov_b32 v77, 0
  v_mov_b32 v78, 0
  v_mov_b32 v79, 0
  v_mov_b32 v80, 0
  v_mov_b32 v81, 0
  v_mov_b32 v82, 0
  v_mov_b32 v83, 0
  v_mov_b32 v84, 0
  v_mov_b32 v85, 0
  v_mov_b32 v86, 0
  v_mov_b32 v87, 0
  v_mov_b32 v88, 0
  v_mov_b32 v89, 0
  v_mov_b32 v90, 0
  v_mov_b32 v91, 0
  v_mov_b32 v92, 0
  v_mov_b32 v93, 0
  v_mov_b32 v94, 0
  v_mov_b32 v95, 0
  v_mov_b32 v96, 0
  v_mov_b32 v97, 0
  v_mov_b32 v98, 0
  v_mov_b32 v99, 0
  v_mov_b32 v100, 0
  v_mov_b32 v101, 0
  v_mov_b32 v102, 0
  v_mov_b32 v103, 0
  v_mov_b32 v104, 0
  v_mov_b32 v105, 0
  v_mov_b32 v106, 0
  v_mov_b32 v107, 0
  v_mov_b32 v108, 0
  v_mov_b32 v109, 0
  v_mov_b32 v110, 0
  v_mov_b32 v111, 0
  v_lshrrev_b32 v221, 4, v2
  v_lshrrev_b32 v222, 2, v2
  v_xor_b32 v221, v221, v222
  v_and_b32 v221, 1, v221
  v_cmp_eq_u32 vcc, 0, v221
  v_mov_b32 v222, 0x3f803f80
  s_nop 0
  v_cndmask_b32 v112, 0, v222, vcc
  v_mov_b32 v113, v112
  v_mov_b32 v114, v112
  v_mov_b32 v115, v112
  v_mov_b32 v40, 0xff61b1e6
  v_mov_b32 v41, 0xff61b1e6
  s_mul_i32 s40, s27, 16384
  v_lshrrev_b32 v221, 2, v220
  v_and_b32 v221, 3, v221
  v_xor_b32 v221, v221, v219
  v_lshlrev_b32 v221, 4, v221
  v_lshlrev_b32 v222, 6, v220
  v_add_u32 v224, v221, v222
  v_add_u32 v212, s40, v224
  v_xor_b32 v213, 32, v212
  v_and_b32 v221, 15, v2
  v_lshrrev_b32 v221, 2, v221
  v_lshlrev_b32 v222, 2, v219
  v_add_u32 v221, v221, v222
  v_lshlrev_b32 v221, 6, v221
  v_lshrrev_b32 v222, 4, v2
  v_and_b32 v222, 1, v222
  v_lshlrev_b32 v222, 5, v222
  v_add_u32 v221, v221, v222
  v_and_b32 v222, 3, v2
  v_lshlrev_b32 v222, 3, v222
  v_add_u32 v221, v221, v222
  v_add_u32 v221, 8192, v221
  v_add_u32 v214, s40, v221
  s_mov_b32 s42, 0
  s_mov_b32 s44, 8
main_kernel_att_sloop:
  s_barrier
  s_mov_b32 s53, 0
  s_add_u32 s43, s53, s41
  s_add_u32 s46, s42, s45
  s_mov_b32 m0, s43
  s_nop 0
  buffer_load_dwordx4 v217, s[8:11], s46 offen sc1 lds
  s_add_u32 m0, s43, 8192
  s_nop 0
  buffer_load_dwordx4 v218, s[12:15], s46 offen sc1 lds
  s_add_u32 s46, s46, 1024
  s_add_u32 m0, s43, 1024
  s_nop 0
  buffer_load_dwordx4 v217, s[8:11], s46 offen sc1 lds
  s_add_u32 m0, s43, 9216
  s_nop 0
  buffer_load_dwordx4 v218, s[12:15], s46 offen sc1 lds
  s_add_u32 s42, s42, 8192
  s_waitcnt vmcnt(0)
  s_barrier
  ds_read_b128 v[24:27], v212 offset:0
  ds_read_b128 v[28:31], v213 offset:0
  ds_read_b64_tr_b16 v[32:33], v214 offset:0
  ds_read_b64_tr_b16 v[34:35], v214 offset:512
  ds_read_b64_tr_b16 v[36:37], v214 offset:1024
  ds_read_b64_tr_b16 v[38:39], v214 offset:1536
  s_waitcnt lgkmcnt(0)
  v_mfma_f32_32x32x16_bf16 v[116:131], v[24:27], v[8:11], 0
  v_mfma_f32_32x32x16_bf16 v[116:131], v[28:31], v[12:15], v[116:131]
  s_nop 11
  v_max3_f32 v221, v116, v117, v118
  v_max3_f32 v221, v221, v119, v120
  v_max3_f32 v221, v221, v121, v122
  v_max3_f32 v221, v221, v123, v124
  v_max3_f32 v221, v221, v125, v126
  v_max3_f32 v221, v221, v127, v128
  v_max3_f32 v221, v221, v129, v130
  v_max_f32 v221, v221, v131
  v_mov_b32 v222, v221
  s_nop 1
  v_permlane32_swap_b32 v222, v221
  v_max_f32 v221, v221, v222
  v_max_f32 v221, v221, v40
  v_sub_f32 v42, v40, v221
  v_exp_f32 v42, v42
  v_mov_b32 v40, v221
  v_sub_f32 v116, v116, v221
  v_exp_f32 v116, v116
  v_sub_f32 v117, v117, v221
  v_exp_f32 v117, v117
  v_sub_f32 v118, v118, v221
  v_exp_f32 v118, v118
  v_sub_f32 v119, v119, v221
  v_exp_f32 v119, v119
  v_sub_f32 v120, v120, v221
  v_exp_f32 v120, v120
  v_sub_f32 v121, v121, v221
  v_exp_f32 v121, v121
  v_sub_f32 v122, v122, v221
  v_exp_f32 v122, v122
  v_sub_f32 v123, v123, v221
  v_exp_f32 v123, v123
  v_sub_f32 v124, v124, v221
  v_exp_f32 v124, v124
  v_sub_f32 v125, v125, v221
  v_exp_f32 v125, v125
  v_sub_f32 v126, v126, v221
  v_exp_f32 v126, v126
  v_sub_f32 v127, v127, v221
  v_exp_f32 v127, v127
  v_sub_f32 v128, v128, v221
  v_exp_f32 v128, v128
  v_sub_f32 v129, v129, v221
  v_exp_f32 v129, v129
  v_sub_f32 v130, v130, v221
  v_exp_f32 v130, v130
  v_sub_f32 v131, v131, v221
  v_exp_f32 v131, v131
  v_mul_f32 v72, v72, v42
  v_mul_f32 v73, v73, v42
  v_mul_f32 v74, v74, v42
  v_mul_f32 v75, v75, v42
  v_mul_f32 v76, v76, v42
  v_mul_f32 v77, v77, v42
  v_mul_f32 v78, v78, v42
  v_mul_f32 v79, v79, v42
  v_mul_f32 v80, v80, v42
  v_mul_f32 v81, v81, v42
  v_mul_f32 v82, v82, v42
  v_mul_f32 v83, v83, v42
  v_mul_f32 v84, v84, v42
  v_mul_f32 v85, v85, v42
  v_mul_f32 v86, v86, v42
  v_mul_f32 v87, v87, v42
  v_mul_f32 v104, v104, v42
  v_mul_f32 v105, v105, v42
  v_mul_f32 v106, v106, v42
  v_mul_f32 v107, v107, v42
  v_cvt_pk_bf16_f32 v180, v116, v117
  v_cvt_pk_bf16_f32 v181, v118, v119
  v_cvt_pk_bf16_f32 v182, v120, v121
  v_cvt_pk_bf16_f32 v183, v122, v123
  v_cvt_pk_bf16_f32 v184, v124, v125
  v_cvt_pk_bf16_f32 v185, v126, v127
  v_cvt_pk_bf16_f32 v186, v128, v129
  v_cvt_pk_bf16_f32 v187, v130, v131
  v_mfma_f32_32x32x16_bf16 v[72:87], v[32:35], v[180:183], v[72:87]
  v_mfma_f32_16x16x32_bf16 v[104:107], v[112:115], v[180:183], v[104:107]
  v_mfma_f32_32x32x16_bf16 v[72:87], v[36:39], v[184:187], v[72:87]
  v_mfma_f32_16x16x32_bf16 v[104:107], v[112:115], v[184:187], v[104:107]
  v_mfma_f32_32x32x16_bf16 v[116:131], v[24:27], v[16:19], 0
  v_mfma_f32_32x32x16_bf16 v[116:131], v[28:31], v[20:23], v[116:131]
  s_nop 11
  v_max3_f32 v221, v116, v117, v118
  v_max3_f32 v221, v221, v119, v120
  v_max3_f32 v221, v221, v121, v122
  v_max3_f32 v221, v221, v123, v124
  v_max3_f32 v221, v221, v125, v126
  v_max3_f32 v221, v221, v127, v128
  v_max3_f32 v221, v221, v129, v130
  v_max_f32 v221, v221, v131
  v_mov_b32 v222, v221
  s_nop 1
  v_permlane32_swap_b32 v222, v221
  v_max_f32 v221, v221, v222
  v_max_f32 v221, v221, v41
  v_sub_f32 v42, v41, v221
  v_exp_f32 v42, v42
  v_mov_b32 v41, v221
  v_sub_f32 v116, v116, v221
  v_exp_f32 v116, v116
  v_sub_f32 v117, v117, v221
  v_exp_f32 v117, v117
  v_sub_f32 v118, v118, v221
  v_exp_f32 v118, v118
  v_sub_f32 v119, v119, v221
  v_exp_f32 v119, v119
  v_sub_f32 v120, v120, v221
  v_exp_f32 v120, v120
  v_sub_f32 v121, v121, v221
  v_exp_f32 v121, v121
  v_sub_f32 v122, v122, v221
  v_exp_f32 v122, v122
  v_sub_f32 v123, v123, v221
  v_exp_f32 v123, v123
  v_sub_f32 v124, v124, v221
  v_exp_f32 v124, v124
  v_sub_f32 v125, v125, v221
  v_exp_f32 v125, v125
  v_sub_f32 v126, v126, v221
  v_exp_f32 v126, v126
  v_sub_f32 v127, v127, v221
  v_exp_f32 v127, v127
  v_sub_f32 v128, v128, v221
  v_exp_f32 v128, v128
  v_sub_f32 v129, v129, v221
  v_exp_f32 v129, v129
  v_sub_f32 v130, v130, v221
  v_exp_f32 v130, v130
  v_sub_f32 v131, v131, v221
  v_exp_f32 v131, v131
  v_mul_f32 v88, v88, v42
  v_mul_f32 v89, v89, v42
  v_mul_f32 v90, v90, v42
  v_mul_f32 v91, v91, v42
  v_mul_f32 v92, v92, v42
  v_mul_f32 v93, v93, v42
  v_mul_f32 v94, v94, v42
  v_mul_f32 v95, v95, v42
  v_mul_f32 v96, v96, v42
  v_mul_f32 v97, v97, v42
  v_mul_f32 v98, v98, v42
  v_mul_f32 v99, v99, v42
  v_mul_f32 v100, v100, v42
  v_mul_f32 v101, v101, v42
  v_mul_f32 v102, v102, v42
  v_mul_f32 v103, v103, v42
  v_mul_f32 v108, v108, v42
  v_mul_f32 v109, v109, v42
  v_mul_f32 v110, v110, v42
  v_mul_f32 v111, v111, v42
  v_cvt_pk_bf16_f32 v180, v116, v117
  v_cvt_pk_bf16_f32 v181, v118, v119
  v_cvt_pk_bf16_f32 v182, v120, v121
  v_cvt_pk_bf16_f32 v183, v122, v123
  v_cvt_pk_bf16_f32 v184, v124, v125
  v_cvt_pk_bf16_f32 v185, v126, v127
  v_cvt_pk_bf16_f32 v186, v128, v129
  v_cvt_pk_bf16_f32 v187, v130, v131
  v_mfma_f32_32x32x16_bf16 v[88:103], v[32:35], v[180:183], v[88:103]
  v_mfma_f32_16x16x32_bf16 v[108:111], v[112:115], v[180:183], v[108:111]
  v_mfma_f32_32x32x16_bf16 v[88:103], v[36:39], v[184:187], v[88:103]
  v_mfma_f32_16x16x32_bf16 v[108:111], v[112:115], v[184:187], v[108:111]
  ds_read_b128 v[24:27], v212 offset:2048
  ds_read_b128 v[28:31], v213 offset:2048
  ds_read_b64_tr_b16 v[32:33], v214 offset:2048
  ds_read_b64_tr_b16 v[34:35], v214 offset:2560
  ds_read_b64_tr_b16 v[36:37], v214 offset:3072
  ds_read_b64_tr_b16 v[38:39], v214 offset:3584
  s_waitcnt lgkmcnt(0)
  v_mfma_f32_32x32x16_bf16 v[116:131], v[24:27], v[8:11], 0
  v_mfma_f32_32x32x16_bf16 v[116:131], v[28:31], v[12:15], v[116:131]
  s_nop 11
  v_max3_f32 v221, v116, v117, v118
  v_max3_f32 v221, v221, v119, v120
  v_max3_f32 v221, v221, v121, v122
  v_max3_f32 v221, v221, v123, v124
  v_max3_f32 v221, v221, v125, v126
  v_max3_f32 v221, v221, v127, v128
  v_max3_f32 v221, v221, v129, v130
  v_max_f32 v221, v221, v131
  v_mov_b32 v222, v221
  s_nop 1
  v_permlane32_swap_b32 v222, v221
  v_max_f32 v221, v221, v222
  v_max_f32 v221, v221, v40
  v_sub_f32 v42, v40, v221
  v_exp_f32 v42, v42
  v_mov_b32 v40, v221
  v_sub_f32 v116, v116, v221
  v_exp_f32 v116, v116
  v_sub_f32 v117, v117, v221
  v_exp_f32 v117, v117
  v_sub_f32 v118, v118, v221
  v_exp_f32 v118, v118
  v_sub_f32 v119, v119, v221
  v_exp_f32 v119, v119
  v_sub_f32 v120, v120, v221
  v_exp_f32 v120, v120
  v_sub_f32 v121, v121, v221
  v_exp_f32 v121, v121
  v_sub_f32 v122, v122, v221
  v_exp_f32 v122, v122
  v_sub_f32 v123, v123, v221
  v_exp_f32 v123, v123
  v_sub_f32 v124, v124, v221
  v_exp_f32 v124, v124
  v_sub_f32 v125, v125, v221
  v_exp_f32 v125, v125
  v_sub_f32 v126, v126, v221
  v_exp_f32 v126, v126
  v_sub_f32 v127, v127, v221
  v_exp_f32 v127, v127
  v_sub_f32 v128, v128, v221
  v_exp_f32 v128, v128
  v_sub_f32 v129, v129, v221
  v_exp_f32 v129, v129
  v_sub_f32 v130, v130, v221
  v_exp_f32 v130, v130
  v_sub_f32 v131, v131, v221
  v_exp_f32 v131, v131
  v_mul_f32 v72, v72, v42
  v_mul_f32 v73, v73, v42
  v_mul_f32 v74, v74, v42
  v_mul_f32 v75, v75, v42
  v_mul_f32 v76, v76, v42
  v_mul_f32 v77, v77, v42
  v_mul_f32 v78, v78, v42
  v_mul_f32 v79, v79, v42
  v_mul_f32 v80, v80, v42
  v_mul_f32 v81, v81, v42
  v_mul_f32 v82, v82, v42
  v_mul_f32 v83, v83, v42
  v_mul_f32 v84, v84, v42
  v_mul_f32 v85, v85, v42
  v_mul_f32 v86, v86, v42
  v_mul_f32 v87, v87, v42
  v_mul_f32 v104, v104, v42
  v_mul_f32 v105, v105, v42
  v_mul_f32 v106, v106, v42
  v_mul_f32 v107, v107, v42
  v_cvt_pk_bf16_f32 v180, v116, v117
  v_cvt_pk_bf16_f32 v181, v118, v119
  v_cvt_pk_bf16_f32 v182, v120, v121
  v_cvt_pk_bf16_f32 v183, v122, v123
  v_cvt_pk_bf16_f32 v184, v124, v125
  v_cvt_pk_bf16_f32 v185, v126, v127
  v_cvt_pk_bf16_f32 v186, v128, v129
  v_cvt_pk_bf16_f32 v187, v130, v131
  v_mfma_f32_32x32x16_bf16 v[72:87], v[32:35], v[180:183], v[72:87]
  v_mfma_f32_16x16x32_bf16 v[104:107], v[112:115], v[180:183], v[104:107]
  v_mfma_f32_32x32x16_bf16 v[72:87], v[36:39], v[184:187], v[72:87]
  v_mfma_f32_16x16x32_bf16 v[104:107], v[112:115], v[184:187], v[104:107]
  v_mfma_f32_32x32x16_bf16 v[116:131], v[24:27], v[16:19], 0
  v_mfma_f32_32x32x16_bf16 v[116:131], v[28:31], v[20:23], v[116:131]
  s_nop 11
  v_max3_f32 v221, v116, v117, v118
  v_max3_f32 v221, v221, v119, v120
  v_max3_f32 v221, v221, v121, v122
  v_max3_f32 v221, v221, v123, v124
  v_max3_f32 v221, v221, v125, v126
  v_max3_f32 v221, v221, v127, v128
  v_max3_f32 v221, v221, v129, v130
  v_max_f32 v221, v221, v131
  v_mov_b32 v222, v221
  s_nop 1
  v_permlane32_swap_b32 v222, v221
  v_max_f32 v221, v221, v222
  v_max_f32 v221, v221, v41
  v_sub_f32 v42, v41, v221
  v_exp_f32 v42, v42
  v_mov_b32 v41, v221
  v_sub_f32 v116, v116, v221
  v_exp_f32 v116, v116
  v_sub_f32 v117, v117, v221
  v_exp_f32 v117, v117
  v_sub_f32 v118, v118, v221
  v_exp_f32 v118, v118
  v_sub_f32 v119, v119, v221
  v_exp_f32 v119, v119
  v_sub_f32 v120, v120, v221
  v_exp_f32 v120, v120
  v_sub_f32 v121, v121, v221
  v_exp_f32 v121, v121
  v_sub_f32 v122, v122, v221
  v_exp_f32 v122, v122
  v_sub_f32 v123, v123, v221
  v_exp_f32 v123, v123
  v_sub_f32 v124, v124, v221
  v_exp_f32 v124, v124
  v_sub_f32 v125, v125, v221
  v_exp_f32 v125, v125
  v_sub_f32 v126, v126, v221
  v_exp_f32 v126, v126
  v_sub_f32 v127, v127, v221
  v_exp_f32 v127, v127
  v_sub_f32 v128, v128, v221
  v_exp_f32 v128, v128
  v_sub_f32 v129, v129, v221
  v_exp_f32 v129, v129
  v_sub_f32 v130, v130, v221
  v_exp_f32 v130, v130
  v_sub_f32 v131, v131, v221
  v_exp_f32 v131, v131
  v_mul_f32 v88, v88, v42
  v_mul_f32 v89, v89, v42
  v_mul_f32 v90, v90, v42
  v_mul_f32 v91, v91, v42
  v_mul_f32 v92, v92, v42
  v_mul_f32 v93, v93, v42
  v_mul_f32 v94, v94, v42
  v_mul_f32 v95, v95, v42
  v_mul_f32 v96, v96, v42
  v_mul_f32 v97, v97, v42
  v_mul_f32 v98, v98, v42
  v_mul_f32 v99, v99, v42
  v_mul_f32 v100, v100, v42
  v_mul_f32 v101, v101, v42
  v_mul_f32 v102, v102, v42
  v_mul_f32 v103, v103, v42
  v_mul_f32 v108, v108, v42
  v_mul_f32 v109, v109, v42
  v_mul_f32 v110, v110, v42
  v_mul_f32 v111, v111, v42
  v_cvt_pk_bf16_f32 v180, v116, v117
  v_cvt_pk_bf16_f32 v181, v118, v119
  v_cvt_pk_bf16_f32 v182, v120, v121
  v_cvt_pk_bf16_f32 v183, v122, v123
  v_cvt_pk_bf16_f32 v184, v124, v125
  v_cvt_pk_bf16_f32 v185, v126, v127
  v_cvt_pk_bf16_f32 v186, v128, v129
  v_cvt_pk_bf16_f32 v187, v130, v131
  v_mfma_f32_32x32x16_bf16 v[88:103], v[32:35], v[180:183], v[88:103]
  v_mfma_f32_16x16x32_bf16 v[108:111], v[112:115], v[180:183], v[108:111]
  v_mfma_f32_32x32x16_bf16 v[88:103], v[36:39], v[184:187], v[88:103]
  v_mfma_f32_16x16x32_bf16 v[108:111], v[112:115], v[184:187], v[108:111]
  ds_read_b128 v[24:27], v212 offset:4096
  ds_read_b128 v[28:31], v213 offset:4096
  ds_read_b64_tr_b16 v[32:33], v214 offset:4096
  ds_read_b64_tr_b16 v[34:35], v214 offset:4608
  ds_read_b64_tr_b16 v[36:37], v214 offset:5120
  ds_read_b64_tr_b16 v[38:39], v214 offset:5632
  s_waitcnt lgkmcnt(0)
  v_mfma_f32_32x32x16_bf16 v[116:131], v[24:27], v[8:11], 0
  v_mfma_f32_32x32x16_bf16 v[116:131], v[28:31], v[12:15], v[116:131]
  s_nop 11
  v_max3_f32 v221, v116, v117, v118
  v_max3_f32 v221, v221, v119, v120
  v_max3_f32 v221, v221, v121, v122
  v_max3_f32 v221, v221, v123, v124
  v_max3_f32 v221, v221, v125, v126
  v_max3_f32 v221, v221, v127, v128
  v_max3_f32 v221, v221, v129, v130
  v_max_f32 v221, v221, v131
  v_mov_b32 v222, v221
  s_nop 1
  v_permlane32_swap_b32 v222, v221
  v_max_f32 v221, v221, v222
  v_max_f32 v221, v221, v40
  v_sub_f32 v42, v40, v221
  v_exp_f32 v42, v42
  v_mov_b32 v40, v221
  v_sub_f32 v116, v116, v221
  v_exp_f32 v116, v116
  v_sub_f32 v117, v117, v221
  v_exp_f32 v117, v117
  v_sub_f32 v118, v118, v221
  v_exp_f32 v118, v118
  v_sub_f32 v119, v119, v221
  v_exp_f32 v119, v119
  v_sub_f32 v120, v120, v221
  v_exp_f32 v120, v120
  v_sub_f32 v121, v121, v221
  v_exp_f32 v121, v121
  v_sub_f32 v122, v122, v221
  v_exp_f32 v122, v122
  v_sub_f32 v123, v123, v221
  v_exp_f32 v123, v123
  v_sub_f32 v124, v124, v221
  v_exp_f32 v124, v124
  v_sub_f32 v125, v125, v221
  v_exp_f32 v125, v125
  v_sub_f32 v126, v126, v221
  v_exp_f32 v126, v126
  v_sub_f32 v127, v127, v221
  v_exp_f32 v127, v127
  v_sub_f32 v128, v128, v221
  v_exp_f32 v128, v128
  v_sub_f32 v129, v129, v221
  v_exp_f32 v129, v129
  v_sub_f32 v130, v130, v221
  v_exp_f32 v130, v130
  v_sub_f32 v131, v131, v221
  v_exp_f32 v131, v131
  v_mul_f32 v72, v72, v42
  v_mul_f32 v73, v73, v42
  v_mul_f32 v74, v74, v42
  v_mul_f32 v75, v75, v42
  v_mul_f32 v76, v76, v42
  v_mul_f32 v77, v77, v42
  v_mul_f32 v78, v78, v42
  v_mul_f32 v79, v79, v42
  v_mul_f32 v80, v80, v42
  v_mul_f32 v81, v81, v42
  v_mul_f32 v82, v82, v42
  v_mul_f32 v83, v83, v42
  v_mul_f32 v84, v84, v42
  v_mul_f32 v85, v85, v42
  v_mul_f32 v86, v86, v42
  v_mul_f32 v87, v87, v42
  v_mul_f32 v104, v104, v42
  v_mul_f32 v105, v105, v42
  v_mul_f32 v106, v106, v42
  v_mul_f32 v107, v107, v42
  v_cvt_pk_bf16_f32 v180, v116, v117
  v_cvt_pk_bf16_f32 v181, v118, v119
  v_cvt_pk_bf16_f32 v182, v120, v121
  v_cvt_pk_bf16_f32 v183, v122, v123
  v_cvt_pk_bf16_f32 v184, v124, v125
  v_cvt_pk_bf16_f32 v185, v126, v127
  v_cvt_pk_bf16_f32 v186, v128, v129
  v_cvt_pk_bf16_f32 v187, v130, v131
  v_mfma_f32_32x32x16_bf16 v[72:87], v[32:35], v[180:183], v[72:87]
  v_mfma_f32_16x16x32_bf16 v[104:107], v[112:115], v[180:183], v[104:107]
  v_mfma_f32_32x32x16_bf16 v[72:87], v[36:39], v[184:187], v[72:87]
  v_mfma_f32_16x16x32_bf16 v[104:107], v[112:115], v[184:187], v[104:107]
  v_mfma_f32_32x32x16_bf16 v[116:131], v[24:27], v[16:19], 0
  v_mfma_f32_32x32x16_bf16 v[116:131], v[28:31], v[20:23], v[116:131]
  s_nop 11
  v_max3_f32 v221, v116, v117, v118
  v_max3_f32 v221, v221, v119, v120
  v_max3_f32 v221, v221, v121, v122
  v_max3_f32 v221, v221, v123, v124
  v_max3_f32 v221, v221, v125, v126
  v_max3_f32 v221, v221, v127, v128
  v_max3_f32 v221, v221, v129, v130
  v_max_f32 v221, v221, v131
  v_mov_b32 v222, v221
  s_nop 1
  v_permlane32_swap_b32 v222, v221
  v_max_f32 v221, v221, v222
  v_max_f32 v221, v221, v41
  v_sub_f32 v42, v41, v221
  v_exp_f32 v42, v42
  v_mov_b32 v41, v221
  v_sub_f32 v116, v116, v221
  v_exp_f32 v116, v116
  v_sub_f32 v117, v117, v221
  v_exp_f32 v117, v117
  v_sub_f32 v118, v118, v221
  v_exp_f32 v118, v118
  v_sub_f32 v119, v119, v221
  v_exp_f32 v119, v119
  v_sub_f32 v120, v120, v221
  v_exp_f32 v120, v120
  v_sub_f32 v121, v121, v221
  v_exp_f32 v121, v121
  v_sub_f32 v122, v122, v221
  v_exp_f32 v122, v122
  v_sub_f32 v123, v123, v221
  v_exp_f32 v123, v123
  v_sub_f32 v124, v124, v221
  v_exp_f32 v124, v124
  v_sub_f32 v125, v125, v221
  v_exp_f32 v125, v125
  v_sub_f32 v126, v126, v221
  v_exp_f32 v126, v126
  v_sub_f32 v127, v127, v221
  v_exp_f32 v127, v127
  v_sub_f32 v128, v128, v221
  v_exp_f32 v128, v128
  v_sub_f32 v129, v129, v221
  v_exp_f32 v129, v129
  v_sub_f32 v130, v130, v221
  v_exp_f32 v130, v130
  v_sub_f32 v131, v131, v221
  v_exp_f32 v131, v131
  v_mul_f32 v88, v88, v42
  v_mul_f32 v89, v89, v42
  v_mul_f32 v90, v90, v42
  v_mul_f32 v91, v91, v42
  v_mul_f32 v92, v92, v42
  v_mul_f32 v93, v93, v42
  v_mul_f32 v94, v94, v42
  v_mul_f32 v95, v95, v42
  v_mul_f32 v96, v96, v42
  v_mul_f32 v97, v97, v42
  v_mul_f32 v98, v98, v42
  v_mul_f32 v99, v99, v42
  v_mul_f32 v100, v100, v42
  v_mul_f32 v101, v101, v42
  v_mul_f32 v102, v102, v42
  v_mul_f32 v103, v103, v42
  v_mul_f32 v108, v108, v42
  v_mul_f32 v109, v109, v42
  v_mul_f32 v110, v110, v42
  v_mul_f32 v111, v111, v42
  v_cvt_pk_bf16_f32 v180, v116, v117
  v_cvt_pk_bf16_f32 v181, v118, v119
  v_cvt_pk_bf16_f32 v182, v120, v121
  v_cvt_pk_bf16_f32 v183, v122, v123
  v_cvt_pk_bf16_f32 v184, v124, v125
  v_cvt_pk_bf16_f32 v185, v126, v127
  v_cvt_pk_bf16_f32 v186, v128, v129
  v_cvt_pk_bf16_f32 v187, v130, v131
  v_mfma_f32_32x32x16_bf16 v[88:103], v[32:35], v[180:183], v[88:103]
  v_mfma_f32_16x16x32_bf16 v[108:111], v[112:115], v[180:183], v[108:111]
  v_mfma_f32_32x32x16_bf16 v[88:103], v[36:39], v[184:187], v[88:103]
  v_mfma_f32_16x16x32_bf16 v[108:111], v[112:115], v[184:187], v[108:111]
  ds_read_b128 v[24:27], v212 offset:6144
  ds_read_b128 v[28:31], v213 offset:6144
  ds_read_b64_tr_b16 v[32:33], v214 offset:6144
  ds_read_b64_tr_b16 v[34:35], v214 offset:6656
  ds_read_b64_tr_b16 v[36:37], v214 offset:7168
  ds_read_b64_tr_b16 v[38:39], v214 offset:7680
  s_waitcnt lgkmcnt(0)
  v_mfma_f32_32x32x16_bf16 v[116:131], v[24:27], v[8:11], 0
  v_mfma_f32_32x32x16_bf16 v[116:131], v[28:31], v[12:15], v[116:131]
  s_nop 11
  v_max3_f32 v221, v116, v117, v118
  v_max3_f32 v221, v221, v119, v120
  v_max3_f32 v221, v221, v121, v122
  v_max3_f32 v221, v221, v123, v124
  v_max3_f32 v221, v221, v125, v126
  v_max3_f32 v221, v221, v127, v128
  v_max3_f32 v221, v221, v129, v130
  v_max_f32 v221, v221, v131
  v_mov_b32 v222, v221
  s_nop 1
  v_permlane32_swap_b32 v222, v221
  v_max_f32 v221, v221, v222
  v_max_f32 v221, v221, v40
  v_sub_f32 v42, v40, v221
  v_exp_f32 v42, v42
  v_mov_b32 v40, v221
  v_sub_f32 v116, v116, v221
  v_exp_f32 v116, v116
  v_sub_f32 v117, v117, v221
  v_exp_f32 v117, v117
  v_sub_f32 v118, v118, v221
  v_exp_f32 v118, v118
  v_sub_f32 v119, v119, v221
  v_exp_f32 v119, v119
  v_sub_f32 v120, v120, v221
  v_exp_f32 v120, v120
  v_sub_f32 v121, v121, v221
  v_exp_f32 v121, v121
  v_sub_f32 v122, v122, v221
  v_exp_f32 v122, v122
  v_sub_f32 v123, v123, v221
  v_exp_f32 v123, v123
  v_sub_f32 v124, v124, v221
  v_exp_f32 v124, v124
  v_sub_f32 v125, v125, v221
  v_exp_f32 v125, v125
  v_sub_f32 v126, v126, v221
  v_exp_f32 v126, v126
  v_sub_f32 v127, v127, v221
  v_exp_f32 v127, v127
  v_sub_f32 v128, v128, v221
  v_exp_f32 v128, v128
  v_sub_f32 v129, v129, v221
  v_exp_f32 v129, v129
  v_sub_f32 v130, v130, v221
  v_exp_f32 v130, v130
  v_sub_f32 v131, v131, v221
  v_exp_f32 v131, v131
  v_mul_f32 v72, v72, v42
  v_mul_f32 v73, v73, v42
  v_mul_f32 v74, v74, v42
  v_mul_f32 v75, v75, v42
  v_mul_f32 v76, v76, v42
  v_mul_f32 v77, v77, v42
  v_mul_f32 v78, v78, v42
  v_mul_f32 v79, v79, v42
  v_mul_f32 v80, v80, v42
  v_mul_f32 v81, v81, v42
  v_mul_f32 v82, v82, v42
  v_mul_f32 v83, v83, v42
  v_mul_f32 v84, v84, v42
  v_mul_f32 v85, v85, v42
  v_mul_f32 v86, v86, v42
  v_mul_f32 v87, v87, v42
  v_mul_f32 v104, v104, v42
  v_mul_f32 v105, v105, v42
  v_mul_f32 v106, v106, v42
  v_mul_f32 v107, v107, v42
  v_cvt_pk_bf16_f32 v180, v116, v117
  v_cvt_pk_bf16_f32 v181, v118, v119
  v_cvt_pk_bf16_f32 v182, v120, v121
  v_cvt_pk_bf16_f32 v183, v122, v123
  v_cvt_pk_bf16_f32 v184, v124, v125
  v_cvt_pk_bf16_f32 v185, v126, v127
  v_cvt_pk_bf16_f32 v186, v128, v129
  v_cvt_pk_bf16_f32 v187, v130, v131
  v_mfma_f32_32x32x16_bf16 v[72:87], v[32:35], v[180:183], v[72:87]
  v_mfma_f32_16x16x32_bf16 v[104:107], v[112:115], v[180:183], v[104:107]
  v_mfma_f32_32x32x16_bf16 v[72:87], v[36:39], v[184:187], v[72:87]
  v_mfma_f32_16x16x32_bf16 v[104:107], v[112:115], v[184:187], v[104:107]
  v_mfma_f32_32x32x16_bf16 v[116:131], v[24:27], v[16:19], 0
  v_mfma_f32_32x32x16_bf16 v[116:131], v[28:31], v[20:23], v[116:131]
  s_nop 11
  v_max3_f32 v221, v116, v117, v118
  v_max3_f32 v221, v221, v119, v120
  v_max3_f32 v221, v221, v121, v122
  v_max3_f32 v221, v221, v123, v124
  v_max3_f32 v221, v221, v125, v126
  v_max3_f32 v221, v221, v127, v128
  v_max3_f32 v221, v221, v129, v130
  v_max_f32 v221, v221, v131
  v_mov_b32 v222, v221
  s_nop 1
  v_permlane32_swap_b32 v222, v221
  v_max_f32 v221, v221, v222
  v_max_f32 v221, v221, v41
  v_sub_f32 v42, v41, v221
  v_exp_f32 v42, v42
  v_mov_b32 v41, v221
  v_sub_f32 v116, v116, v221
  v_exp_f32 v116, v116
  v_sub_f32 v117, v117, v221
  v_exp_f32 v117, v117
  v_sub_f32 v118, v118, v221
  v_exp_f32 v118, v118
  v_sub_f32 v119, v119, v221
  v_exp_f32 v119, v119
  v_sub_f32 v120, v120, v221
  v_exp_f32 v120, v120
  v_sub_f32 v121, v121, v221
  v_exp_f32 v121, v121
  v_sub_f32 v122, v122, v221
  v_exp_f32 v122, v122
  v_sub_f32 v123, v123, v221
  v_exp_f32 v123, v123
  v_sub_f32 v124, v124, v221
  v_exp_f32 v124, v124
  v_sub_f32 v125, v125, v221
  v_exp_f32 v125, v125
  v_sub_f32 v126, v126, v221
  v_exp_f32 v126, v126
  v_sub_f32 v127, v127, v221
  v_exp_f32 v127, v127
  v_sub_f32 v128, v128, v221
  v_exp_f32 v128, v128
  v_sub_f32 v129, v129, v221
  v_exp_f32 v129, v129
  v_sub_f32 v130, v130, v221
  v_exp_f32 v130, v130
  v_sub_f32 v131, v131, v221
  v_exp_f32 v131, v131
  v_mul_f32 v88, v88, v42
  v_mul_f32 v89, v89, v42
  v_mul_f32 v90, v90, v42
  v_mul_f32 v91, v91, v42
  v_mul_f32 v92, v92, v42
  v_mul_f32 v93, v93, v42
  v_mul_f32 v94, v94, v42
  v_mul_f32 v95, v95, v42
  v_mul_f32 v96, v96, v42
  v_mul_f32 v97, v97, v42
  v_mul_f32 v98, v98, v42
  v_mul_f32 v99, v99, v42
  v_mul_f32 v100, v100, v42
  v_mul_f32 v101, v101, v42
  v_mul_f32 v102, v102, v42
  v_mul_f32 v103, v103, v42
  v_mul_f32 v108, v108, v42
  v_mul_f32 v109, v109, v42
  v_mul_f32 v110, v110, v42
  v_mul_f32 v111, v111, v42
  v_cvt_pk_bf16_f32 v180, v116, v117
  v_cvt_pk_bf16_f32 v181, v118, v119
  v_cvt_pk_bf16_f32 v182, v120, v121
  v_cvt_pk_bf16_f32 v183, v122, v123
  v_cvt_pk_bf16_f32 v184, v124, v125
  v_cvt_pk_bf16_f32 v185, v126, v127
  v_cvt_pk_bf16_f32 v186, v128, v129
  v_cvt_pk_bf16_f32 v187, v130, v131
  v_mfma_f32_32x32x16_bf16 v[88:103], v[32:35], v[180:183], v[88:103]
  v_mfma_f32_16x16x32_bf16 v[108:111], v[112:115], v[180:183], v[108:111]
  v_mfma_f32_32x32x16_bf16 v[88:103], v[36:39], v[184:187], v[88:103]
  v_mfma_f32_16x16x32_bf16 v[108:111], v[112:115], v[184:187], v[108:111]
  s_sub_u32 s44, s44, 1
  s_cmp_lg_u32 s44, 0
  s_cbranch_scc1 main_kernel_att_sloop
  s_barrier
  s_cmp_eq_u32 s27, 0
  s_cbranch_scc1 main_kernel_att_keep0s
  s_nop 4
  v_swap_b32 v72, v88
  v_swap_b32 v73, v89
  v_swap_b32 v74, v90
  v_swap_b32 v75, v91
  v_swap_b32 v76, v92
  v_swap_b32 v77, v93
  v_swap_b32 v78, v94
  v_swap_b32 v79, v95
  v_swap_b32 v80, v96
  v_swap_b32 v81, v97
  v_swap_b32 v82, v98
  v_swap_b32 v83, v99
  v_swap_b32 v84, v100
  v_swap_b32 v85, v101
  v_swap_b32 v86, v102
  v_swap_b32 v87, v103
  v_swap_b32 v104, v108
  v_swap_b32 v40, v41
main_kernel_att_keep0s:
  s_mul_i32 s52, s24, 5376
  v_lshlrev_b32 v221, 4, v2
  v_add_u32 v221, s52, v221
  s_nop 1
  ds_write_b128 v221, v[88:91] offset:0
  ds_write_b128 v221, v[92:95] offset:1024
  ds_write_b128 v221, v[96:99] offset:2048
  ds_write_b128 v221, v[100:103] offset:3072
  v_lshlrev_b32 v222, 2, v2
  v_add_u32 v222, s52, v222
  ds_write_b32 v222, v108 offset:4096
  ds_write_b32 v222, v41 offset:4352
  s_waitcnt lgkmcnt(0)
  s_barrier
  s_xor_b32 s52, s24, 4
  s_mul_i32 s52, s52, 5376
  v_lshlrev_b32 v221, 4, v2
  v_add_u32 v221, s52, v221
  ds_read_b128 v[88:91], v221 offset:0
  ds_read_b128 v[92:95], v221 offset:1024
  ds_read_b128 v[96:99], v221 offset:2048
  ds_read_b128 v[100:103], v221 offset:3072
  v_lshlrev_b32 v222, 2, v2
  v_add_u32 v222, s52, v222
  ds_read_b32 v108, v222 offset:4096
  ds_read_b32 v41, v222 offset:4352
  s_waitcnt lgkmcnt(0)
  v_max_f32 v221, v40, v41
  v_sub_f32 v222, v40, v221
  v_sub_f32 v223, v41, v221
  v_exp_f32 v222, v222
  v_exp_f32 v223, v223
  v_mul_f32 v72, v72, v222
  v_fmac_f32 v72, v88, v223
  v_mul_f32 v73, v73, v222
  v_fmac_f32 v73, v89, v223
  v_mul_f32 v74, v74, v222
  v_fmac_f32 v74, v90, v223
  v_mul_f32 v75, v75, v222
  v_fmac_f32 v75, v91, v223
  v_mul_f32 v76, v76, v222
  v_fmac_f32 v76, v92, v223
  v_mul_f32 v77, v77, v222
  v_fmac_f32 v77, v93, v223
  v_mul_f32 v78, v78, v222
  v_fmac_f32 v78, v94, v223
  v_mul_f32 v79, v79, v222
  v_fmac_f32 v79, v95, v223
  v_mul_f32 v80, v80, v222
  v_fmac_f32 v80, v96, v223
  v_mul_f32 v81, v81, v222
  v_fmac_f32 v81, v97, v223
  v_mul_f32 v82, v82, v222
  v_fmac_f32 v82, v98, v223
  v_mul_f32 v83, v83, v222
  v_fmac_f32 v83, v99, v223
  v_mul_f32 v84, v84, v222
  v_fmac_f32 v84, v100, v223
  v_mul_f32 v85, v85, v222
  v_fmac_f32 v85, v101, v223
  v_mul_f32 v86, v86, v222
  v_fmac_f32 v86, v102, v223
  v_mul_f32 v87, v87, v222
  v_fmac_f32 v87, v103, v223
  v_mul_f32 v104, v104, v222
  v_fmac_f32 v104, v108, v223
  v_rcp_f32 v221, v104
  s_nop 0
  v_mul_f32 v72, v72, v221
  v_mul_f32 v73, v73, v221
  v_mul_f32 v74, v74, v221
  v_mul_f32 v75, v75, v221
  v_mul_f32 v76, v76, v221
  v_mul_f32 v77, v77, v221
  v_mul_f32 v78, v78, v221
  v_mul_f32 v79, v79, v221
  v_mul_f32 v80, v80, v221
  v_mul_f32 v81, v81, v221
  v_mul_f32 v82, v82, v221
  v_mul_f32 v83, v83, v221
  v_mul_f32 v84, v84, v221
  v_mul_f32 v85, v85, v221
  v_mul_f32 v86, v86, v221
  v_mul_f32 v87, v87, v221
  s_barrier
  s_branch main_kernel_att_store
main_kernel_wo_c:
  s_and_b32 s36, s2, 7
  s_lshr_b32 s37, s2, 3
  s_and_b32 s38, s36, 1
  s_lshr_b32 s39, s36, 1
  s_and_b32 s40, s37, 7
  s_lshr_b32 s41, s37, 3
  s_mul_i32 s38, s38, 8
  s_add_u32 s26, s38, s40
  s_mul_i32 s39, s39, 4
  s_add_u32 s25, s39, s41
  s_lshr_b32 s42, s24, 1
  s_and_b32 s43, s24, 1
  v_and_b32 v3, 15, v2
  v_lshrrev_b32 v4, 4, v2
  s_lshl_b32 s44, s25, 7
  s_lshl_b32 s45, s42, 6
  s_add_u32 s44, s44, s45
  s_mul_i32 s46, s26, 64
  s_mul_i32 s45, s43, 32
  s_add_u32 s46, s46, s45
  s_add_u32 s20, s66, 0x20000
  s_addc_u32 s21, s67, 0
  s_mov_b32 s22, 0x6000
  s_mov_b32 s23, 0x20000
  s_add_u32 s12, s66, 0x1500000
  s_addc_u32 s13, s67, 0
  s_mov_b32 s14, 0x400000
  s_mov_b32 s15, 0x20000
  s_mov_b32 s16, s68
  s_mov_b32 s17, s69
  s_mov_b32 s18, 0x400000
  s_mov_b32 s19, 0x20000
  v_add_u32 v5, s44, v3
  v_lshlrev_b32 v5, 11, v5
  v_lshlrev_b32 v6, 3, v4
  v_add_u32 v5, v5, v6
  s_lshl_b32 s47, s46, 1
  v_add_u32 v5, s47, v5
  s_mov_b32 s48, 0
  buffer_load_dwordx2 v[92:93], v5, s[16:19], s48 offen offset:0
  buffer_load_dwordx2 v[94:95], v5, s[16:19], s48 offen offset:32
  s_mov_b32 s48, 32768
  buffer_load_dwordx2 v[96:97], v5, s[16:19], s48 offen offset:0
  buffer_load_dwordx2 v[98:99], v5, s[16:19], s48 offen offset:32
  s_mov_b32 s48, 65536
  buffer_load_dwordx2 v[100:101], v5, s[16:19], s48 offen offset:0
  buffer_load_dwordx2 v[102:103], v5, s[16:19], s48 offen offset:32
  s_mov_b32 s48, 98304
  buffer_load_dwordx2 v[104:105], v5, s[16:19], s48 offen offset:0
  buffer_load_dwordx2 v[106:107], v5, s[16:19], s48 offen offset:32
  s_and_b32 s35, s2, 7
  s_lshl_b32 s35, s35, 7
  s_add_u32 s35, s35, 271872
  v_lshlrev_b32 v6, 2, v2
  v_add_u32 v6, s35, v6
  s_mov_b32 s33, 0
  s_mov_b64 exec, 0x1
main_kernel_pollmr:
  buffer_load_dword v7, v6, s[28:31], 0 offen sc1
  s_waitcnt vmcnt(0)
  v_cmp_ne_u32 vcc, 1, v7
  s_nop 0
  s_cmp_eq_u64 vcc, 0
  s_cbranch_scc1 main_kernel_pollxmr
  s_add_u32 s33, s33, 1
  s_cmp_ge_u32 s33, 400000
  s_cbranch_scc1 main_kernel_pollxmr
  s_sleep 2
  s_branch main_kernel_pollmr
main_kernel_pollxmr:
  s_mov_b64 exec, -1
  v_lshlrev_b32 v6, 4, v4
  s_lshl_b32 s47, s46, 2
  s_add_u32 s47, s47, 8192
  buffer_load_dwordx4 v[108:111], v6, s[20:23], s47 offen offset:0 sc1
  buffer_load_dwordx4 v[112:115], v6, s[20:23], s47 offen offset:64 sc1
  s_lshl_b32 s47, s46, 2
  s_add_u32 s47, s47, 16384
  buffer_load_dwordx4 v[116:119], v6, s[20:23], s47 offen offset:0 sc1
  buffer_load_dwordx4 v[120:123], v6, s[20:23], s47 offen offset:64 sc1
  s_lshr_b32 s60, s2, 3
  s_and_b32 s59, s2, 3
  s_lshl_b32 s59, s59, 2
  s_and_b32 s61, s60, 3
  s_add_u32 s59, s59, s61
  s_bfe_u32 s58, s2, 0x10002
  s_lshl_b32 s58, s58, 3
  s_lshr_b32 s61, s60, 2
  s_add_u32 s58, s58, s61
  v_mul_u32_u24 v5, 2341, v2
  v_lshrrev_b32 v5, 16, v5
  v_mul_u32_u24 v6, 28, v5
  v_sub_u32 v6, v2, v6
  s_lshl_b32 s60, s58, 6
  s_lshl_b32 s61, s24, 4
  s_add_u32 s60, s60, s61
  v_add_u32 v5, s60, v5
  v_mul_u32_u24 v7, 7168, v5
  v_lshlrev_b32 v6, 4, v6
  v_add_u32 v7, v7, v6
  s_mul_i32 s60, s59, 448
  v_add_u32 v7, s60, v7
  s_mov_b32 s60, s72
  s_mov_b32 s61, s73
  s_mov_b32 s62, 0x700000
  s_mov_b32 s63, 0x20000
  v_cmp_gt_u32 vcc, 56, v2
  s_nop 0
  s_and_saveexec_b64 s[34:35], vcc
  s_mov_b32 s64, 0
  buffer_load_dwordx4 v[124:127], v7, s[60:63], s64 offen
  s_mov_b32 s64, 14336
  buffer_load_dwordx4 v[128:131], v7, s[60:63], s64 offen
  s_mov_b32 s64, 28672
  buffer_load_dwordx4 v[132:135], v7, s[60:63], s64 offen
  s_mov_b32 s64, 43008
  buffer_load_dwordx4 v[136:139], v7, s[60:63], s64 offen
  s_mov_b32 s64, 57344
  buffer_load_dwordx4 v[140:143], v7, s[60:63], s64 offen
  s_mov_b32 s64, 71680
  buffer_load_dwordx4 v[144:147], v7, s[60:63], s64 offen
  s_mov_b32 s64, 86016
  buffer_load_dwordx4 v[148:151], v7, s[60:63], s64 offen
  s_mov_b32 s64, 100352
  buffer_load_dwordx4 v[152:155], v7, s[60:63], s64 offen
  v_lshlrev_b32 v5, 2, v5
  s_mov_b32 s64, 16384
  s_mov_b32 s65, 12288
  buffer_load_dword v156, v5, s[20:23], s64 offen offset:0 sc1
  buffer_load_dword v164, v5, s[20:23], s65 offen offset:0 sc1
  buffer_load_dword v157, v5, s[20:23], s64 offen offset:8 sc1
  buffer_load_dword v165, v5, s[20:23], s65 offen offset:8 sc1
  buffer_load_dword v158, v5, s[20:23], s64 offen offset:16 sc1
  buffer_load_dword v166, v5, s[20:23], s65 offen offset:16 sc1
  buffer_load_dword v159, v5, s[20:23], s64 offen offset:24 sc1
  buffer_load_dword v167, v5, s[20:23], s65 offen offset:24 sc1
  buffer_load_dword v160, v5, s[20:23], s64 offen offset:32 sc1
  buffer_load_dword v168, v5, s[20:23], s65 offen offset:32 sc1
  buffer_load_dword v161, v5, s[20:23], s64 offen offset:40 sc1
  buffer_load_dword v169, v5, s[20:23], s65 offen offset:40 sc1
  buffer_load_dword v162, v5, s[20:23], s64 offen offset:48 sc1
  buffer_load_dword v170, v5, s[20:23], s65 offen offset:48 sc1
  buffer_load_dword v163, v5, s[20:23], s64 offen offset:56 sc1
  buffer_load_dword v171, v5, s[20:23], s65 offen offset:56 sc1
  s_mov_b64 exec, s[34:35]
  v_lshrrev_b32 v5, 1, v3
  v_xor_b32 v5, v5, v4
  v_and_b32 v5, 7, v5
  v_lshlrev_b32 v5, 4, v5
  s_lshl_b32 s47, s42, 6
  v_add_u32 v6, s47, v3
  v_lshlrev_b32 v6, 7, v6
  v_add_u32 v88, v5, v6
  v_xor_b32 v89, 64, v88
  v_lshrrev_b32 v5, 2, v3
  v_and_b32 v6, 3, v2
  v_lshlrev_b32 v7, 3, v4
  v_add_u32 v7, v7, v5
  v_mul_u32_u24 v7, 128, v7
  v_lshlrev_b32 v6, 3, v6
  v_add_u32 v7, v7, v6
  v_add_u32 v7, 16384, v7
  v_lshrrev_b32 v5, 1, v5
  v_and_b32 v6, 1, v4
  v_lshlrev_b32 v6, 1, v6
  v_or_b32 v5, v5, v6
  s_mul_i32 s47, s43, 2
  s_add_u32 s48, s47, 0
  v_xor_b32 v6, s48, v5
  v_lshlrev_b32 v6, 5, v6
  v_add_u32 v90, v7, v6
  s_add_u32 s48, s47, 1
  v_xor_b32 v6, s48, v5
  v_lshlrev_b32 v6, 5, v6
  v_add_u32 v91, v7, v6
  v_mov_b32 v8, 0
  v_mov_b32 v9, 0
  v_mov_b32 v10, 0
  v_mov_b32 v11, 0
  v_mov_b32 v12, 0
  v_mov_b32 v13, 0
  v_mov_b32 v14, 0
  v_mov_b32 v15, 0
  v_mov_b32 v16, 0
  v_mov_b32 v17, 0
  v_mov_b32 v18, 0
  v_mov_b32 v19, 0
  v_mov_b32 v20, 0
  v_mov_b32 v21, 0
  v_mov_b32 v22, 0
  v_mov_b32 v23, 0
  v_mov_b32 v24, 0
  v_mov_b32 v25, 0
  v_mov_b32 v26, 0
  v_mov_b32 v27, 0
  v_mov_b32 v28, 0
  v_mov_b32 v29, 0
  v_mov_b32 v30, 0
  v_mov_b32 v31, 0
  v_mov_b32 v32, 0
  v_mov_b32 v33, 0
  v_mov_b32 v34, 0
  v_mov_b32 v35, 0
  v_mov_b32 v36, 0
  v_mov_b32 v37, 0
  v_mov_b32 v38, 0
  v_mov_b32 v39, 0
  s_mov_b32 s49, 0
  s_mov_b32 s54, 24576
  s_mov_b32 s55, 0xfffe8000
  s_barrier
  ds_read_b128 v[40:43], v88 offset:0
  ds_read_b64_tr_b16 v[56:57], v90 offset:0
  ds_read_b64_tr_b16 v[58:59], v90 offset:512
  ds_read_b128 v[44:47], v88 offset:2048
  ds_read_b128 v[48:51], v88 offset:4096
  ds_read_b128 v[52:55], v88 offset:6144
  ds_read_b64_tr_b16 v[60:61], v91 offset:0
  ds_read_b64_tr_b16 v[62:63], v91 offset:512
  s_mov_b32 s50, 15
.p2align 6
main_kernel_wo_cloop:
  s_waitcnt lgkmcnt(0)
  v_mfma_f32_16x16x32_bf16 v[8:11], v[56:59], v[40:43], v[8:11]
  s_add_u32 s49, s49, 1
  ds_read_b128 v[64:67], v89 offset:0
  ds_read_b64_tr_b16 v[80:81], v90 offset:4096
  v_mfma_f32_16x16x32_bf16 v[12:15], v[60:63], v[40:43], v[12:15]
  s_cmp_eq_u32 s49, 5
  ds_read_b64_tr_b16 v[82:83], v90 offset:4608
  ds_read_b128 v[68:71], v89 offset:2048
  v_mfma_f32_16x16x32_bf16 v[16:19], v[56:59], v[44:47], v[16:19]
  s_cselect_b32 s51, s55, s54
  ds_read_b128 v[72:75], v89 offset:4096
  ds_read_b128 v[76:79], v89 offset:6144
  v_mfma_f32_16x16x32_bf16 v[20:23], v[60:63], v[44:47], v[20:23]
  s_cselect_b32 s49, 0, s49
  ds_read_b64_tr_b16 v[84:85], v91 offset:4096
  ds_read_b64_tr_b16 v[86:87], v91 offset:4608
  v_mfma_f32_16x16x32_bf16 v[24:27], v[56:59], v[48:51], v[24:27]
  v_add_u32 v88, s51, v88
  v_mfma_f32_16x16x32_bf16 v[28:31], v[60:63], v[48:51], v[28:31]
  v_add_u32 v89, s51, v89
  v_mfma_f32_16x16x32_bf16 v[32:35], v[56:59], v[52:55], v[32:35]
  v_add_u32 v90, s51, v90
  v_mfma_f32_16x16x32_bf16 v[36:39], v[60:63], v[52:55], v[36:39]
  v_add_u32 v91, s51, v91
  s_waitcnt lgkmcnt(0)
  s_barrier
  v_mfma_f32_16x16x32_bf16 v[8:11], v[80:83], v[64:67], v[8:11]
  ds_read_b128 v[40:43], v88 offset:0
  ds_read_b64_tr_b16 v[56:57], v90 offset:0
  v_mfma_f32_16x16x32_bf16 v[12:15], v[84:87], v[64:67], v[12:15]
  s_sub_u32 s50, s50, 1
  ds_read_b64_tr_b16 v[58:59], v90 offset:512
  ds_read_b128 v[44:47], v88 offset:2048
  v_mfma_f32_16x16x32_bf16 v[16:19], v[80:83], v[68:71], v[16:19]
  s_cmp_lg_u32 s50, 0
  ds_read_b128 v[48:51], v88 offset:4096
  ds_read_b128 v[52:55], v88 offset:6144
  v_mfma_f32_16x16x32_bf16 v[20:23], v[84:87], v[68:71], v[20:23]
  ds_read_b64_tr_b16 v[60:61], v91 offset:0
  ds_read_b64_tr_b16 v[62:63], v91 offset:512
  v_mfma_f32_16x16x32_bf16 v[24:27], v[80:83], v[72:75], v[24:27]
  v_mfma_f32_16x16x32_bf16 v[28:31], v[84:87], v[72:75], v[28:31]
  v_mfma_f32_16x16x32_bf16 v[32:35], v[80:83], v[76:79], v[32:35]
  v_mfma_f32_16x16x32_bf16 v[36:39], v[84:87], v[76:79], v[36:39]
  s_cbranch_scc1 main_kernel_wo_cloop
  s_waitcnt lgkmcnt(0)
  v_mfma_f32_16x16x32_bf16 v[8:11], v[56:59], v[40:43], v[8:11]
  ds_read_b128 v[64:67], v89 offset:0
  ds_read_b64_tr_b16 v[80:81], v90 offset:4096
  v_mfma_f32_16x16x32_bf16 v[12:15], v[60:63], v[40:43], v[12:15]
  ds_read_b64_tr_b16 v[82:83], v90 offset:4608
  ds_read_b128 v[68:71], v89 offset:2048
  v_mfma_f32_16x16x32_bf16 v[16:19], v[56:59], v[44:47], v[16:19]
  ds_read_b128 v[72:75], v89 offset:4096
  ds_read_b128 v[76:79], v89 offset:6144
  v_mfma_f32_16x16x32_bf16 v[20:23], v[60:63], v[44:47], v[20:23]
  ds_read_b64_tr_b16 v[84:85], v91 offset:4096
  ds_read_b64_tr_b16 v[86:87], v91 offset:4608
  v_mfma_f32_16x16x32_bf16 v[24:27], v[56:59], v[48:51], v[24:27]
  v_mfma_f32_16x16x32_bf16 v[28:31], v[60:63], v[48:51], v[28:31]
  v_mfma_f32_16x16x32_bf16 v[32:35], v[56:59], v[52:55], v[32:35]
  v_mfma_f32_16x16x32_bf16 v[36:39], v[60:63], v[52:55], v[36:39]
  s_waitcnt lgkmcnt(0)
  s_barrier
  v_mfma_f32_16x16x32_bf16 v[8:11], v[80:83], v[64:67], v[8:11]
  v_mfma_f32_16x16x32_bf16 v[12:15], v[84:87], v[64:67], v[12:15]
  v_mfma_f32_16x16x32_bf16 v[16:19], v[80:83], v[68:71], v[16:19]
  v_mfma_f32_16x16x32_bf16 v[20:23], v[84:87], v[68:71], v[20:23]
  v_mfma_f32_16x16x32_bf16 v[24:27], v[80:83], v[72:75], v[24:27]
  v_mfma_f32_16x16x32_bf16 v[28:31], v[84:87], v[72:75], v[28:31]
  v_mfma_f32_16x16x32_bf16 v[32:35], v[80:83], v[76:79], v[32:35]
  v_mfma_f32_16x16x32_bf16 v[36:39], v[84:87], v[76:79], v[36:39]
  v_and_b32 v5, 1, v4
  v_lshlrev_b32 v5, 5, v5
  v_lshrrev_b32 v6, 1, v4
  v_lshlrev_b32 v6, 4, v6
  v_add_u32 v5, v5, v6
  s_waitcnt vmcnt(0)
  v_add_u32 v6, s44, v3
  v_lshlrev_b32 v6, 11, v6
  s_lshl_b32 s47, s46, 1
  v_add_u32 v6, s47, v6
  v_add_u32 v5, v5, v6
  s_add_u32 s16, s66, 0x2800000
  s_addc_u32 s17, s67, 0
  s_mov_b32 s18, 0x400000
  s_mov_b32 s19, 0x20000
  s_add_u32 s60, s66, 0x2c00000
  s_addc_u32 s61, s67, 0
  s_mov_b32 s62, 0x80000
  s_mov_b32 s63, 0x20000
  v_add_f32 v116, 1.0, v116
  v_cvt_pk_bf16_f32 v116, v116, v116
  v_lshlrev_b32 v116, 16, v116
  v_add_f32 v117, 1.0, v117
  v_cvt_pk_bf16_f32 v117, v117, v117
  v_lshlrev_b32 v117, 16, v117
  v_add_f32 v118, 1.0, v118
  v_cvt_pk_bf16_f32 v118, v118, v118
  v_lshlrev_b32 v118, 16, v118
  v_add_f32 v119, 1.0, v119
  v_cvt_pk_bf16_f32 v119, v119, v119
  v_lshlrev_b32 v119, 16, v119
  v_add_f32 v120, 1.0, v120
  v_cvt_pk_bf16_f32 v120, v120, v120
  v_lshlrev_b32 v120, 16, v120
  v_add_f32 v121, 1.0, v121
  v_cvt_pk_bf16_f32 v121, v121, v121
  v_lshlrev_b32 v121, 16, v121
  v_add_f32 v122, 1.0, v122
  v_cvt_pk_bf16_f32 v122, v122, v122
  v_lshlrev_b32 v122, 16, v122
  v_add_f32 v123, 1.0, v123
  v_cvt_pk_bf16_f32 v123, v123, v123
  v_lshlrev_b32 v123, 16, v123
  s_lshl_b32 s49, s26, 1
  s_add_u32 s49, s49, s43
  s_lshl_b32 s49, s49, 14
  s_lshl_b32 s50, s44, 3
  s_add_u32 s49, s49, s50
  v_lshlrev_b32 v1, 3, v3
  v_and_b32 v6, 1, v4
  v_lshlrev_b32 v6, 2, v6
  v_add_u32 v1, v1, v6
  s_lshl_b32 s47, s25, 4
  s_add_u32 s47, s47, s26
  s_lshl_b32 s47, s47, 2
  s_add_u32 s47, s47, s24
  s_lshl_b32 s47, s47, 12
  v_lshlrev_b32 v7, 4, v2
  v_mov_b32 v253, v7
  s_mov_b32 s48, 0
  v_lshlrev_b32 v72, 16, v92
  v_and_b32 v73, 0xffff0000, v92
  v_lshlrev_b32 v74, 16, v93
  v_and_b32 v75, 0xffff0000, v93
  v_pk_fma_f32 v[8:9], v[8:9], v[108:109], v[72:73]
  v_pk_fma_f32 v[10:11], v[10:11], v[110:111], v[74:75]
  v_lshlrev_b32 v72, 16, v94
  v_and_b32 v73, 0xffff0000, v94
  v_lshlrev_b32 v74, 16, v95
  v_and_b32 v75, 0xffff0000, v95
  v_pk_fma_f32 v[12:13], v[12:13], v[112:113], v[72:73]
  v_pk_fma_f32 v[14:15], v[14:15], v[114:115], v[74:75]
  v_pk_mul_f32 v[72:73], v[8:9], v[116:117]
  v_pk_mul_f32 v[76:77], v[12:13], v[120:121]
  v_pk_mul_f32 v[74:75], v[10:11], v[118:119]
  v_pk_mul_f32 v[78:79], v[14:15], v[122:123]
  v_cvt_pk_bf16_f32 v48, v72, v73
  v_cvt_pk_bf16_f32 v49, v74, v75
  v_cvt_pk_bf16_f32 v50, v76, v77
  v_cvt_pk_bf16_f32 v51, v78, v79
  s_nop 0
  v_permlane16_swap_b32 v48, v50
  v_permlane16_swap_b32 v49, v51
  buffer_store_dwordx4 v[48:51], v5, s[16:19], s48 offen sc1
  s_mov_b32 s48, 32768
  v_lshlrev_b32 v72, 16, v96
  v_and_b32 v73, 0xffff0000, v96
  v_lshlrev_b32 v74, 16, v97
  v_and_b32 v75, 0xffff0000, v97
  v_pk_fma_f32 v[16:17], v[16:17], v[108:109], v[72:73]
  v_pk_fma_f32 v[18:19], v[18:19], v[110:111], v[74:75]
  v_lshlrev_b32 v72, 16, v98
  v_and_b32 v73, 0xffff0000, v98
  v_lshlrev_b32 v74, 16, v99
  v_and_b32 v75, 0xffff0000, v99
  v_pk_fma_f32 v[20:21], v[20:21], v[112:113], v[72:73]
  v_pk_fma_f32 v[22:23], v[22:23], v[114:115], v[74:75]
  v_pk_mul_f32 v[72:73], v[16:17], v[116:117]
  v_pk_mul_f32 v[76:77], v[20:21], v[120:121]
  v_pk_mul_f32 v[74:75], v[18:19], v[118:119]
  v_pk_mul_f32 v[78:79], v[22:23], v[122:123]
  v_cvt_pk_bf16_f32 v52, v72, v73
  v_cvt_pk_bf16_f32 v53, v74, v75
  v_cvt_pk_bf16_f32 v54, v76, v77
  v_cvt_pk_bf16_f32 v55, v78, v79
  s_nop 0
  v_permlane16_swap_b32 v52, v54
  v_permlane16_swap_b32 v53, v55
  buffer_store_dwordx4 v[52:55], v5, s[16:19], s48 offen sc1
  s_mov_b32 s48, 65536
  v_lshlrev_b32 v72, 16, v100
  v_and_b32 v73, 0xffff0000, v100
  v_lshlrev_b32 v74, 16, v101
  v_and_b32 v75, 0xffff0000, v101
  v_pk_fma_f32 v[24:25], v[24:25], v[108:109], v[72:73]
  v_pk_fma_f32 v[26:27], v[26:27], v[110:111], v[74:75]
  v_lshlrev_b32 v72, 16, v102
  v_and_b32 v73, 0xffff0000, v102
  v_lshlrev_b32 v74, 16, v103
  v_and_b32 v75, 0xffff0000, v103
  v_pk_fma_f32 v[28:29], v[28:29], v[112:113], v[72:73]
  v_pk_fma_f32 v[30:31], v[30:31], v[114:115], v[74:75]
  v_pk_mul_f32 v[72:73], v[24:25], v[116:117]
  v_pk_mul_f32 v[76:77], v[28:29], v[120:121]
  v_pk_mul_f32 v[74:75], v[26:27], v[118:119]
  v_pk_mul_f32 v[78:79], v[30:31], v[122:123]
  v_cvt_pk_bf16_f32 v48, v72, v73
  v_cvt_pk_bf16_f32 v49, v74, v75
  v_cvt_pk_bf16_f32 v50, v76, v77
  v_cvt_pk_bf16_f32 v51, v78, v79
  s_nop 0
  v_permlane16_swap_b32 v48, v50
  v_permlane16_swap_b32 v49, v51
  buffer_store_dwordx4 v[48:51], v5, s[16:19], s48 offen sc1
  s_mov_b32 s48, 98304
  v_lshlrev_b32 v72, 16, v104
  v_and_b32 v73, 0xffff0000, v104
  v_lshlrev_b32 v74, 16, v105
  v_and_b32 v75, 0xffff0000, v105
  v_pk_fma_f32 v[32:33], v[32:33], v[108:109], v[72:73]
  v_pk_fma_f32 v[34:35], v[34:35], v[110:111], v[74:75]
  v_lshlrev_b32 v72, 16, v106
  v_and_b32 v73, 0xffff0000, v106
  v_lshlrev_b32 v74, 16, v107
  v_and_b32 v75, 0xffff0000, v107
  v_pk_fma_f32 v[36:37], v[36:37], v[112:113], v[72:73]
  v_pk_fma_f32 v[38:39], v[38:39], v[114:115], v[74:75]
  v_pk_mul_f32 v[72:73], v[32:33], v[116:117]
  v_pk_mul_f32 v[76:77], v[36:37], v[120:121]
  v_pk_mul_f32 v[74:75], v[34:35], v[118:119]
  v_pk_mul_f32 v[78:79], v[38:39], v[122:123]
  v_cvt_pk_bf16_f32 v52, v72, v73
  v_cvt_pk_bf16_f32 v53, v74, v75
  v_cvt_pk_bf16_f32 v54, v76, v77
  v_cvt_pk_bf16_f32 v55, v78, v79
  s_nop 0
  v_permlane16_swap_b32 v52, v54
  v_permlane16_swap_b32 v53, v55
  buffer_store_dwordx4 v[52:55], v5, s[16:19], s48 offen sc1
  v_cvt_pk_bf16_f32 v40, v8, v9
  v_cvt_pk_bf16_f32 v41, v10, v11
  v_cvt_pk_bf16_f32 v42, v12, v13
  v_cvt_pk_bf16_f32 v43, v14, v15
  buffer_store_dwordx4 v[40:43], v253, s[12:15], s47 offen offset:0 sc1
  v_pk_add_f32 v[56:57], v[8:9], v[10:11]
  v_pk_mul_f32 v[58:59], v[8:9], v[8:9]
  v_pk_add_f32 v[56:57], v[56:57], v[12:13]
  v_pk_fma_f32 v[58:59], v[10:11], v[10:11], v[58:59]
  v_pk_add_f32 v[56:57], v[56:57], v[14:15]
  v_pk_fma_f32 v[58:59], v[12:13], v[12:13], v[58:59]
  v_pk_fma_f32 v[58:59], v[14:15], v[14:15], v[58:59]
  v_add_f32 v56, v56, v57
  v_add_f32 v58, v58, v59
  s_nop 1
  v_permlane16_swap_b32 v56, v58
  v_add_f32 v56, v56, v58
  v_mov_b32 v57, v56
  s_nop 1
  v_permlane32_swap_b32 v56, v57
  v_add_f32 v56, v56, v57
  s_mov_b32 exec_lo, -1
  s_mov_b32 exec_hi, 0
  buffer_store_dword v56, v1, s[60:63], s49 offen offset:0 sc1
  s_mov_b64 exec, -1
  v_cvt_pk_bf16_f32 v44, v16, v17
  v_cvt_pk_bf16_f32 v45, v18, v19
  v_cvt_pk_bf16_f32 v46, v20, v21
  v_cvt_pk_bf16_f32 v47, v22, v23
  buffer_store_dwordx4 v[44:47], v253, s[12:15], s47 offen offset:1024 sc1
  v_pk_add_f32 v[60:61], v[16:17], v[18:19]
  v_pk_mul_f32 v[62:63], v[16:17], v[16:17]
  v_pk_add_f32 v[60:61], v[60:61], v[20:21]
  v_pk_fma_f32 v[62:63], v[18:19], v[18:19], v[62:63]
  v_pk_add_f32 v[60:61], v[60:61], v[22:23]
  v_pk_fma_f32 v[62:63], v[20:21], v[20:21], v[62:63]
  v_pk_fma_f32 v[62:63], v[22:23], v[22:23], v[62:63]
  v_add_f32 v60, v60, v61
  v_add_f32 v62, v62, v63
  s_nop 1
  v_permlane16_swap_b32 v60, v62
  v_add_f32 v60, v60, v62
  v_mov_b32 v61, v60
  s_nop 1
  v_permlane32_swap_b32 v60, v61
  v_add_f32 v60, v60, v61
  s_mov_b32 exec_lo, -1
  s_mov_b32 exec_hi, 0
  buffer_store_dword v60, v1, s[60:63], s49 offen offset:128 sc1
  s_mov_b64 exec, -1
  v_cvt_pk_bf16_f32 v40, v24, v25
  v_cvt_pk_bf16_f32 v41, v26, v27
  v_cvt_pk_bf16_f32 v42, v28, v29
  v_cvt_pk_bf16_f32 v43, v30, v31
  buffer_store_dwordx4 v[40:43], v253, s[12:15], s47 offen offset:2048 sc1
  v_pk_add_f32 v[56:57], v[24:25], v[26:27]
  v_pk_mul_f32 v[58:59], v[24:25], v[24:25]
  v_pk_add_f32 v[56:57], v[56:57], v[28:29]
  v_pk_fma_f32 v[58:59], v[26:27], v[26:27], v[58:59]
  v_pk_add_f32 v[56:57], v[56:57], v[30:31]
  v_pk_fma_f32 v[58:59], v[28:29], v[28:29], v[58:59]
  v_pk_fma_f32 v[58:59], v[30:31], v[30:31], v[58:59]
  v_add_f32 v56, v56, v57
  v_add_f32 v58, v58, v59
  s_nop 1
  v_permlane16_swap_b32 v56, v58
  v_add_f32 v56, v56, v58
  v_mov_b32 v57, v56
  s_nop 1
  v_permlane32_swap_b32 v56, v57
  v_add_f32 v56, v56, v57
  s_mov_b32 exec_lo, -1
  s_mov_b32 exec_hi, 0
  buffer_store_dword v56, v1, s[60:63], s49 offen offset:256 sc1
  s_mov_b64 exec, -1
  v_cvt_pk_bf16_f32 v44, v32, v33
  v_cvt_pk_bf16_f32 v45, v34, v35
  v_cvt_pk_bf16_f32 v46, v36, v37
  v_cvt_pk_bf16_f32 v47, v38, v39
  buffer_store_dwordx4 v[44:47], v253, s[12:15], s47 offen offset:3072 sc1
  v_pk_add_f32 v[60:61], v[32:33], v[34:35]
  v_pk_mul_f32 v[62:63], v[32:33], v[32:33]
  v_pk_add_f32 v[60:61], v[60:61], v[36:37]
  v_pk_fma_f32 v[62:63], v[34:35], v[34:35], v[62:63]
  v_pk_add_f32 v[60:61], v[60:61], v[38:39]
  v_pk_fma_f32 v[62:63], v[36:37], v[36:37], v[62:63]
  v_pk_fma_f32 v[62:63], v[38:39], v[38:39], v[62:63]
  v_add_f32 v60, v60, v61
  v_add_f32 v62, v62, v63
  s_nop 1
  v_permlane16_swap_b32 v60, v62
  v_add_f32 v60, v60, v62
  v_mov_b32 v61, v60
  s_nop 1
  v_permlane32_swap_b32 v60, v61
  v_add_f32 v60, v60, v61
  s_mov_b32 exec_lo, -1
  s_mov_b32 exec_hi, 0
  buffer_store_dword v60, v1, s[60:63], s49 offen offset:384 sc1
  s_mov_b64 exec, -1
  s_add_u32 s35, s25, 24
  s_waitcnt vmcnt(8)
  v_mov_b32 v6, 138248
  v_mov_b32 v7, 1
  s_mov_b64 exec, 1
  ds_add_rtn_u32 v7, v6, v7
  s_waitcnt lgkmcnt(0)
  v_readfirstlane_b32 s32, v7
  s_mov_b64 exec, -1
  s_cmp_lg_u32 s32, 3
  s_cbranch_scc1 main_kernel_sigwo
  s_lshl_b32 s33, s25, 9
  s_lshl_b32 s34, s26, 2
  s_add_u32 s33, s33, s34
  s_add_u32 s33, s33, 173568
  v_lshlrev_b32 v6, 7, v2
  v_add_u32 v6, s33, v6
  v_mov_b32 v7, 1
  s_mov_b64 exec, 0xf
  buffer_store_dword v7, v6, s[28:31], 0 offen sc1
main_kernel_sigwo:
  s_mov_b64 exec, -1
  s_waitcnt vmcnt(0)
  v_mov_b32 v6, 138400
  v_mov_b32 v7, 1
  s_mov_b64 exec, 1
  ds_add_rtn_u32 v7, v6, v7
  s_waitcnt lgkmcnt(0)
  v_readfirstlane_b32 s32, v7
  s_mov_b64 exec, -1
  s_cmp_lg_u32 s32, 3
  s_cbranch_scc1 main_kernel_sigwo2
  s_lshl_b32 s33, s25, 9
  s_lshl_b32 s34, s26, 2
  s_add_u32 s33, s33, s34
  s_add_u32 s33, s33, 272896
  v_lshlrev_b32 v6, 7, v2
  v_add_u32 v6, s33, v6
  v_mov_b32 v7, 1
  s_mov_b64 exec, 0xf
  buffer_store_dword v7, v6, s[28:31], 0 offen sc1
main_kernel_sigwo2:
  s_mov_b64 exec, -1
  v_mov_b32 v8, 0
  v_mov_b32 v9, 0
  v_mov_b32 v10, 0
  v_mov_b32 v11, 0
  v_mov_b32 v12, 0
  v_mov_b32 v13, 0
  v_mov_b32 v14, 0
  v_mov_b32 v15, 0
  v_mov_b32 v16, 0
  v_mov_b32 v17, 0
  v_mov_b32 v18, 0
  v_mov_b32 v19, 0
  v_mov_b32 v20, 0
  v_mov_b32 v21, 0
  v_mov_b32 v22, 0
  v_mov_b32 v23, 0
  v_add_f32 v156, 1.0, v156
  v_cvt_pk_bf16_f32 v156, v156, v156
  v_lshlrev_b32 v156, 16, v156
  v_lshlrev_b32 v6, 16, v124
  v_and_b32 v7, 0xffff0000, v124
  v_fmac_f32 v8, v156, v6
  v_fmac_f32 v9, v156, v7
  v_fmac_f32 v16, v164, v6
  v_fmac_f32 v17, v164, v7
  v_lshlrev_b32 v6, 16, v125
  v_and_b32 v7, 0xffff0000, v125
  v_fmac_f32 v10, v156, v6
  v_fmac_f32 v11, v156, v7
  v_fmac_f32 v18, v164, v6
  v_fmac_f32 v19, v164, v7
  v_lshlrev_b32 v6, 16, v126
  v_and_b32 v7, 0xffff0000, v126
  v_fmac_f32 v12, v156, v6
  v_fmac_f32 v13, v156, v7
  v_fmac_f32 v20, v164, v6
  v_fmac_f32 v21, v164, v7
  v_lshlrev_b32 v6, 16, v127
  v_and_b32 v7, 0xffff0000, v127
  v_fmac_f32 v14, v156, v6
  v_fmac_f32 v15, v156, v7
  v_fmac_f32 v22, v164, v6
  v_fmac_f32 v23, v164, v7
  v_add_f32 v157, 1.0, v157
  v_cvt_pk_bf16_f32 v157, v157, v157
  v_lshlrev_b32 v157, 16, v157
  v_lshlrev_b32 v6, 16, v128
  v_and_b32 v7, 0xffff0000, v128
  v_fmac_f32 v8, v157, v6
  v_fmac_f32 v9, v157, v7
  v_fmac_f32 v16, v165, v6
  v_fmac_f32 v17, v165, v7
  v_lshlrev_b32 v6, 16, v129
  v_and_b32 v7, 0xffff0000, v129
  v_fmac_f32 v10, v157, v6
  v_fmac_f32 v11, v157, v7
  v_fmac_f32 v18, v165, v6
  v_fmac_f32 v19, v165, v7
  v_lshlrev_b32 v6, 16, v130
  v_and_b32 v7, 0xffff0000, v130
  v_fmac_f32 v12, v157, v6
  v_fmac_f32 v13, v157, v7
  v_fmac_f32 v20, v165, v6
  v_fmac_f32 v21, v165, v7
  v_lshlrev_b32 v6, 16, v131
  v_and_b32 v7, 0xffff0000, v131
  v_fmac_f32 v14, v157, v6
  v_fmac_f32 v15, v157, v7
  v_fmac_f32 v22, v165, v6
  v_fmac_f32 v23, v165, v7
  v_add_f32 v158, 1.0, v158
  v_cvt_pk_bf16_f32 v158, v158, v158
  v_lshlrev_b32 v158, 16, v158
  v_lshlrev_b32 v6, 16, v132
  v_and_b32 v7, 0xffff0000, v132
  v_fmac_f32 v8, v158, v6
  v_fmac_f32 v9, v158, v7
  v_fmac_f32 v16, v166, v6
  v_fmac_f32 v17, v166, v7
  v_lshlrev_b32 v6, 16, v133
  v_and_b32 v7, 0xffff0000, v133
  v_fmac_f32 v10, v158, v6
  v_fmac_f32 v11, v158, v7
  v_fmac_f32 v18, v166, v6
  v_fmac_f32 v19, v166, v7
  v_lshlrev_b32 v6, 16, v134
  v_and_b32 v7, 0xffff0000, v134
  v_fmac_f32 v12, v158, v6
  v_fmac_f32 v13, v158, v7
  v_fmac_f32 v20, v166, v6
  v_fmac_f32 v21, v166, v7
  v_lshlrev_b32 v6, 16, v135
  v_and_b32 v7, 0xffff0000, v135
  v_fmac_f32 v14, v158, v6
  v_fmac_f32 v15, v158, v7
  v_fmac_f32 v22, v166, v6
  v_fmac_f32 v23, v166, v7
  v_add_f32 v159, 1.0, v159
  v_cvt_pk_bf16_f32 v159, v159, v159
  v_lshlrev_b32 v159, 16, v159
  v_lshlrev_b32 v6, 16, v136
  v_and_b32 v7, 0xffff0000, v136
  v_fmac_f32 v8, v159, v6
  v_fmac_f32 v9, v159, v7
  v_fmac_f32 v16, v167, v6
  v_fmac_f32 v17, v167, v7
  v_lshlrev_b32 v6, 16, v137
  v_and_b32 v7, 0xffff0000, v137
  v_fmac_f32 v10, v159, v6
  v_fmac_f32 v11, v159, v7
  v_fmac_f32 v18, v167, v6
  v_fmac_f32 v19, v167, v7
  v_lshlrev_b32 v6, 16, v138
  v_and_b32 v7, 0xffff0000, v138
  v_fmac_f32 v12, v159, v6
  v_fmac_f32 v13, v159, v7
  v_fmac_f32 v20, v167, v6
  v_fmac_f32 v21, v167, v7
  v_lshlrev_b32 v6, 16, v139
  v_and_b32 v7, 0xffff0000, v139
  v_fmac_f32 v14, v159, v6
  v_fmac_f32 v15, v159, v7
  v_fmac_f32 v22, v167, v6
  v_fmac_f32 v23, v167, v7
  v_add_f32 v160, 1.0, v160
  v_cvt_pk_bf16_f32 v160, v160, v160
  v_lshlrev_b32 v160, 16, v160
  v_lshlrev_b32 v6, 16, v140
  v_and_b32 v7, 0xffff0000, v140
  v_fmac_f32 v8, v160, v6
  v_fmac_f32 v9, v160, v7
  v_fmac_f32 v16, v168, v6
  v_fmac_f32 v17, v168, v7
  v_lshlrev_b32 v6, 16, v141
  v_and_b32 v7, 0xffff0000, v141
  v_fmac_f32 v10, v160, v6
  v_fmac_f32 v11, v160, v7
  v_fmac_f32 v18, v168, v6
  v_fmac_f32 v19, v168, v7
  v_lshlrev_b32 v6, 16, v142
  v_and_b32 v7, 0xffff0000, v142
  v_fmac_f32 v12, v160, v6
  v_fmac_f32 v13, v160, v7
  v_fmac_f32 v20, v168, v6
  v_fmac_f32 v21, v168, v7
  v_lshlrev_b32 v6, 16, v143
  v_and_b32 v7, 0xffff0000, v143
  v_fmac_f32 v14, v160, v6
  v_fmac_f32 v15, v160, v7
  v_fmac_f32 v22, v168, v6
  v_fmac_f32 v23, v168, v7
  v_add_f32 v161, 1.0, v161
  v_cvt_pk_bf16_f32 v161, v161, v161
  v_lshlrev_b32 v161, 16, v161
  v_lshlrev_b32 v6, 16, v144
  v_and_b32 v7, 0xffff0000, v144
  v_fmac_f32 v8, v161, v6
  v_fmac_f32 v9, v161, v7
  v_fmac_f32 v16, v169, v6
  v_fmac_f32 v17, v169, v7
  v_lshlrev_b32 v6, 16, v145
  v_and_b32 v7, 0xffff0000, v145
  v_fmac_f32 v10, v161, v6
  v_fmac_f32 v11, v161, v7
  v_fmac_f32 v18, v169, v6
  v_fmac_f32 v19, v169, v7
  v_lshlrev_b32 v6, 16, v146
  v_and_b32 v7, 0xffff0000, v146
  v_fmac_f32 v12, v161, v6
  v_fmac_f32 v13, v161, v7
  v_fmac_f32 v20, v169, v6
  v_fmac_f32 v21, v169, v7
  v_lshlrev_b32 v6, 16, v147
  v_and_b32 v7, 0xffff0000, v147
  v_fmac_f32 v14, v161, v6
  v_fmac_f32 v15, v161, v7
  v_fmac_f32 v22, v169, v6
  v_fmac_f32 v23, v169, v7
  v_add_f32 v162, 1.0, v162
  v_cvt_pk_bf16_f32 v162, v162, v162
  v_lshlrev_b32 v162, 16, v162
  v_lshlrev_b32 v6, 16, v148
  v_and_b32 v7, 0xffff0000, v148
  v_fmac_f32 v8, v162, v6
  v_fmac_f32 v9, v162, v7
  v_fmac_f32 v16, v170, v6
  v_fmac_f32 v17, v170, v7
  v_lshlrev_b32 v6, 16, v149
  v_and_b32 v7, 0xffff0000, v149
  v_fmac_f32 v10, v162, v6
  v_fmac_f32 v11, v162, v7
  v_fmac_f32 v18, v170, v6
  v_fmac_f32 v19, v170, v7
  v_lshlrev_b32 v6, 16, v150
  v_and_b32 v7, 0xffff0000, v150
  v_fmac_f32 v12, v162, v6
  v_fmac_f32 v13, v162, v7
  v_fmac_f32 v20, v170, v6
  v_fmac_f32 v21, v170, v7
  v_lshlrev_b32 v6, 16, v151
  v_and_b32 v7, 0xffff0000, v151
  v_fmac_f32 v14, v162, v6
  v_fmac_f32 v15, v162, v7
  v_fmac_f32 v22, v170, v6
  v_fmac_f32 v23, v170, v7
  v_add_f32 v163, 1.0, v163
  v_cvt_pk_bf16_f32 v163, v163, v163
  v_lshlrev_b32 v163, 16, v163
  v_lshlrev_b32 v6, 16, v152
  v_and_b32 v7, 0xffff0000, v152
  v_fmac_f32 v8, v163, v6
  v_fmac_f32 v9, v163, v7
  v_fmac_f32 v16, v171, v6
  v_fmac_f32 v17, v171, v7
  v_lshlrev_b32 v6, 16, v153
  v_and_b32 v7, 0xffff0000, v153
  v_fmac_f32 v10, v163, v6
  v_fmac_f32 v11, v163, v7
  v_fmac_f32 v18, v171, v6
  v_fmac_f32 v19, v171, v7
  v_lshlrev_b32 v6, 16, v154
  v_and_b32 v7, 0xffff0000, v154
  v_fmac_f32 v12, v163, v6
  v_fmac_f32 v13, v163, v7
  v_fmac_f32 v20, v171, v6
  v_fmac_f32 v21, v171, v7
  v_lshlrev_b32 v6, 16, v155
  v_and_b32 v7, 0xffff0000, v155
  v_fmac_f32 v14, v163, v6
  v_fmac_f32 v15, v163, v7
  v_fmac_f32 v22, v171, v6
  v_fmac_f32 v23, v171, v7
  v_mul_u32_u24 v5, 2341, v2
  v_lshrrev_b32 v5, 16, v5
  v_mul_u32_u24 v6, 28, v5
  v_sub_u32 v6, v2, v6
  s_lshl_b32 s32, s24, 1
  v_add_u32 v5, s32, v5
  v_mul_u32_u24 v5, 1792, v5
  v_lshlrev_b32 v6, 5, v6
  v_add_u32 v5, v5, v6
  v_add_u32 v5, 139264, v5
  v_cmp_gt_u32 vcc, 56, v2
  s_nop 0
  s_and_saveexec_b64 s[34:35], vcc
  ds_write_b128 v5, v[8:11]
  ds_write_b128 v5, v[12:15] offset:16
  ds_write_b128 v5, v[16:19] offset:896
  ds_write_b128 v5, v[20:23] offset:912
  s_mov_b64 exec, s[34:35]
  s_waitcnt lgkmcnt(0)
  v_mov_b32 v6, 138252
  v_mov_b32 v7, 1
  s_mov_b64 exec, 1
  ds_add_rtn_u32 v7, v6, v7
  s_waitcnt lgkmcnt(0)
  v_readfirstlane_b32 s32, v7
  s_mov_b64 exec, -1
  s_cmp_lg_u32 s32, 3
  s_cbranch_scc1 main_kernel_wo_ubx
  v_lshlrev_b32 v5, 2, v2
  v_add_u32 v5, 139264, v5
  ds_read_b32 v8, v5 offset:0
  ds_read_b32 v9, v5 offset:1792
  ds_read_b32 v10, v5 offset:3584
  ds_read_b32 v11, v5 offset:5376
  ds_read_b32 v12, v5 offset:7168
  ds_read_b32 v13, v5 offset:8960
  ds_read_b32 v14, v5 offset:10752
  ds_read_b32 v15, v5 offset:12544
  s_waitcnt lgkmcnt(0)
  v_add_f32 v8, v8, v9
  v_add_f32 v8, v8, v10
  v_add_f32 v8, v8, v11
  v_add_f32 v8, v8, v12
  v_add_f32 v8, v8, v13
  v_add_f32 v8, v8, v14
  v_add_f32 v8, v8, v15
  v_mov_b32 v24, v8
  ds_read_b32 v8, v5 offset:256
  ds_read_b32 v9, v5 offset:2048
  ds_read_b32 v10, v5 offset:3840
  ds_read_b32 v11, v5 offset:5632
  ds_read_b32 v12, v5 offset:7424
  ds_read_b32 v13, v5 offset:9216
  ds_read_b32 v14, v5 offset:11008
  ds_read_b32 v15, v5 offset:12800
  s_waitcnt lgkmcnt(0)
  v_add_f32 v8, v8, v9
  v_add_f32 v8, v8, v10
  v_add_f32 v8, v8, v11
  v_add_f32 v8, v8, v12
  v_add_f32 v8, v8, v13
  v_add_f32 v8, v8, v14
  v_add_f32 v8, v8, v15
  v_mov_b32 v25, v8
  ds_read_b32 v8, v5 offset:512
  ds_read_b32 v9, v5 offset:2304
  ds_read_b32 v10, v5 offset:4096
  ds_read_b32 v11, v5 offset:5888
  ds_read_b32 v12, v5 offset:7680
  ds_read_b32 v13, v5 offset:9472
  ds_read_b32 v14, v5 offset:11264
  ds_read_b32 v15, v5 offset:13056
  s_waitcnt lgkmcnt(0)
  v_add_f32 v8, v8, v9
  v_add_f32 v8, v8, v10
  v_add_f32 v8, v8, v11
  v_add_f32 v8, v8, v12
  v_add_f32 v8, v8, v13
  v_add_f32 v8, v8, v14
  v_add_f32 v8, v8, v15
  v_mov_b32 v26, v8
  ds_read_b32 v8, v5 offset:768
  ds_read_b32 v9, v5 offset:2560
  ds_read_b32 v10, v5 offset:4352
  ds_read_b32 v11, v5 offset:6144
  ds_read_b32 v12, v5 offset:7936
  ds_read_b32 v13, v5 offset:9728
  ds_read_b32 v14, v5 offset:11520
  ds_read_b32 v15, v5 offset:13312
  s_waitcnt lgkmcnt(0)
  v_add_f32 v8, v8, v9
  v_add_f32 v8, v8, v10
  v_add_f32 v8, v8, v11
  v_add_f32 v8, v8, v12
  v_add_f32 v8, v8, v13
  v_add_f32 v8, v8, v14
  v_add_f32 v8, v8, v15
  v_mov_b32 v27, v8
  ds_read_b32 v8, v5 offset:1024
  ds_read_b32 v9, v5 offset:2816
  ds_read_b32 v10, v5 offset:4608
  ds_read_b32 v11, v5 offset:6400
  ds_read_b32 v12, v5 offset:8192
  ds_read_b32 v13, v5 offset:9984
  ds_read_b32 v14, v5 offset:11776
  ds_read_b32 v15, v5 offset:13568
  s_waitcnt lgkmcnt(0)
  v_add_f32 v8, v8, v9
  v_add_f32 v8, v8, v10
  v_add_f32 v8, v8, v11
  v_add_f32 v8, v8, v12
  v_add_f32 v8, v8, v13
  v_add_f32 v8, v8, v14
  v_add_f32 v8, v8, v15
  v_mov_b32 v28, v8
  ds_read_b32 v8, v5 offset:1280
  ds_read_b32 v9, v5 offset:3072
  ds_read_b32 v10, v5 offset:4864
  ds_read_b32 v11, v5 offset:6656
  ds_read_b32 v12, v5 offset:8448
  ds_read_b32 v13, v5 offset:10240
  ds_read_b32 v14, v5 offset:12032
  ds_read_b32 v15, v5 offset:13824
  s_waitcnt lgkmcnt(0)
  v_add_f32 v8, v8, v9
  v_add_f32 v8, v8, v10
  v_add_f32 v8, v8, v11
  v_add_f32 v8, v8, v12
  v_add_f32 v8, v8, v13
  v_add_f32 v8, v8, v14
  v_add_f32 v8, v8, v15
  v_mov_b32 v29, v8
  ds_read_b32 v8, v5 offset:1536
  ds_read_b32 v9, v5 offset:3328
  ds_read_b32 v10, v5 offset:5120
  ds_read_b32 v11, v5 offset:6912
  ds_read_b32 v12, v5 offset:8704
  ds_read_b32 v13, v5 offset:10496
  ds_read_b32 v14, v5 offset:12288
  ds_read_b32 v15, v5 offset:14080
  s_waitcnt lgkmcnt(0)
  v_add_f32 v8, v8, v9
  v_add_f32 v8, v8, v10
  v_add_f32 v8, v8, v11
  v_add_f32 v8, v8, v12
  v_add_f32 v8, v8, v13
  v_add_f32 v8, v8, v14
  v_add_f32 v8, v8, v15
  v_mov_b32 v30, v8
  s_add_u32 s16, s66, 0x2d00000
  s_addc_u32 s17, s67, 0
  s_mov_b32 s18, 0x70000
  s_mov_b32 s19, 0x20000
  s_mul_i32 s49, s58, 28672
  s_mul_i32 s50, s59, 896
  s_add_u32 s49, s49, s50
  v_add_u32 v5, 0, v2
  v_cmp_le_u32 vcc, 224, v5
  v_mov_b32 v6, 13440
  s_nop 0
  v_cndmask_b32 v6, 0, v6, vcc
  v_lshl_add_u32 v5, v5, 2, v6
  buffer_store_dword v24, v5, s[16:19], s49 offen sc1
  v_add_u32 v5, 64, v2
  v_cmp_le_u32 vcc, 224, v5
  v_mov_b32 v6, 13440
  s_nop 0
  v_cndmask_b32 v6, 0, v6, vcc
  v_lshl_add_u32 v5, v5, 2, v6
  buffer_store_dword v25, v5, s[16:19], s49 offen sc1
  v_add_u32 v5, 128, v2
  v_cmp_le_u32 vcc, 224, v5
  v_mov_b32 v6, 13440
  s_nop 0
  v_cndmask_b32 v6, 0, v6, vcc
  v_lshl_add_u32 v5, v5, 2, v6
  buffer_store_dword v26, v5, s[16:19], s49 offen sc1
  v_add_u32 v5, 192, v2
  v_cmp_le_u32 vcc, 224, v5
  v_mov_b32 v6, 13440
  s_nop 0
  v_cndmask_b32 v6, 0, v6, vcc
  v_lshl_add_u32 v5, v5, 2, v6
  buffer_store_dword v27, v5, s[16:19], s49 offen sc1
  v_add_u32 v5, 256, v2
  v_cmp_le_u32 vcc, 224, v5
  v_mov_b32 v6, 13440
  s_nop 0
  v_cndmask_b32 v6, 0, v6, vcc
  v_lshl_add_u32 v5, v5, 2, v6
  buffer_store_dword v28, v5, s[16:19], s49 offen sc1
  v_add_u32 v5, 320, v2
  v_cmp_le_u32 vcc, 224, v5
  v_mov_b32 v6, 13440
  s_nop 0
  v_cndmask_b32 v6, 0, v6, vcc
  v_lshl_add_u32 v5, v5, 2, v6
  buffer_store_dword v29, v5, s[16:19], s49 offen sc1
  v_add_u32 v5, 384, v2
  v_cmp_le_u32 vcc, 224, v5
  v_mov_b32 v6, 13440
  s_nop 0
  v_cndmask_b32 v6, 0, v6, vcc
  v_lshl_add_u32 v5, v5, 2, v6
  buffer_store_dword v30, v5, s[16:19], s49 offen sc1
  s_waitcnt vmcnt(0)
  s_add_u32 s35, s59, 40
  s_mov_b64 exec, 1
  s_lshl_b32 s33, s35, 8
  v_mov_b32 v6, s33
  v_mov_b32 v7, 1
  buffer_atomic_add v7, v6, s[28:31], 0 offen sc0 sc1
  s_waitcnt vmcnt(0)
  v_readfirstlane_b32 s33, v7
  s_nop 0
  s_cmp_lg_u32 s33, 15
  s_cbranch_scc1 main_kernel_arrub
  v_mov_b32 v7, 16
  buffer_store_dword v7, v6, s[28:31], 0 offen offset:128 sc1
main_kernel_arrub:
  s_mov_b64 exec, -1
main_kernel_wo_ubx:
  s_branch main_kernel_f1_c
main_kernel_wo_l:
  s_and_b32 s36, s2, 7
  s_lshr_b32 s37, s2, 3
  s_and_b32 s38, s36, 1
  s_lshr_b32 s39, s36, 1
  s_and_b32 s40, s37, 7
  s_lshr_b32 s41, s37, 3
  s_mul_i32 s38, s38, 8
  s_add_u32 s26, s38, s40
  s_mul_i32 s39, s39, 4
  s_add_u32 s25, s39, s41
  s_add_u32 s4, s66, 0x1100000
  s_addc_u32 s5, s67, 0
  s_mov_b32 s6, 0x400000
  s_mov_b32 s7, 0x20000
  s_mov_b32 s8, s76
  s_mov_b32 s9, s77
  s_mov_b32 s10, 0x200000
  s_mov_b32 s11, 0x20000
  s_sub_u32 s42, s24, 4
  s_lshl_b32 s43, s25, 7
  s_mul_i32 s44, s42, 32
  s_add_u32 s43, s43, s44
  v_lshrrev_b32 v3, 3, v2
  v_add_u32 v3, s43, v3
  s_mov_b32 s45, 2048
  v_mul_lo_u32 v3, s45, v3
  v_and_b32 v4, 7, v2
  v_lshrrev_b32 v5, 4, v2
  v_xor_b32 v6, 0, v5
  v_xor_b32 v6, v6, v4
  v_lshlrev_b32 v6, 4, v6
  v_add_u32 v6, v6, v3
  v_add_u32 v8, 0, v6
  v_xor_b32 v6, 4, v5
  v_xor_b32 v6, v6, v4
  v_lshlrev_b32 v6, 4, v6
  v_add_u32 v6, v6, v3
  v_add_u32 v9, 16384, v6
  v_xor_b32 v6, 0, v5
  v_xor_b32 v6, v6, v4
  v_lshlrev_b32 v6, 4, v6
  v_add_u32 v6, v6, v3
  v_add_u32 v10, 32768, v6
  v_xor_b32 v6, 4, v5
  v_xor_b32 v6, v6, v4
  v_lshlrev_b32 v6, 4, v6
  v_add_u32 v6, v6, v3
  v_add_u32 v11, 49152, v6
  s_mul_i32 s43, s42, 32768
  s_mul_i32 s44, s26, 128
  s_add_u32 s43, s43, s44
  v_add_u32 v3, 0, v2
  v_mul_u32_u24 v4, 8192, v3
  v_lshrrev_b32 v4, 16, v4
  v_mul_u32_u24 v5, 8, v4
  v_sub_u32 v3, v3, v5
  v_and_b32 v5, 2, v4
  v_lshrrev_b32 v6, 1, v4
  v_and_b32 v6, 4, v6
  v_or_b32 v5, v5, v6
  v_xor_b32 v3, v3, v5
  v_lshlrev_b32 v3, 4, v3
  s_mov_b32 s45, 2048
  v_mul_lo_u32 v4, s45, v4
  v_add_u32 v3, v3, v4
  v_add_u32 v12, s43, v3
  v_add_u32 v3, 64, v2
  v_mul_u32_u24 v4, 8192, v3
  v_lshrrev_b32 v4, 16, v4
  v_mul_u32_u24 v5, 8, v4
  v_sub_u32 v3, v3, v5
  v_and_b32 v5, 2, v4
  v_lshrrev_b32 v6, 1, v4
  v_and_b32 v6, 4, v6
  v_or_b32 v5, v5, v6
  v_xor_b32 v3, v3, v5
  v_lshlrev_b32 v3, 4, v3
  s_mov_b32 s45, 2048
  v_mul_lo_u32 v4, s45, v4
  v_add_u32 v3, v3, v4
  v_add_u32 v13, s43, v3
  s_mul_i32 s46, s42, 4096
  s_mul_i32 s47, s42, 2048
  s_add_u32 s47, s47, 16384
  s_mov_b32 s62, 0
  s_mov_b32 s63, 0
  s_lshr_b32 s35, s25, 1
  s_add_u32 s35, s35, 16
  s_cmp_eq_u32 s24, 4
  s_cbranch_scc1 main_kernel_wo_w4a
  s_add_u32 s52, s47, 0
  s_add_u32 s49, s63, 0
  s_add_u32 m0, s52, 0
  s_nop 0
  buffer_load_dwordx4 v12, s[8:11], s49 offen lds
  s_add_u32 m0, s52, 1024
  s_nop 0
  buffer_load_dwordx4 v13, s[8:11], s49 offen lds
  s_add_u32 s52, s47, 24576
  s_add_u32 s49, s63, 131072
  s_add_u32 m0, s52, 0
  s_nop 0
  buffer_load_dwordx4 v12, s[8:11], s49 offen lds
  s_add_u32 m0, s52, 1024
  s_nop 0
  buffer_load_dwordx4 v13, s[8:11], s49 offen lds
  s_add_u32 s52, s47, 49152
  s_add_u32 s49, s63, 262144
  s_add_u32 m0, s52, 0
  s_nop 0
  buffer_load_dwordx4 v12, s[8:11], s49 offen lds
  s_add_u32 m0, s52, 1024
  s_nop 0
  buffer_load_dwordx4 v13, s[8:11], s49 offen lds
  s_add_u32 s52, s47, 73728
  s_add_u32 s49, s63, 393216
  s_add_u32 m0, s52, 0
  s_nop 0
  buffer_load_dwordx4 v12, s[8:11], s49 offen lds
  s_add_u32 m0, s52, 1024
  s_nop 0
  buffer_load_dwordx4 v13, s[8:11], s49 offen lds
main_kernel_wo_w4a:
  s_cmp_lg_u32 s24, 4
  s_cbranch_scc1 main_kernel_dwwo
  s_lshr_b32 s34, s25, 1
  s_lshl_b32 s34, s34, 1
  s_lshr_b32 s33, s26, 3
  s_add_u32 s34, s34, s33
  s_lshl_b32 s34, s34, 7
  s_add_u32 s34, s34, 140800
  v_lshlrev_b32 v6, 2, v2
  v_add_u32 v6, s34, v6
  s_mov_b32 s33, 0
  s_mov_b32 exec_lo, -1
  s_mov_b32 exec_hi, 0x0
main_kernel_pollwo:
  buffer_load_dword v7, v6, s[28:31], 0 offen sc1
  s_waitcnt vmcnt(0)
  v_cmp_ne_u32 vcc, 1, v7
  s_nop 0
  s_cmp_eq_u64 vcc, 0
  s_cbranch_scc1 main_kernel_pollxwo
  s_add_u32 s33, s33, 1
  s_cmp_ge_u32 s33, 400000
  s_cbranch_scc1 main_kernel_pollxwo
  s_sleep 2
  s_branch main_kernel_pollwo
main_kernel_pollxwo:
  s_mov_b64 exec, -1
  v_mov_b32 v6, 138272
  v_mov_b32 v7, 1
  ds_write_b32 v6, v7
  s_waitcnt lgkmcnt(0)
  s_branch main_kernel_dwxwo
main_kernel_dwwo:
  v_mov_b32 v6, 138272
  s_mov_b32 s33, 0
main_kernel_dwlwo:
  ds_read_b32 v7, v6
  s_waitcnt lgkmcnt(0)
  v_readfirstlane_b32 s34, v7
  s_nop 0
  s_cmp_lg_u32 s34, 0
  s_cbranch_scc1 main_kernel_dwxwo
  s_add_u32 s33, s33, 1
  s_cmp_ge_u32 s33, 1600000
  s_cbranch_scc1 main_kernel_dwxwo
  s_sleep 1
  s_branch main_kernel_dwlwo
main_kernel_dwxwo:
  s_cmp_lg_u32 s24, 4
  s_cbranch_scc1 main_kernel_wo_w4b
  s_add_u32 s52, s47, 0
  s_add_u32 s49, s63, 0
  s_add_u32 m0, s52, 0
  s_nop 0
  buffer_load_dwordx4 v12, s[8:11], s49 offen lds
  s_add_u32 m0, s52, 1024
  s_nop 0
  buffer_load_dwordx4 v13, s[8:11], s49 offen lds
  s_add_u32 s52, s47, 24576
  s_add_u32 s49, s63, 131072
  s_add_u32 m0, s52, 0
  s_nop 0
  buffer_load_dwordx4 v12, s[8:11], s49 offen lds
  s_add_u32 m0, s52, 1024
  s_nop 0
  buffer_load_dwordx4 v13, s[8:11], s49 offen lds
  s_add_u32 s52, s47, 49152
  s_add_u32 s49, s63, 262144
  s_add_u32 m0, s52, 0
  s_nop 0
  buffer_load_dwordx4 v12, s[8:11], s49 offen lds
  s_add_u32 m0, s52, 1024
  s_nop 0
  buffer_load_dwordx4 v13, s[8:11], s49 offen lds
  s_add_u32 s52, s47, 73728
  s_add_u32 s49, s63, 393216
  s_add_u32 m0, s52, 0
  s_nop 0
  buffer_load_dwordx4 v12, s[8:11], s49 offen lds
  s_add_u32 m0, s52, 1024
  s_nop 0
  buffer_load_dwordx4 v13, s[8:11], s49 offen lds
main_kernel_wo_w4b:
  s_add_u32 s51, s46, 0
  s_add_u32 s48, s62, 0
  s_add_u32 m0, s51, 0
  s_nop 0
  buffer_load_dwordx4 v8, s[4:7], s48 offen sc1 lds
  s_add_u32 m0, s51, 1024
  s_nop 0
  buffer_load_dwordx4 v9, s[4:7], s48 offen sc1 lds
  s_add_u32 m0, s51, 2048
  s_nop 0
  buffer_load_dwordx4 v10, s[4:7], s48 offen sc1 lds
  s_add_u32 m0, s51, 3072
  s_nop 0
  buffer_load_dwordx4 v11, s[4:7], s48 offen sc1 lds
  s_add_u32 s51, s46, 24576
  s_add_u32 s48, s62, 128
  s_add_u32 m0, s51, 0
  s_nop 0
  buffer_load_dwordx4 v8, s[4:7], s48 offen sc1 lds
  s_add_u32 m0, s51, 1024
  s_nop 0
  buffer_load_dwordx4 v9, s[4:7], s48 offen sc1 lds
  s_add_u32 m0, s51, 2048
  s_nop 0
  buffer_load_dwordx4 v10, s[4:7], s48 offen sc1 lds
  s_add_u32 m0, s51, 3072
  s_nop 0
  buffer_load_dwordx4 v11, s[4:7], s48 offen sc1 lds
  s_add_u32 s51, s46, 49152
  s_add_u32 s48, s62, 256
  s_add_u32 m0, s51, 0
  s_nop 0
  buffer_load_dwordx4 v8, s[4:7], s48 offen sc1 lds
  s_add_u32 m0, s51, 1024
  s_nop 0
  buffer_load_dwordx4 v9, s[4:7], s48 offen sc1 lds
  s_add_u32 m0, s51, 2048
  s_nop 0
  buffer_load_dwordx4 v10, s[4:7], s48 offen sc1 lds
  s_add_u32 m0, s51, 3072
  s_nop 0
  buffer_load_dwordx4 v11, s[4:7], s48 offen sc1 lds
  s_add_u32 s51, s46, 73728
  s_add_u32 s48, s62, 384
  s_add_u32 m0, s51, 0
  s_nop 0
  buffer_load_dwordx4 v8, s[4:7], s48 offen sc1 lds
  s_add_u32 m0, s51, 1024
  s_nop 0
  buffer_load_dwordx4 v9, s[4:7], s48 offen sc1 lds
  s_add_u32 m0, s51, 2048
  s_nop 0
  buffer_load_dwordx4 v10, s[4:7], s48 offen sc1 lds
  s_add_u32 m0, s51, 3072
  s_nop 0
  buffer_load_dwordx4 v11, s[4:7], s48 offen sc1 lds
  s_add_u32 s48, s62, 512
  s_add_u32 s49, s63, 524288
  s_mov_b32 s50, 98304
  s_waitcnt vmcnt(12)
  s_barrier
  s_add_u32 s51, s50, s46
  s_add_u32 s52, s50, s47
  s_add_u32 m0, s51, 0
  s_nop 0
  buffer_load_dwordx4 v8, s[4:7], s48 offen sc1 lds
  s_add_u32 m0, s51, 1024
  s_nop 0
  buffer_load_dwordx4 v9, s[4:7], s48 offen sc1 lds
  s_add_u32 m0, s51, 2048
  s_nop 0
  buffer_load_dwordx4 v10, s[4:7], s48 offen sc1 lds
  s_add_u32 m0, s51, 3072
  s_nop 0
  buffer_load_dwordx4 v11, s[4:7], s48 offen sc1 lds
  s_add_u32 m0, s52, 0
  s_nop 0
  buffer_load_dwordx4 v12, s[8:11], s49 offen lds
  s_add_u32 m0, s52, 1024
  s_nop 0
  buffer_load_dwordx4 v13, s[8:11], s49 offen lds
  s_add_u32 s48, s48, 128
  s_add_u32 s49, s49, 131072
  s_add_u32 s50, s50, 24576
  s_cmp_eq_u32 s50, 122880
  s_cselect_b32 s50, 0, s50
  s_waitcnt vmcnt(14)
  s_barrier
  s_add_u32 s51, s50, s46
  s_add_u32 s52, s50, s47
  s_add_u32 m0, s51, 0
  s_nop 0
  buffer_load_dwordx4 v8, s[4:7], s48 offen sc1 lds
  s_add_u32 m0, s51, 1024
  s_nop 0
  buffer_load_dwordx4 v9, s[4:7], s48 offen sc1 lds
  s_add_u32 m0, s51, 2048
  s_nop 0
  buffer_load_dwordx4 v10, s[4:7], s48 offen sc1 lds
  s_add_u32 m0, s51, 3072
  s_nop 0
  buffer_load_dwordx4 v11, s[4:7], s48 offen sc1 lds
  s_add_u32 m0, s52, 0
  s_nop 0
  buffer_load_dwordx4 v12, s[8:11], s49 offen lds
  s_add_u32 m0, s52, 1024
  s_nop 0
  buffer_load_dwordx4 v13, s[8:11], s49 offen lds
  s_add_u32 s48, s48, 128
  s_add_u32 s49, s49, 131072
  s_add_u32 s50, s50, 24576
  s_cmp_eq_u32 s50, 122880
  s_cselect_b32 s50, 0, s50
  s_waitcnt vmcnt(16)
  s_barrier
  s_add_u32 s51, s50, s46
  s_add_u32 s52, s50, s47
  s_add_u32 m0, s51, 0
  s_nop 0
  buffer_load_dwordx4 v8, s[4:7], s48 offen sc1 lds
  s_add_u32 m0, s51, 1024
  s_nop 0
  buffer_load_dwordx4 v9, s[4:7], s48 offen sc1 lds
  s_add_u32 m0, s51, 2048
  s_nop 0
  buffer_load_dwordx4 v10, s[4:7], s48 offen sc1 lds
  s_add_u32 m0, s51, 3072
  s_nop 0
  buffer_load_dwordx4 v11, s[4:7], s48 offen sc1 lds
  s_add_u32 m0, s52, 0
  s_nop 0
  buffer_load_dwordx4 v12, s[8:11], s49 offen lds
  s_add_u32 m0, s52, 1024
  s_nop 0
  buffer_load_dwordx4 v13, s[8:11], s49 offen lds
  s_add_u32 s48, s48, 128
  s_add_u32 s49, s49, 131072
  s_add_u32 s50, s50, 24576
  s_cmp_eq_u32 s50, 122880
  s_cselect_b32 s50, 0, s50
  s_waitcnt vmcnt(18)
  s_barrier
  s_add_u32 s51, s50, s46
  s_add_u32 s52, s50, s47
  s_add_u32 m0, s51, 0
  s_nop 0
  buffer_load_dwordx4 v8, s[4:7], s48 offen sc1 lds
  s_add_u32 m0, s51, 1024
  s_nop 0
  buffer_load_dwordx4 v9, s[4:7], s48 offen sc1 lds
  s_add_u32 m0, s51, 2048
  s_nop 0
  buffer_load_dwordx4 v10, s[4:7], s48 offen sc1 lds
  s_add_u32 m0, s51, 3072
  s_nop 0
  buffer_load_dwordx4 v11, s[4:7], s48 offen sc1 lds
  s_add_u32 m0, s52, 0
  s_nop 0
  buffer_load_dwordx4 v12, s[8:11], s49 offen lds
  s_add_u32 m0, s52, 1024
  s_nop 0
  buffer_load_dwordx4 v13, s[8:11], s49 offen lds
  s_add_u32 s48, s48, 128
  s_add_u32 s49, s49, 131072
  s_add_u32 s50, s50, 24576
  s_cmp_eq_u32 s50, 122880
  s_cselect_b32 s50, 0, s50
  s_mov_b32 s53, 8
main_kernel_wo_lloop:
  s_waitcnt vmcnt(18)
  s_barrier
  s_add_u32 s51, s50, s46
  s_add_u32 s52, s50, s47
  s_add_u32 m0, s51, 0
  s_nop 0
  buffer_load_dwordx4 v8, s[4:7], s48 offen sc1 lds
  s_add_u32 m0, s51, 1024
  s_nop 0
  buffer_load_dwordx4 v9, s[4:7], s48 offen sc1 lds
  s_add_u32 m0, s51, 2048
  s_nop 0
  buffer_load_dwordx4 v10, s[4:7], s48 offen sc1 lds
  s_add_u32 m0, s51, 3072
  s_nop 0
  buffer_load_dwordx4 v11, s[4:7], s48 offen sc1 lds
  s_add_u32 m0, s52, 0
  s_nop 0
  buffer_load_dwordx4 v12, s[8:11], s49 offen lds
  s_add_u32 m0, s52, 1024
  s_nop 0
  buffer_load_dwordx4 v13, s[8:11], s49 offen lds
  s_add_u32 s48, s48, 128
  s_add_u32 s49, s49, 131072
  s_add_u32 s50, s50, 24576
  s_cmp_eq_u32 s50, 122880
  s_cselect_b32 s50, 0, s50
  s_sub_u32 s53, s53, 1
  s_cmp_lg_u32 s53, 0
  s_cbranch_scc1 main_kernel_wo_lloop
  s_waitcnt vmcnt(18)
  s_barrier
  s_waitcnt vmcnt(12)
  s_barrier
  s_waitcnt vmcnt(6)
  s_barrier
  s_waitcnt vmcnt(0)
  s_barrier
  s_barrier
  s_branch main_kernel_f1_l
main_kernel_f1_c:
  s_and_b32 s36, s2, 7
  s_lshr_b32 s37, s2, 3
  s_and_b32 s38, s36, 3
  s_lshr_b32 s39, s36, 2
  s_and_b32 s40, s37, 3
  s_lshr_b32 s41, s37, 2
  s_mul_i32 s38, s38, 4
  s_add_u32 s26, s38, s40
  s_mul_i32 s39, s39, 8
  s_add_u32 s25, s39, s41
  s_lshr_b32 s42, s24, 1
  s_and_b32 s43, s24, 1
  v_and_b32 v3, 15, v2
  v_lshrrev_b32 v4, 4, v2
  s_lshl_b32 s44, s25, 7
  s_lshl_b32 s45, s42, 6
  s_add_u32 s44, s44, s45
  s_mul_i32 s46, s26, 224
  s_mul_i32 s45, s43, 112
  s_add_u32 s46, s46, s45
  s_add_u32 s20, s66, 0x20000
  s_addc_u32 s21, s67, 0
  s_mov_b32 s22, 0x6000
  s_mov_b32 s23, 0x20000
  s_add_u32 s12, s66, 0x1900000
  s_addc_u32 s13, s67, 0
  s_mov_b32 s14, 0xe00000
  s_mov_b32 s15, 0x20000
  v_lshrrev_b32 v5, 1, v3
  v_xor_b32 v5, v5, v4
  v_and_b32 v5, 7, v5
  v_lshlrev_b32 v5, 4, v5
  s_lshl_b32 s47, s42, 6
  v_add_u32 v6, s47, v3
  v_lshlrev_b32 v6, 7, v6
  v_add_u32 v208, v5, v6
  v_xor_b32 v209, 64, v208
  v_lshrrev_b32 v5, 2, v3
  v_and_b32 v6, 3, v2
  v_lshlrev_b32 v7, 3, v4
  v_add_u32 v7, v7, v5
  v_mul_u32_u24 v7, 448, v7
  v_lshlrev_b32 v6, 3, v6
  v_add_u32 v7, v7, v6
  v_add_u32 v7, 16384, v7
  v_and_b32 v5, 1, v4
  s_mul_i32 s47, s43, 7
  s_add_u32 s48, s47, 0
  v_xor_b32 v6, s48, v5
  v_lshlrev_b32 v6, 5, v6
  v_add_u32 v210, v7, v6
  s_add_u32 s48, s47, 1
  v_xor_b32 v6, s48, v5
  v_lshlrev_b32 v6, 5, v6
  v_add_u32 v211, v7, v6
  s_add_u32 s48, s47, 2
  v_xor_b32 v6, s48, v5
  v_lshlrev_b32 v6, 5, v6
  v_add_u32 v212, v7, v6
  s_add_u32 s48, s47, 3
  v_xor_b32 v6, s48, v5
  v_lshlrev_b32 v6, 5, v6
  v_add_u32 v213, v7, v6
  s_add_u32 s48, s47, 4
  v_xor_b32 v6, s48, v5
  v_lshlrev_b32 v6, 5, v6
  v_add_u32 v214, v7, v6
  s_add_u32 s48, s47, 5
  v_xor_b32 v6, s48, v5
  v_lshlrev_b32 v6, 5, v6
  v_add_u32 v215, v7, v6
  s_add_u32 s48, s47, 6
  v_xor_b32 v6, s48, v5
  v_lshlrev_b32 v6, 5, v6
  v_add_u32 v216, v7, v6
  v_mov_b32 v8, 0
  v_mov_b32 v9, 0
  v_mov_b32 v10, 0
  v_mov_b32 v11, 0
  v_mov_b32 v12, 0
  v_mov_b32 v13, 0
  v_mov_b32 v14, 0
  v_mov_b32 v15, 0
  v_mov_b32 v16, 0
  v_mov_b32 v17, 0
  v_mov_b32 v18, 0
  v_mov_b32 v19, 0
  v_mov_b32 v20, 0
  v_mov_b32 v21, 0
  v_mov_b32 v22, 0
  v_mov_b32 v23, 0
  v_mov_b32 v24, 0
  v_mov_b32 v25, 0
  v_mov_b32 v26, 0
  v_mov_b32 v27, 0
  v_mov_b32 v28, 0
  v_mov_b32 v29, 0
  v_mov_b32 v30, 0
  v_mov_b32 v31, 0
  v_mov_b32 v32, 0
  v_mov_b32 v33, 0
  v_mov_b32 v34, 0
  v_mov_b32 v35, 0
  v_mov_b32 v36, 0
  v_mov_b32 v37, 0
  v_mov_b32 v38, 0
  v_mov_b32 v39, 0
  v_mov_b32 v40, 0
  v_mov_b32 v41, 0
  v_mov_b32 v42, 0
  v_mov_b32 v43, 0
  v_mov_b32 v44, 0
  v_mov_b32 v45, 0
  v_mov_b32 v46, 0
  v_mov_b32 v47, 0
  v_mov_b32 v48, 0
  v_mov_b32 v49, 0
  v_mov_b32 v50, 0
  v_mov_b32 v51, 0
  v_mov_b32 v52, 0
  v_mov_b32 v53, 0
  v_mov_b32 v54, 0
  v_mov_b32 v55, 0
  v_mov_b32 v56, 0
  v_mov_b32 v57, 0
  v_mov_b32 v58, 0
  v_mov_b32 v59, 0
  v_mov_b32 v60, 0
  v_mov_b32 v61, 0
  v_mov_b32 v62, 0
  v_mov_b32 v63, 0
  v_mov_b32 v64, 0
  v_mov_b32 v65, 0
  v_mov_b32 v66, 0
  v_mov_b32 v67, 0
  v_mov_b32 v68, 0
  v_mov_b32 v69, 0
  v_mov_b32 v70, 0
  v_mov_b32 v71, 0
  v_mov_b32 v72, 0
  v_mov_b32 v73, 0
  v_mov_b32 v74, 0
  v_mov_b32 v75, 0
  v_mov_b32 v76, 0
  v_mov_b32 v77, 0
  v_mov_b32 v78, 0
  v_mov_b32 v79, 0
  v_mov_b32 v80, 0
  v_mov_b32 v81, 0
  v_mov_b32 v82, 0
  v_mov_b32 v83, 0
  v_mov_b32 v84, 0
  v_mov_b32 v85, 0
  v_mov_b32 v86, 0
  v_mov_b32 v87, 0
  v_mov_b32 v88, 0
  v_mov_b32 v89, 0
  v_mov_b32 v90, 0
  v_mov_b32 v91, 0
  v_mov_b32 v92, 0
  v_mov_b32 v93, 0
  v_mov_b32 v94, 0
  v_mov_b32 v95, 0
  v_mov_b32 v96, 0
  v_mov_b32 v97, 0
  v_mov_b32 v98, 0
  v_mov_b32 v99, 0
  v_mov_b32 v100, 0
  v_mov_b32 v101, 0
  v_mov_b32 v102, 0
  v_mov_b32 v103, 0
  v_mov_b32 v104, 0
  v_mov_b32 v105, 0
  v_mov_b32 v106, 0
  v_mov_b32 v107, 0
  v_mov_b32 v108, 0
  v_mov_b32 v109, 0
  v_mov_b32 v110, 0
  v_mov_b32 v111, 0
  v_mov_b32 v112, 0
  v_mov_b32 v113, 0
  v_mov_b32 v114, 0
  v_mov_b32 v115, 0
  v_mov_b32 v116, 0
  v_mov_b32 v117, 0
  v_mov_b32 v118, 0
  v_mov_b32 v119, 0
  s_mov_b32 s49, 0
  s_mov_b32 s54, 45056
  s_mov_b32 s55, 0xfffea000
  s_barrier
  ds_read_b128 v[120:123], v208 offset:0
  ds_read_b64_tr_b16 v[136:137], v210 offset:0
  ds_read_b64_tr_b16 v[138:139], v210 offset:1792
  ds_read_b128 v[124:127], v208 offset:2048
  ds_read_b128 v[128:131], v208 offset:4096
  ds_read_b128 v[132:135], v208 offset:6144
  ds_read_b64_tr_b16 v[140:141], v211 offset:0
  ds_read_b64_tr_b16 v[142:143], v211 offset:1792
  ds_read_b64_tr_b16 v[144:145], v212 offset:0
  ds_read_b64_tr_b16 v[146:147], v212 offset:1792
  ds_read_b64_tr_b16 v[148:149], v213 offset:0
  ds_read_b64_tr_b16 v[150:151], v213 offset:1792
  ds_read_b64_tr_b16 v[152:153], v214 offset:0
  ds_read_b64_tr_b16 v[154:155], v214 offset:1792
  ds_read_b64_tr_b16 v[156:157], v215 offset:0
  ds_read_b64_tr_b16 v[158:159], v215 offset:1792
  ds_read_b64_tr_b16 v[160:161], v216 offset:0
  ds_read_b64_tr_b16 v[162:163], v216 offset:1792
  s_mov_b32 s50, 15
.p2align 6
main_kernel_f1_cloop:
  s_waitcnt lgkmcnt(0)
  v_mfma_f32_16x16x32_bf16 v[8:11], v[136:139], v[120:123], v[8:11]
  s_add_u32 s49, s49, 1
  ds_read_b128 v[164:167], v209 offset:0
  v_mfma_f32_16x16x32_bf16 v[12:15], v[140:143], v[120:123], v[12:15]
  s_cmp_eq_u32 s49, 3
  ds_read_b64_tr_b16 v[180:181], v210 offset:14336
  v_mfma_f32_16x16x32_bf16 v[16:19], v[144:147], v[120:123], v[16:19]
  s_cselect_b32 s51, s55, s54
  ds_read_b64_tr_b16 v[182:183], v210 offset:16128
  v_mfma_f32_16x16x32_bf16 v[20:23], v[148:151], v[120:123], v[20:23]
  s_cselect_b32 s49, 0, s49
  ds_read_b128 v[168:171], v209 offset:2048
  v_mfma_f32_16x16x32_bf16 v[24:27], v[152:155], v[120:123], v[24:27]
  ds_read_b128 v[172:175], v209 offset:4096
  v_mfma_f32_16x16x32_bf16 v[28:31], v[156:159], v[120:123], v[28:31]
  ds_read_b128 v[176:179], v209 offset:6144
  v_mfma_f32_16x16x32_bf16 v[32:35], v[160:163], v[120:123], v[32:35]
  ds_read_b64_tr_b16 v[184:185], v211 offset:14336
  v_mfma_f32_16x16x32_bf16 v[36:39], v[136:139], v[124:127], v[36:39]
  ds_read_b64_tr_b16 v[186:187], v211 offset:16128
  v_mfma_f32_16x16x32_bf16 v[40:43], v[140:143], v[124:127], v[40:43]
  ds_read_b64_tr_b16 v[188:189], v212 offset:14336
  v_mfma_f32_16x16x32_bf16 v[44:47], v[144:147], v[124:127], v[44:47]
  ds_read_b64_tr_b16 v[190:191], v212 offset:16128
  v_mfma_f32_16x16x32_bf16 v[48:51], v[148:151], v[124:127], v[48:51]
  ds_read_b64_tr_b16 v[192:193], v213 offset:14336
  v_mfma_f32_16x16x32_bf16 v[52:55], v[152:155], v[124:127], v[52:55]
  ds_read_b64_tr_b16 v[194:195], v213 offset:16128
  v_mfma_f32_16x16x32_bf16 v[56:59], v[156:159], v[124:127], v[56:59]
  ds_read_b64_tr_b16 v[196:197], v214 offset:14336
  v_mfma_f32_16x16x32_bf16 v[60:63], v[160:163], v[124:127], v[60:63]
  ds_read_b64_tr_b16 v[198:199], v214 offset:16128
  v_mfma_f32_16x16x32_bf16 v[64:67], v[136:139], v[128:131], v[64:67]
  ds_read_b64_tr_b16 v[200:201], v215 offset:14336
  v_mfma_f32_16x16x32_bf16 v[68:71], v[140:143], v[128:131], v[68:71]
  ds_read_b64_tr_b16 v[202:203], v215 offset:16128
  v_mfma_f32_16x16x32_bf16 v[72:75], v[144:147], v[128:131], v[72:75]
  ds_read_b64_tr_b16 v[204:205], v216 offset:14336
  v_mfma_f32_16x16x32_bf16 v[76:79], v[148:151], v[128:131], v[76:79]
  ds_read_b64_tr_b16 v[206:207], v216 offset:16128
  v_mfma_f32_16x16x32_bf16 v[80:83], v[152:155], v[128:131], v[80:83]
  v_add_u32 v208, s51, v208
  v_mfma_f32_16x16x32_bf16 v[84:87], v[156:159], v[128:131], v[84:87]
  v_add_u32 v209, s51, v209
  v_mfma_f32_16x16x32_bf16 v[88:91], v[160:163], v[128:131], v[88:91]
  v_add_u32 v210, s51, v210
  v_mfma_f32_16x16x32_bf16 v[92:95], v[136:139], v[132:135], v[92:95]
  v_add_u32 v211, s51, v211
  v_mfma_f32_16x16x32_bf16 v[96:99], v[140:143], v[132:135], v[96:99]
  v_add_u32 v212, s51, v212
  v_mfma_f32_16x16x32_bf16 v[100:103], v[144:147], v[132:135], v[100:103]
  v_add_u32 v213, s51, v213
  v_mfma_f32_16x16x32_bf16 v[104:107], v[148:151], v[132:135], v[104:107]
  v_add_u32 v214, s51, v214
  v_mfma_f32_16x16x32_bf16 v[108:111], v[152:155], v[132:135], v[108:111]
  v_add_u32 v215, s51, v215
  v_mfma_f32_16x16x32_bf16 v[112:115], v[156:159], v[132:135], v[112:115]
  v_add_u32 v216, s51, v216
  v_mfma_f32_16x16x32_bf16 v[116:119], v[160:163], v[132:135], v[116:119]
  s_waitcnt lgkmcnt(0)
  s_barrier
  v_mfma_f32_16x16x32_bf16 v[8:11], v[180:183], v[164:167], v[8:11]
  ds_read_b128 v[120:123], v208 offset:0
  v_mfma_f32_16x16x32_bf16 v[12:15], v[184:187], v[164:167], v[12:15]
  s_sub_u32 s50, s50, 1
  ds_read_b64_tr_b16 v[136:137], v210 offset:0
  v_mfma_f32_16x16x32_bf16 v[16:19], v[188:191], v[164:167], v[16:19]
  s_cmp_lg_u32 s50, 0
  ds_read_b64_tr_b16 v[138:139], v210 offset:1792
  v_mfma_f32_16x16x32_bf16 v[20:23], v[192:195], v[164:167], v[20:23]
  ds_read_b128 v[124:127], v208 offset:2048
  v_mfma_f32_16x16x32_bf16 v[24:27], v[196:199], v[164:167], v[24:27]
  ds_read_b128 v[128:131], v208 offset:4096
  v_mfma_f32_16x16x32_bf16 v[28:31], v[200:203], v[164:167], v[28:31]
  ds_read_b128 v[132:135], v208 offset:6144
  v_mfma_f32_16x16x32_bf16 v[32:35], v[204:207], v[164:167], v[32:35]
  ds_read_b64_tr_b16 v[140:141], v211 offset:0
  v_mfma_f32_16x16x32_bf16 v[36:39], v[180:183], v[168:171], v[36:39]
  ds_read_b64_tr_b16 v[142:143], v211 offset:1792
  v_mfma_f32_16x16x32_bf16 v[40:43], v[184:187], v[168:171], v[40:43]
  ds_read_b64_tr_b16 v[144:145], v212 offset:0
  v_mfma_f32_16x16x32_bf16 v[44:47], v[188:191], v[168:171], v[44:47]
  ds_read_b64_tr_b16 v[146:147], v212 offset:1792
  v_mfma_f32_16x16x32_bf16 v[48:51], v[192:195], v[168:171], v[48:51]
  ds_read_b64_tr_b16 v[148:149], v213 offset:0
  v_mfma_f32_16x16x32_bf16 v[52:55], v[196:199], v[168:171], v[52:55]
  ds_read_b64_tr_b16 v[150:151], v213 offset:1792
  v_mfma_f32_16x16x32_bf16 v[56:59], v[200:203], v[168:171], v[56:59]
  ds_read_b64_tr_b16 v[152:153], v214 offset:0
  v_mfma_f32_16x16x32_bf16 v[60:63], v[204:207], v[168:171], v[60:63]
  ds_read_b64_tr_b16 v[154:155], v214 offset:1792
  v_mfma_f32_16x16x32_bf16 v[64:67], v[180:183], v[172:175], v[64:67]
  ds_read_b64_tr_b16 v[156:157], v215 offset:0
  v_mfma_f32_16x16x32_bf16 v[68:71], v[184:187], v[172:175], v[68:71]
  ds_read_b64_tr_b16 v[158:159], v215 offset:1792
  v_mfma_f32_16x16x32_bf16 v[72:75], v[188:191], v[172:175], v[72:75]
  ds_read_b64_tr_b16 v[160:161], v216 offset:0
  v_mfma_f32_16x16x32_bf16 v[76:79], v[192:195], v[172:175], v[76:79]
  ds_read_b64_tr_b16 v[162:163], v216 offset:1792
  v_mfma_f32_16x16x32_bf16 v[80:83], v[196:199], v[172:175], v[80:83]
  v_mfma_f32_16x16x32_bf16 v[84:87], v[200:203], v[172:175], v[84:87]
  v_mfma_f32_16x16x32_bf16 v[88:91], v[204:207], v[172:175], v[88:91]
  v_mfma_f32_16x16x32_bf16 v[92:95], v[180:183], v[176:179], v[92:95]
  v_mfma_f32_16x16x32_bf16 v[96:99], v[184:187], v[176:179], v[96:99]
  v_mfma_f32_16x16x32_bf16 v[100:103], v[188:191], v[176:179], v[100:103]
  v_mfma_f32_16x16x32_bf16 v[104:107], v[192:195], v[176:179], v[104:107]
  v_mfma_f32_16x16x32_bf16 v[108:111], v[196:199], v[176:179], v[108:111]
  v_mfma_f32_16x16x32_bf16 v[112:115], v[200:203], v[176:179], v[112:115]
  v_mfma_f32_16x16x32_bf16 v[116:119], v[204:207], v[176:179], v[116:119]
  s_cbranch_scc1 main_kernel_f1_cloop
  s_waitcnt lgkmcnt(0)
  v_mfma_f32_16x16x32_bf16 v[8:11], v[136:139], v[120:123], v[8:11]
  ds_read_b128 v[164:167], v209 offset:0
  v_mfma_f32_16x16x32_bf16 v[12:15], v[140:143], v[120:123], v[12:15]
  ds_read_b64_tr_b16 v[180:181], v210 offset:14336
  v_mfma_f32_16x16x32_bf16 v[16:19], v[144:147], v[120:123], v[16:19]
  ds_read_b64_tr_b16 v[182:183], v210 offset:16128
  v_mfma_f32_16x16x32_bf16 v[20:23], v[148:151], v[120:123], v[20:23]
  ds_read_b128 v[168:171], v209 offset:2048
  v_mfma_f32_16x16x32_bf16 v[24:27], v[152:155], v[120:123], v[24:27]
  ds_read_b128 v[172:175], v209 offset:4096
  v_mfma_f32_16x16x32_bf16 v[28:31], v[156:159], v[120:123], v[28:31]
  ds_read_b128 v[176:179], v209 offset:6144
  v_mfma_f32_16x16x32_bf16 v[32:35], v[160:163], v[120:123], v[32:35]
  ds_read_b64_tr_b16 v[184:185], v211 offset:14336
  v_mfma_f32_16x16x32_bf16 v[36:39], v[136:139], v[124:127], v[36:39]
  ds_read_b64_tr_b16 v[186:187], v211 offset:16128
  v_mfma_f32_16x16x32_bf16 v[40:43], v[140:143], v[124:127], v[40:43]
  ds_read_b64_tr_b16 v[188:189], v212 offset:14336
  v_mfma_f32_16x16x32_bf16 v[44:47], v[144:147], v[124:127], v[44:47]
  ds_read_b64_tr_b16 v[190:191], v212 offset:16128
  v_mfma_f32_16x16x32_bf16 v[48:51], v[148:151], v[124:127], v[48:51]
  ds_read_b64_tr_b16 v[192:193], v213 offset:14336
  v_mfma_f32_16x16x32_bf16 v[52:55], v[152:155], v[124:127], v[52:55]
  ds_read_b64_tr_b16 v[194:195], v213 offset:16128
  v_mfma_f32_16x16x32_bf16 v[56:59], v[156:159], v[124:127], v[56:59]
  ds_read_b64_tr_b16 v[196:197], v214 offset:14336
  v_mfma_f32_16x16x32_bf16 v[60:63], v[160:163], v[124:127], v[60:63]
  ds_read_b64_tr_b16 v[198:199], v214 offset:16128
  v_mfma_f32_16x16x32_bf16 v[64:67], v[136:139], v[128:131], v[64:67]
  ds_read_b64_tr_b16 v[200:201], v215 offset:14336
  v_mfma_f32_16x16x32_bf16 v[68:71], v[140:143], v[128:131], v[68:71]
  ds_read_b64_tr_b16 v[202:203], v215 offset:16128
  v_mfma_f32_16x16x32_bf16 v[72:75], v[144:147], v[128:131], v[72:75]
  ds_read_b64_tr_b16 v[204:205], v216 offset:14336
  v_mfma_f32_16x16x32_bf16 v[76:79], v[148:151], v[128:131], v[76:79]
  ds_read_b64_tr_b16 v[206:207], v216 offset:16128
  v_mfma_f32_16x16x32_bf16 v[80:83], v[152:155], v[128:131], v[80:83]
  v_mfma_f32_16x16x32_bf16 v[84:87], v[156:159], v[128:131], v[84:87]
  v_mfma_f32_16x16x32_bf16 v[88:91], v[160:163], v[128:131], v[88:91]
  v_mfma_f32_16x16x32_bf16 v[92:95], v[136:139], v[132:135], v[92:95]
  v_mfma_f32_16x16x32_bf16 v[96:99], v[140:143], v[132:135], v[96:99]
  v_mfma_f32_16x16x32_bf16 v[100:103], v[144:147], v[132:135], v[100:103]
  v_mfma_f32_16x16x32_bf16 v[104:107], v[148:151], v[132:135], v[104:107]
  v_mfma_f32_16x16x32_bf16 v[108:111], v[152:155], v[132:135], v[108:111]
  v_mfma_f32_16x16x32_bf16 v[112:115], v[156:159], v[132:135], v[112:115]
  v_mfma_f32_16x16x32_bf16 v[116:119], v[160:163], v[132:135], v[116:119]
  s_waitcnt lgkmcnt(0)
  s_barrier
  v_mfma_f32_16x16x32_bf16 v[8:11], v[180:183], v[164:167], v[8:11]
  v_mfma_f32_16x16x32_bf16 v[12:15], v[184:187], v[164:167], v[12:15]
  v_mfma_f32_16x16x32_bf16 v[16:19], v[188:191], v[164:167], v[16:19]
  v_mfma_f32_16x16x32_bf16 v[20:23], v[192:195], v[164:167], v[20:23]
  v_mfma_f32_16x16x32_bf16 v[24:27], v[196:199], v[164:167], v[24:27]
  v_mfma_f32_16x16x32_bf16 v[28:31], v[200:203], v[164:167], v[28:31]
  v_mfma_f32_16x16x32_bf16 v[32:35], v[204:207], v[164:167], v[32:35]
  v_mfma_f32_16x16x32_bf16 v[36:39], v[180:183], v[168:171], v[36:39]
  v_mfma_f32_16x16x32_bf16 v[40:43], v[184:187], v[168:171], v[40:43]
  v_mfma_f32_16x16x32_bf16 v[44:47], v[188:191], v[168:171], v[44:47]
  v_mfma_f32_16x16x32_bf16 v[48:51], v[192:195], v[168:171], v[48:51]
  v_mfma_f32_16x16x32_bf16 v[52:55], v[196:199], v[168:171], v[52:55]
  v_mfma_f32_16x16x32_bf16 v[56:59], v[200:203], v[168:171], v[56:59]
  v_mfma_f32_16x16x32_bf16 v[60:63], v[204:207], v[168:171], v[60:63]
  v_mfma_f32_16x16x32_bf16 v[64:67], v[180:183], v[172:175], v[64:67]
  v_mfma_f32_16x16x32_bf16 v[68:71], v[184:187], v[172:175], v[68:71]
  v_mfma_f32_16x16x32_bf16 v[72:75], v[188:191], v[172:175], v[72:75]
  v_mfma_f32_16x16x32_bf16 v[76:79], v[192:195], v[172:175], v[76:79]
  v_mfma_f32_16x16x32_bf16 v[80:83], v[196:199], v[172:175], v[80:83]
  v_mfma_f32_16x16x32_bf16 v[84:87], v[200:203], v[172:175], v[84:87]
  v_mfma_f32_16x16x32_bf16 v[88:91], v[204:207], v[172:175], v[88:91]
  v_mfma_f32_16x16x32_bf16 v[92:95], v[180:183], v[176:179], v[92:95]
  v_mfma_f32_16x16x32_bf16 v[96:99], v[184:187], v[176:179], v[96:99]
  v_mfma_f32_16x16x32_bf16 v[100:103], v[188:191], v[176:179], v[100:103]
  v_mfma_f32_16x16x32_bf16 v[104:107], v[192:195], v[176:179], v[104:107]
  v_mfma_f32_16x16x32_bf16 v[108:111], v[196:199], v[176:179], v[108:111]
  v_mfma_f32_16x16x32_bf16 v[112:115], v[200:203], v[176:179], v[112:115]
  v_mfma_f32_16x16x32_bf16 v[116:119], v[204:207], v[176:179], v[116:119]
  v_and_b32 v5, 1, v4
  v_lshlrev_b32 v5, 5, v5
  v_lshrrev_b32 v6, 1, v4
  v_lshlrev_b32 v6, 4, v6
  v_add_u32 v5, v5, v6
  s_lshl_b32 s47, s42, 6
  v_add_u32 v6, s47, v3
  v_lshlrev_b32 v6, 3, v6
  v_add_u32 v6, 135168, v6
  ds_read_b64 v[120:121], v6 offset:0
  ds_read_b64 v[122:123], v6 offset:128
  ds_read_b64 v[124:125], v6 offset:256
  ds_read_b64 v[126:127], v6 offset:384
  s_mul_i32 s47, s43, 448
  s_add_u32 s47, s47, 136192
  v_lshlrev_b32 v7, 4, v4
  v_add_u32 v7, s47, v7
  ds_read_b128 v[128:131], v7 offset:0
  ds_read_b128 v[156:159], v7 offset:896
  ds_read_b128 v[132:135], v7 offset:64
  ds_read_b128 v[160:163], v7 offset:960
  ds_read_b128 v[136:139], v7 offset:128
  ds_read_b128 v[164:167], v7 offset:1024
  ds_read_b128 v[140:143], v7 offset:192
  ds_read_b128 v[168:171], v7 offset:1088
  ds_read_b128 v[144:147], v7 offset:256
  ds_read_b128 v[172:175], v7 offset:1152
  ds_read_b128 v[148:151], v7 offset:320
  ds_read_b128 v[176:179], v7 offset:1216
  ds_read_b128 v[152:155], v7 offset:384
  ds_read_b128 v[180:183], v7 offset:1280
  s_lshl_b32 s47, s42, 6
  v_add_u32 v6, s47, v3
  v_lshlrev_b32 v6, 6, v6
  v_lshrrev_b32 v7, 1, v4
  v_lshlrev_b32 v7, 4, v7
  v_add_u32 v6, v6, v7
  v_and_b32 v7, 1, v4
  v_lshlrev_b32 v5, 5, v7
  v_add_u32 v5, v5, v6
  v_lshlrev_b32 v7, 10, v7
  v_add_u32 v6, v6, v7
  s_lshl_b32 s47, s43, 5
  v_add_u32 v6, s47, v6
  s_mul_i32 s48, s25, 112
  s_mul_i32 s47, s26, 7
  s_add_u32 s48, s48, s47
  s_lshl_b32 s48, s48, 13
  s_add_u32 s53, s48, 24576
  s_waitcnt lgkmcnt(0)
  s_lshl_b32 s47, s24, 10
  v_lshlrev_b32 v7, 4, v2
  v_add_u32 v7, s47, v7
  v_add_u32 v7, 139264, v7
  s_cmp_eq_u32 s43, 1
  s_cbranch_scc1 main_kernel_f1_ep1
  v_pk_fma_f32 v[184:185], v[120:121], v[152:153], v[180:181] op_sel_hi:[0,1,1] neg_lo:[1,0,0] neg_hi:[1,0,0]
  v_pk_fma_f32 v[186:187], v[120:121], v[154:155], v[182:183] op_sel_hi:[0,1,1] neg_lo:[1,0,0] neg_hi:[1,0,0]
  v_pk_fma_f32 v[32:33], v[32:33], v[120:121], v[184:185] op_sel:[0,1,0]
  v_pk_fma_f32 v[34:35], v[34:35], v[120:121], v[186:187] op_sel:[0,1,0]
  v_pk_fma_f32 v[188:189], v[122:123], v[152:153], v[180:181] op_sel_hi:[0,1,1] neg_lo:[1,0,0] neg_hi:[1,0,0]
  v_pk_fma_f32 v[190:191], v[122:123], v[154:155], v[182:183] op_sel_hi:[0,1,1] neg_lo:[1,0,0] neg_hi:[1,0,0]
  v_pk_fma_f32 v[60:61], v[60:61], v[122:123], v[188:189] op_sel:[0,1,0]
  v_pk_fma_f32 v[62:63], v[62:63], v[122:123], v[190:191] op_sel:[0,1,0]
  v_pk_fma_f32 v[184:185], v[124:125], v[152:153], v[180:181] op_sel_hi:[0,1,1] neg_lo:[1,0,0] neg_hi:[1,0,0]
  v_pk_fma_f32 v[186:187], v[124:125], v[154:155], v[182:183] op_sel_hi:[0,1,1] neg_lo:[1,0,0] neg_hi:[1,0,0]
  v_pk_fma_f32 v[88:89], v[88:89], v[124:125], v[184:185] op_sel:[0,1,0]
  v_pk_fma_f32 v[90:91], v[90:91], v[124:125], v[186:187] op_sel:[0,1,0]
  v_pk_fma_f32 v[188:189], v[126:127], v[152:153], v[180:181] op_sel_hi:[0,1,1] neg_lo:[1,0,0] neg_hi:[1,0,0]
  v_pk_fma_f32 v[190:191], v[126:127], v[154:155], v[182:183] op_sel_hi:[0,1,1] neg_lo:[1,0,0] neg_hi:[1,0,0]
  v_pk_fma_f32 v[116:117], v[116:117], v[126:127], v[188:189] op_sel:[0,1,0]
  v_pk_fma_f32 v[118:119], v[118:119], v[126:127], v[190:191] op_sel:[0,1,0]
  v_cvt_pk_bf16_f32 v208, v32, v33
  v_cvt_pk_bf16_f32 v209, v34, v35
  v_cvt_pk_bf16_f32 v210, v60, v61
  v_cvt_pk_bf16_f32 v211, v62, v63
  v_cvt_pk_bf16_f32 v212, v88, v89
  v_cvt_pk_bf16_f32 v213, v90, v91
  v_cvt_pk_bf16_f32 v214, v116, v117
  v_cvt_pk_bf16_f32 v215, v118, v119
  v_pk_max_i16 v208, v208, 0
  v_pk_max_i16 v209, v209, 0
  v_pk_max_i16 v210, v210, 0
  v_pk_max_i16 v211, v211, 0
  v_pk_max_i16 v212, v212, 0
  v_pk_max_i16 v213, v213, 0
  v_pk_max_i16 v214, v214, 0
  v_pk_max_i16 v215, v215, 0
  ds_write_b128 v7, v[212:215]
  s_waitcnt lgkmcnt(0)
  s_lshl_b32 s47, s24, 2
  s_add_u32 s47, s47, 138288
  v_mov_b32 v184, s47
  v_mov_b32 v185, 1
  ds_write_b32 v184, v185
  v_pk_fma_f32 v[184:185], v[120:121], v[128:129], v[156:157] op_sel_hi:[0,1,1] neg_lo:[1,0,0] neg_hi:[1,0,0]
  v_pk_fma_f32 v[186:187], v[120:121], v[130:131], v[158:159] op_sel_hi:[0,1,1] neg_lo:[1,0,0] neg_hi:[1,0,0]
  v_pk_fma_f32 v[8:9], v[8:9], v[120:121], v[184:185] op_sel:[0,1,0]
  v_pk_fma_f32 v[10:11], v[10:11], v[120:121], v[186:187] op_sel:[0,1,0]
  v_pk_fma_f32 v[188:189], v[120:121], v[132:133], v[160:161] op_sel_hi:[0,1,1] neg_lo:[1,0,0] neg_hi:[1,0,0]
  v_pk_fma_f32 v[190:191], v[120:121], v[134:135], v[162:163] op_sel_hi:[0,1,1] neg_lo:[1,0,0] neg_hi:[1,0,0]
  v_pk_fma_f32 v[12:13], v[12:13], v[120:121], v[188:189] op_sel:[0,1,0]
  v_pk_fma_f32 v[14:15], v[14:15], v[120:121], v[190:191] op_sel:[0,1,0]
  v_cvt_pk_bf16_f32 v192, v8, v9
  v_cvt_pk_bf16_f32 v193, v10, v11
  v_cvt_pk_bf16_f32 v194, v12, v13
  v_cvt_pk_bf16_f32 v195, v14, v15
  v_pk_max_i16 v192, v192, 0
  v_pk_max_i16 v193, v193, 0
  v_pk_max_i16 v194, v194, 0
  v_pk_max_i16 v195, v195, 0
  s_nop 0
  v_permlane16_swap_b32 v192, v194
  v_permlane16_swap_b32 v193, v195
  buffer_store_dwordx4 v[192:195], v5, s[12:15], s48 offen offset:0 sc1
  v_pk_fma_f32 v[184:185], v[122:123], v[128:129], v[156:157] op_sel_hi:[0,1,1] neg_lo:[1,0,0] neg_hi:[1,0,0]
  v_pk_fma_f32 v[186:187], v[122:123], v[130:131], v[158:159] op_sel_hi:[0,1,1] neg_lo:[1,0,0] neg_hi:[1,0,0]
  v_pk_fma_f32 v[36:37], v[36:37], v[122:123], v[184:185] op_sel:[0,1,0]
  v_pk_fma_f32 v[38:39], v[38:39], v[122:123], v[186:187] op_sel:[0,1,0]
  v_pk_fma_f32 v[188:189], v[122:123], v[132:133], v[160:161] op_sel_hi:[0,1,1] neg_lo:[1,0,0] neg_hi:[1,0,0]
  v_pk_fma_f32 v[190:191], v[122:123], v[134:135], v[162:163] op_sel_hi:[0,1,1] neg_lo:[1,0,0] neg_hi:[1,0,0]
  v_pk_fma_f32 v[40:41], v[40:41], v[122:123], v[188:189] op_sel:[0,1,0]
  v_pk_fma_f32 v[42:43], v[42:43], v[122:123], v[190:191] op_sel:[0,1,0]
  v_cvt_pk_bf16_f32 v196, v36, v37
  v_cvt_pk_bf16_f32 v197, v38, v39
  v_cvt_pk_bf16_f32 v198, v40, v41
  v_cvt_pk_bf16_f32 v199, v42, v43
  v_pk_max_i16 v196, v196, 0
  v_pk_max_i16 v197, v197, 0
  v_pk_max_i16 v198, v198, 0
  v_pk_max_i16 v199, v199, 0
  s_nop 0
  v_permlane16_swap_b32 v196, v198
  v_permlane16_swap_b32 v197, v199
  buffer_store_dwordx4 v[196:199], v5, s[12:15], s48 offen offset:1024 sc1
  v_pk_fma_f32 v[184:185], v[124:125], v[128:129], v[156:157] op_sel_hi:[0,1,1] neg_lo:[1,0,0] neg_hi:[1,0,0]
  v_pk_fma_f32 v[186:187], v[124:125], v[130:131], v[158:159] op_sel_hi:[0,1,1] neg_lo:[1,0,0] neg_hi:[1,0,0]
  v_pk_fma_f32 v[64:65], v[64:65], v[124:125], v[184:185] op_sel:[0,1,0]
  v_pk_fma_f32 v[66:67], v[66:67], v[124:125], v[186:187] op_sel:[0,1,0]
  v_pk_fma_f32 v[188:189], v[124:125], v[132:133], v[160:161] op_sel_hi:[0,1,1] neg_lo:[1,0,0] neg_hi:[1,0,0]
  v_pk_fma_f32 v[190:191], v[124:125], v[134:135], v[162:163] op_sel_hi:[0,1,1] neg_lo:[1,0,0] neg_hi:[1,0,0]
  v_pk_fma_f32 v[68:69], v[68:69], v[124:125], v[188:189] op_sel:[0,1,0]
  v_pk_fma_f32 v[70:71], v[70:71], v[124:125], v[190:191] op_sel:[0,1,0]
  v_cvt_pk_bf16_f32 v200, v64, v65
  v_cvt_pk_bf16_f32 v201, v66, v67
  v_cvt_pk_bf16_f32 v202, v68, v69
  v_cvt_pk_bf16_f32 v203, v70, v71
  v_pk_max_i16 v200, v200, 0
  v_pk_max_i16 v201, v201, 0
  v_pk_max_i16 v202, v202, 0
  v_pk_max_i16 v203, v203, 0
  s_nop 0
  v_permlane16_swap_b32 v200, v202
  v_permlane16_swap_b32 v201, v203
  buffer_store_dwordx4 v[200:203], v5, s[12:15], s48 offen offset:2048 sc1
  v_pk_fma_f32 v[184:185], v[126:127], v[128:129], v[156:157] op_sel_hi:[0,1,1] neg_lo:[1,0,0] neg_hi:[1,0,0]
  v_pk_fma_f32 v[186:187], v[126:127], v[130:131], v[158:159] op_sel_hi:[0,1,1] neg_lo:[1,0,0] neg_hi:[1,0,0]
  v_pk_fma_f32 v[92:93], v[92:93], v[126:127], v[184:185] op_sel:[0,1,0]
  v_pk_fma_f32 v[94:95], v[94:95], v[126:127], v[186:187] op_sel:[0,1,0]
  v_pk_fma_f32 v[188:189], v[126:127], v[132:133], v[160:161] op_sel_hi:[0,1,1] neg_lo:[1,0,0] neg_hi:[1,0,0]
  v_pk_fma_f32 v[190:191], v[126:127], v[134:135], v[162:163] op_sel_hi:[0,1,1] neg_lo:[1,0,0] neg_hi:[1,0,0]
  v_pk_fma_f32 v[96:97], v[96:97], v[126:127], v[188:189] op_sel:[0,1,0]
  v_pk_fma_f32 v[98:99], v[98:99], v[126:127], v[190:191] op_sel:[0,1,0]
  v_cvt_pk_bf16_f32 v204, v92, v93
  v_cvt_pk_bf16_f32 v205, v94, v95
  v_cvt_pk_bf16_f32 v206, v96, v97
  v_cvt_pk_bf16_f32 v207, v98, v99
  v_pk_max_i16 v204, v204, 0
  v_pk_max_i16 v205, v205, 0
  v_pk_max_i16 v206, v206, 0
  v_pk_max_i16 v207, v207, 0
  s_nop 0
  v_permlane16_swap_b32 v204, v206
  v_permlane16_swap_b32 v205, v207
  buffer_store_dwordx4 v[204:207], v5, s[12:15], s48 offen offset:3072 sc1
  s_add_u32 s48, s48, 8192
  v_pk_fma_f32 v[184:185], v[120:121], v[136:137], v[164:165] op_sel_hi:[0,1,1] neg_lo:[1,0,0] neg_hi:[1,0,0]
  v_pk_fma_f32 v[186:187], v[120:121], v[138:139], v[166:167] op_sel_hi:[0,1,1] neg_lo:[1,0,0] neg_hi:[1,0,0]
  v_pk_fma_f32 v[16:17], v[16:17], v[120:121], v[184:185] op_sel:[0,1,0]
  v_pk_fma_f32 v[18:19], v[18:19], v[120:121], v[186:187] op_sel:[0,1,0]
  v_pk_fma_f32 v[188:189], v[120:121], v[140:141], v[168:169] op_sel_hi:[0,1,1] neg_lo:[1,0,0] neg_hi:[1,0,0]
  v_pk_fma_f32 v[190:191], v[120:121], v[142:143], v[170:171] op_sel_hi:[0,1,1] neg_lo:[1,0,0] neg_hi:[1,0,0]
  v_pk_fma_f32 v[20:21], v[20:21], v[120:121], v[188:189] op_sel:[0,1,0]
  v_pk_fma_f32 v[22:23], v[22:23], v[120:121], v[190:191] op_sel:[0,1,0]
  v_cvt_pk_bf16_f32 v192, v16, v17
  v_cvt_pk_bf16_f32 v193, v18, v19
  v_cvt_pk_bf16_f32 v194, v20, v21
  v_cvt_pk_bf16_f32 v195, v22, v23
  v_pk_max_i16 v192, v192, 0
  v_pk_max_i16 v193, v193, 0
  v_pk_max_i16 v194, v194, 0
  v_pk_max_i16 v195, v195, 0
  s_nop 0
  v_permlane16_swap_b32 v192, v194
  v_permlane16_swap_b32 v193, v195
  buffer_store_dwordx4 v[192:195], v5, s[12:15], s48 offen offset:0 sc1
  v_pk_fma_f32 v[184:185], v[122:123], v[136:137], v[164:165] op_sel_hi:[0,1,1] neg_lo:[1,0,0] neg_hi:[1,0,0]
  v_pk_fma_f32 v[186:187], v[122:123], v[138:139], v[166:167] op_sel_hi:[0,1,1] neg_lo:[1,0,0] neg_hi:[1,0,0]
  v_pk_fma_f32 v[44:45], v[44:45], v[122:123], v[184:185] op_sel:[0,1,0]
  v_pk_fma_f32 v[46:47], v[46:47], v[122:123], v[186:187] op_sel:[0,1,0]
  v_pk_fma_f32 v[188:189], v[122:123], v[140:141], v[168:169] op_sel_hi:[0,1,1] neg_lo:[1,0,0] neg_hi:[1,0,0]
  v_pk_fma_f32 v[190:191], v[122:123], v[142:143], v[170:171] op_sel_hi:[0,1,1] neg_lo:[1,0,0] neg_hi:[1,0,0]
  v_pk_fma_f32 v[48:49], v[48:49], v[122:123], v[188:189] op_sel:[0,1,0]
  v_pk_fma_f32 v[50:51], v[50:51], v[122:123], v[190:191] op_sel:[0,1,0]
  v_cvt_pk_bf16_f32 v196, v44, v45
  v_cvt_pk_bf16_f32 v197, v46, v47
  v_cvt_pk_bf16_f32 v198, v48, v49
  v_cvt_pk_bf16_f32 v199, v50, v51
  v_pk_max_i16 v196, v196, 0
  v_pk_max_i16 v197, v197, 0
  v_pk_max_i16 v198, v198, 0
  v_pk_max_i16 v199, v199, 0
  s_nop 0
  v_permlane16_swap_b32 v196, v198
  v_permlane16_swap_b32 v197, v199
  buffer_store_dwordx4 v[196:199], v5, s[12:15], s48 offen offset:1024 sc1
  v_pk_fma_f32 v[184:185], v[124:125], v[136:137], v[164:165] op_sel_hi:[0,1,1] neg_lo:[1,0,0] neg_hi:[1,0,0]
  v_pk_fma_f32 v[186:187], v[124:125], v[138:139], v[166:167] op_sel_hi:[0,1,1] neg_lo:[1,0,0] neg_hi:[1,0,0]
  v_pk_fma_f32 v[72:73], v[72:73], v[124:125], v[184:185] op_sel:[0,1,0]
  v_pk_fma_f32 v[74:75], v[74:75], v[124:125], v[186:187] op_sel:[0,1,0]
  v_pk_fma_f32 v[188:189], v[124:125], v[140:141], v[168:169] op_sel_hi:[0,1,1] neg_lo:[1,0,0] neg_hi:[1,0,0]
  v_pk_fma_f32 v[190:191], v[124:125], v[142:143], v[170:171] op_sel_hi:[0,1,1] neg_lo:[1,0,0] neg_hi:[1,0,0]
  v_pk_fma_f32 v[76:77], v[76:77], v[124:125], v[188:189] op_sel:[0,1,0]
  v_pk_fma_f32 v[78:79], v[78:79], v[124:125], v[190:191] op_sel:[0,1,0]
  v_cvt_pk_bf16_f32 v200, v72, v73
  v_cvt_pk_bf16_f32 v201, v74, v75
  v_cvt_pk_bf16_f32 v202, v76, v77
  v_cvt_pk_bf16_f32 v203, v78, v79
  v_pk_max_i16 v200, v200, 0
  v_pk_max_i16 v201, v201, 0
  v_pk_max_i16 v202, v202, 0
  v_pk_max_i16 v203, v203, 0
  s_nop 0
  v_permlane16_swap_b32 v200, v202
  v_permlane16_swap_b32 v201, v203
  buffer_store_dwordx4 v[200:203], v5, s[12:15], s48 offen offset:2048 sc1
  v_pk_fma_f32 v[184:185], v[126:127], v[136:137], v[164:165] op_sel_hi:[0,1,1] neg_lo:[1,0,0] neg_hi:[1,0,0]
  v_pk_fma_f32 v[186:187], v[126:127], v[138:139], v[166:167] op_sel_hi:[0,1,1] neg_lo:[1,0,0] neg_hi:[1,0,0]
  v_pk_fma_f32 v[100:101], v[100:101], v[126:127], v[184:185] op_sel:[0,1,0]
  v_pk_fma_f32 v[102:103], v[102:103], v[126:127], v[186:187] op_sel:[0,1,0]
  v_pk_fma_f32 v[188:189], v[126:127], v[140:141], v[168:169] op_sel_hi:[0,1,1] neg_lo:[1,0,0] neg_hi:[1,0,0]
  v_pk_fma_f32 v[190:191], v[126:127], v[142:143], v[170:171] op_sel_hi:[0,1,1] neg_lo:[1,0,0] neg_hi:[1,0,0]
  v_pk_fma_f32 v[104:105], v[104:105], v[126:127], v[188:189] op_sel:[0,1,0]
  v_pk_fma_f32 v[106:107], v[106:107], v[126:127], v[190:191] op_sel:[0,1,0]
  v_cvt_pk_bf16_f32 v204, v100, v101
  v_cvt_pk_bf16_f32 v205, v102, v103
  v_cvt_pk_bf16_f32 v206, v104, v105
  v_cvt_pk_bf16_f32 v207, v106, v107
  v_pk_max_i16 v204, v204, 0
  v_pk_max_i16 v205, v205, 0
  v_pk_max_i16 v206, v206, 0
  v_pk_max_i16 v207, v207, 0
  s_nop 0
  v_permlane16_swap_b32 v204, v206
  v_permlane16_swap_b32 v205, v207
  buffer_store_dwordx4 v[204:207], v5, s[12:15], s48 offen offset:3072 sc1
  s_add_u32 s48, s48, 8192
  v_pk_fma_f32 v[184:185], v[120:121], v[144:145], v[172:173] op_sel_hi:[0,1,1] neg_lo:[1,0,0] neg_hi:[1,0,0]
  v_pk_fma_f32 v[186:187], v[120:121], v[146:147], v[174:175] op_sel_hi:[0,1,1] neg_lo:[1,0,0] neg_hi:[1,0,0]
  v_pk_fma_f32 v[24:25], v[24:25], v[120:121], v[184:185] op_sel:[0,1,0]
  v_pk_fma_f32 v[26:27], v[26:27], v[120:121], v[186:187] op_sel:[0,1,0]
  v_pk_fma_f32 v[188:189], v[120:121], v[148:149], v[176:177] op_sel_hi:[0,1,1] neg_lo:[1,0,0] neg_hi:[1,0,0]
  v_pk_fma_f32 v[190:191], v[120:121], v[150:151], v[178:179] op_sel_hi:[0,1,1] neg_lo:[1,0,0] neg_hi:[1,0,0]
  v_pk_fma_f32 v[28:29], v[28:29], v[120:121], v[188:189] op_sel:[0,1,0]
  v_pk_fma_f32 v[30:31], v[30:31], v[120:121], v[190:191] op_sel:[0,1,0]
  v_cvt_pk_bf16_f32 v192, v24, v25
  v_cvt_pk_bf16_f32 v193, v26, v27
  v_cvt_pk_bf16_f32 v194, v28, v29
  v_cvt_pk_bf16_f32 v195, v30, v31
  v_pk_max_i16 v192, v192, 0
  v_pk_max_i16 v193, v193, 0
  v_pk_max_i16 v194, v194, 0
  v_pk_max_i16 v195, v195, 0
  s_nop 0
  v_permlane16_swap_b32 v192, v194
  v_permlane16_swap_b32 v193, v195
  buffer_store_dwordx4 v[192:195], v5, s[12:15], s48 offen offset:0 sc1
  v_pk_fma_f32 v[184:185], v[122:123], v[144:145], v[172:173] op_sel_hi:[0,1,1] neg_lo:[1,0,0] neg_hi:[1,0,0]
  v_pk_fma_f32 v[186:187], v[122:123], v[146:147], v[174:175] op_sel_hi:[0,1,1] neg_lo:[1,0,0] neg_hi:[1,0,0]
  v_pk_fma_f32 v[52:53], v[52:53], v[122:123], v[184:185] op_sel:[0,1,0]
  v_pk_fma_f32 v[54:55], v[54:55], v[122:123], v[186:187] op_sel:[0,1,0]
  v_pk_fma_f32 v[188:189], v[122:123], v[148:149], v[176:177] op_sel_hi:[0,1,1] neg_lo:[1,0,0] neg_hi:[1,0,0]
  v_pk_fma_f32 v[190:191], v[122:123], v[150:151], v[178:179] op_sel_hi:[0,1,1] neg_lo:[1,0,0] neg_hi:[1,0,0]
  v_pk_fma_f32 v[56:57], v[56:57], v[122:123], v[188:189] op_sel:[0,1,0]
  v_pk_fma_f32 v[58:59], v[58:59], v[122:123], v[190:191] op_sel:[0,1,0]
  v_cvt_pk_bf16_f32 v196, v52, v53
  v_cvt_pk_bf16_f32 v197, v54, v55
  v_cvt_pk_bf16_f32 v198, v56, v57
  v_cvt_pk_bf16_f32 v199, v58, v59
  v_pk_max_i16 v196, v196, 0
  v_pk_max_i16 v197, v197, 0
  v_pk_max_i16 v198, v198, 0
  v_pk_max_i16 v199, v199, 0
  s_nop 0
  v_permlane16_swap_b32 v196, v198
  v_permlane16_swap_b32 v197, v199
  buffer_store_dwordx4 v[196:199], v5, s[12:15], s48 offen offset:1024 sc1
  v_pk_fma_f32 v[184:185], v[124:125], v[144:145], v[172:173] op_sel_hi:[0,1,1] neg_lo:[1,0,0] neg_hi:[1,0,0]
  v_pk_fma_f32 v[186:187], v[124:125], v[146:147], v[174:175] op_sel_hi:[0,1,1] neg_lo:[1,0,0] neg_hi:[1,0,0]
  v_pk_fma_f32 v[80:81], v[80:81], v[124:125], v[184:185] op_sel:[0,1,0]
  v_pk_fma_f32 v[82:83], v[82:83], v[124:125], v[186:187] op_sel:[0,1,0]
  v_pk_fma_f32 v[188:189], v[124:125], v[148:149], v[176:177] op_sel_hi:[0,1,1] neg_lo:[1,0,0] neg_hi:[1,0,0]
  v_pk_fma_f32 v[190:191], v[124:125], v[150:151], v[178:179] op_sel_hi:[0,1,1] neg_lo:[1,0,0] neg_hi:[1,0,0]
  v_pk_fma_f32 v[84:85], v[84:85], v[124:125], v[188:189] op_sel:[0,1,0]
  v_pk_fma_f32 v[86:87], v[86:87], v[124:125], v[190:191] op_sel:[0,1,0]
  v_cvt_pk_bf16_f32 v200, v80, v81
  v_cvt_pk_bf16_f32 v201, v82, v83
  v_cvt_pk_bf16_f32 v202, v84, v85
  v_cvt_pk_bf16_f32 v203, v86, v87
  v_pk_max_i16 v200, v200, 0
  v_pk_max_i16 v201, v201, 0
  v_pk_max_i16 v202, v202, 0
  v_pk_max_i16 v203, v203, 0
  s_nop 0
  v_permlane16_swap_b32 v200, v202
  v_permlane16_swap_b32 v201, v203
  buffer_store_dwordx4 v[200:203], v5, s[12:15], s48 offen offset:2048 sc1
  v_pk_fma_f32 v[184:185], v[126:127], v[144:145], v[172:173] op_sel_hi:[0,1,1] neg_lo:[1,0,0] neg_hi:[1,0,0]
  v_pk_fma_f32 v[186:187], v[126:127], v[146:147], v[174:175] op_sel_hi:[0,1,1] neg_lo:[1,0,0] neg_hi:[1,0,0]
  v_pk_fma_f32 v[108:109], v[108:109], v[126:127], v[184:185] op_sel:[0,1,0]
  v_pk_fma_f32 v[110:111], v[110:111], v[126:127], v[186:187] op_sel:[0,1,0]
  v_pk_fma_f32 v[188:189], v[126:127], v[148:149], v[176:177] op_sel_hi:[0,1,1] neg_lo:[1,0,0] neg_hi:[1,0,0]
  v_pk_fma_f32 v[190:191], v[126:127], v[150:151], v[178:179] op_sel_hi:[0,1,1] neg_lo:[1,0,0] neg_hi:[1,0,0]
  v_pk_fma_f32 v[112:113], v[112:113], v[126:127], v[188:189] op_sel:[0,1,0]
  v_pk_fma_f32 v[114:115], v[114:115], v[126:127], v[190:191] op_sel:[0,1,0]
  v_cvt_pk_bf16_f32 v204, v108, v109
  v_cvt_pk_bf16_f32 v205, v110, v111
  v_cvt_pk_bf16_f32 v206, v112, v113
  v_cvt_pk_bf16_f32 v207, v114, v115
  v_pk_max_i16 v204, v204, 0
  v_pk_max_i16 v205, v205, 0
  v_pk_max_i16 v206, v206, 0
  v_pk_max_i16 v207, v207, 0
  s_nop 0
  v_permlane16_swap_b32 v204, v206
  v_permlane16_swap_b32 v205, v207
  buffer_store_dwordx4 v[204:207], v5, s[12:15], s48 offen offset:3072 sc1
  s_xor_b32 s47, s24, 1
  s_lshl_b32 s47, s47, 2
  s_add_u32 s47, s47, 138288
  v_mov_b32 v184, s47
  s_mov_b32 s33, 0
main_kernel_f1_xwx0:
  ds_read_b32 v185, v184
  s_waitcnt lgkmcnt(0)
  v_readfirstlane_b32 s34, v185
  s_nop 0
  s_cmp_lg_u32 s34, 0
  s_cbranch_scc1 main_kernel_f1_xxx0
  s_add_u32 s33, s33, 1
  s_cmp_lt_u32 s33, 400000
  s_cbranch_scc1 main_kernel_f1_xwx0
main_kernel_f1_xxx0:
  v_xor_b32 v7, 1024, v7
  ds_read_b128 v[184:187], v7
  s_waitcnt lgkmcnt(0)
  v_mov_b32 v192, v208
  v_mov_b32 v193, v209
  v_mov_b32 v194, v184
  v_mov_b32 v195, v185
  s_nop 0
  v_permlane16_swap_b32 v192, v194
  v_permlane16_swap_b32 v193, v195
  buffer_store_dwordx4 v[192:195], v5, s[12:15], s53 offen offset:0 sc1
  v_mov_b32 v196, v210
  v_mov_b32 v197, v211
  v_mov_b32 v198, v186
  v_mov_b32 v199, v187
  s_nop 0
  v_permlane16_swap_b32 v196, v198
  v_permlane16_swap_b32 v197, v199
  buffer_store_dwordx4 v[196:199], v5, s[12:15], s53 offen offset:1024 sc1
  s_branch main_kernel_f1_ep2
main_kernel_f1_ep1:
  s_add_u32 s48, s48, 32768
  v_pk_fma_f32 v[184:185], v[120:121], v[128:129], v[156:157] op_sel_hi:[0,1,1] neg_lo:[1,0,0] neg_hi:[1,0,0]
  v_pk_fma_f32 v[186:187], v[120:121], v[130:131], v[158:159] op_sel_hi:[0,1,1] neg_lo:[1,0,0] neg_hi:[1,0,0]
  v_pk_fma_f32 v[8:9], v[8:9], v[120:121], v[184:185] op_sel:[0,1,0]
  v_pk_fma_f32 v[10:11], v[10:11], v[120:121], v[186:187] op_sel:[0,1,0]
  v_pk_fma_f32 v[188:189], v[122:123], v[128:129], v[156:157] op_sel_hi:[0,1,1] neg_lo:[1,0,0] neg_hi:[1,0,0]
  v_pk_fma_f32 v[190:191], v[122:123], v[130:131], v[158:159] op_sel_hi:[0,1,1] neg_lo:[1,0,0] neg_hi:[1,0,0]
  v_pk_fma_f32 v[36:37], v[36:37], v[122:123], v[188:189] op_sel:[0,1,0]
  v_pk_fma_f32 v[38:39], v[38:39], v[122:123], v[190:191] op_sel:[0,1,0]
  v_pk_fma_f32 v[184:185], v[124:125], v[128:129], v[156:157] op_sel_hi:[0,1,1] neg_lo:[1,0,0] neg_hi:[1,0,0]
  v_pk_fma_f32 v[186:187], v[124:125], v[130:131], v[158:159] op_sel_hi:[0,1,1] neg_lo:[1,0,0] neg_hi:[1,0,0]
  v_pk_fma_f32 v[64:65], v[64:65], v[124:125], v[184:185] op_sel:[0,1,0]
  v_pk_fma_f32 v[66:67], v[66:67], v[124:125], v[186:187] op_sel:[0,1,0]
  v_pk_fma_f32 v[188:189], v[126:127], v[128:129], v[156:157] op_sel_hi:[0,1,1] neg_lo:[1,0,0] neg_hi:[1,0,0]
  v_pk_fma_f32 v[190:191], v[126:127], v[130:131], v[158:159] op_sel_hi:[0,1,1] neg_lo:[1,0,0] neg_hi:[1,0,0]
  v_pk_fma_f32 v[92:93], v[92:93], v[126:127], v[188:189] op_sel:[0,1,0]
  v_pk_fma_f32 v[94:95], v[94:95], v[126:127], v[190:191] op_sel:[0,1,0]
  v_cvt_pk_bf16_f32 v208, v8, v9
  v_cvt_pk_bf16_f32 v209, v10, v11
  v_cvt_pk_bf16_f32 v210, v36, v37
  v_cvt_pk_bf16_f32 v211, v38, v39
  v_cvt_pk_bf16_f32 v212, v64, v65
  v_cvt_pk_bf16_f32 v213, v66, v67
  v_cvt_pk_bf16_f32 v214, v92, v93
  v_cvt_pk_bf16_f32 v215, v94, v95
  v_pk_max_i16 v208, v208, 0
  v_pk_max_i16 v209, v209, 0
  v_pk_max_i16 v210, v210, 0
  v_pk_max_i16 v211, v211, 0
  v_pk_max_i16 v212, v212, 0
  v_pk_max_i16 v213, v213, 0
  v_pk_max_i16 v214, v214, 0
  v_pk_max_i16 v215, v215, 0
  ds_write_b128 v7, v[208:211]
  s_waitcnt lgkmcnt(0)
  s_lshl_b32 s47, s24, 2
  s_add_u32 s47, s47, 138288
  v_mov_b32 v184, s47
  v_mov_b32 v185, 1
  ds_write_b32 v184, v185
  v_pk_fma_f32 v[184:185], v[120:121], v[132:133], v[160:161] op_sel_hi:[0,1,1] neg_lo:[1,0,0] neg_hi:[1,0,0]
  v_pk_fma_f32 v[186:187], v[120:121], v[134:135], v[162:163] op_sel_hi:[0,1,1] neg_lo:[1,0,0] neg_hi:[1,0,0]
  v_pk_fma_f32 v[12:13], v[12:13], v[120:121], v[184:185] op_sel:[0,1,0]
  v_pk_fma_f32 v[14:15], v[14:15], v[120:121], v[186:187] op_sel:[0,1,0]
  v_pk_fma_f32 v[188:189], v[120:121], v[136:137], v[164:165] op_sel_hi:[0,1,1] neg_lo:[1,0,0] neg_hi:[1,0,0]
  v_pk_fma_f32 v[190:191], v[120:121], v[138:139], v[166:167] op_sel_hi:[0,1,1] neg_lo:[1,0,0] neg_hi:[1,0,0]
  v_pk_fma_f32 v[16:17], v[16:17], v[120:121], v[188:189] op_sel:[0,1,0]
  v_pk_fma_f32 v[18:19], v[18:19], v[120:121], v[190:191] op_sel:[0,1,0]
  v_cvt_pk_bf16_f32 v200, v12, v13
  v_cvt_pk_bf16_f32 v201, v14, v15
  v_cvt_pk_bf16_f32 v202, v16, v17
  v_cvt_pk_bf16_f32 v203, v18, v19
  v_pk_max_i16 v200, v200, 0
  v_pk_max_i16 v201, v201, 0
  v_pk_max_i16 v202, v202, 0
  v_pk_max_i16 v203, v203, 0
  s_nop 0
  v_permlane16_swap_b32 v200, v202
  v_permlane16_swap_b32 v201, v203
  buffer_store_dwordx4 v[200:203], v5, s[12:15], s48 offen offset:0 sc1
  v_pk_fma_f32 v[184:185], v[122:123], v[132:133], v[160:161] op_sel_hi:[0,1,1] neg_lo:[1,0,0] neg_hi:[1,0,0]
  v_pk_fma_f32 v[186:187], v[122:123], v[134:135], v[162:163] op_sel_hi:[0,1,1] neg_lo:[1,0,0] neg_hi:[1,0,0]
  v_pk_fma_f32 v[40:41], v[40:41], v[122:123], v[184:185] op_sel:[0,1,0]
  v_pk_fma_f32 v[42:43], v[42:43], v[122:123], v[186:187] op_sel:[0,1,0]
  v_pk_fma_f32 v[188:189], v[122:123], v[136:137], v[164:165] op_sel_hi:[0,1,1] neg_lo:[1,0,0] neg_hi:[1,0,0]
  v_pk_fma_f32 v[190:191], v[122:123], v[138:139], v[166:167] op_sel_hi:[0,1,1] neg_lo:[1,0,0] neg_hi:[1,0,0]
  v_pk_fma_f32 v[44:45], v[44:45], v[122:123], v[188:189] op_sel:[0,1,0]
  v_pk_fma_f32 v[46:47], v[46:47], v[122:123], v[190:191] op_sel:[0,1,0]
  v_cvt_pk_bf16_f32 v204, v40, v41
  v_cvt_pk_bf16_f32 v205, v42, v43
  v_cvt_pk_bf16_f32 v206, v44, v45
  v_cvt_pk_bf16_f32 v207, v46, v47
  v_pk_max_i16 v204, v204, 0
  v_pk_max_i16 v205, v205, 0
  v_pk_max_i16 v206, v206, 0
  v_pk_max_i16 v207, v207, 0
  s_nop 0
  v_permlane16_swap_b32 v204, v206
  v_permlane16_swap_b32 v205, v207
  buffer_store_dwordx4 v[204:207], v5, s[12:15], s48 offen offset:1024 sc1
  v_pk_fma_f32 v[184:185], v[124:125], v[132:133], v[160:161] op_sel_hi:[0,1,1] neg_lo:[1,0,0] neg_hi:[1,0,0]
  v_pk_fma_f32 v[186:187], v[124:125], v[134:135], v[162:163] op_sel_hi:[0,1,1] neg_lo:[1,0,0] neg_hi:[1,0,0]
  v_pk_fma_f32 v[68:69], v[68:69], v[124:125], v[184:185] op_sel:[0,1,0]
  v_pk_fma_f32 v[70:71], v[70:71], v[124:125], v[186:187] op_sel:[0,1,0]
  v_pk_fma_f32 v[188:189], v[124:125], v[136:137], v[164:165] op_sel_hi:[0,1,1] neg_lo:[1,0,0] neg_hi:[1,0,0]
  v_pk_fma_f32 v[190:191], v[124:125], v[138:139], v[166:167] op_sel_hi:[0,1,1] neg_lo:[1,0,0] neg_hi:[1,0,0]
  v_pk_fma_f32 v[72:73], v[72:73], v[124:125], v[188:189] op_sel:[0,1,0]
  v_pk_fma_f32 v[74:75], v[74:75], v[124:125], v[190:191] op_sel:[0,1,0]
  v_cvt_pk_bf16_f32 v192, v68, v69
  v_cvt_pk_bf16_f32 v193, v70, v71
  v_cvt_pk_bf16_f32 v194, v72, v73
  v_cvt_pk_bf16_f32 v195, v74, v75
  v_pk_max_i16 v192, v192, 0
  v_pk_max_i16 v193, v193, 0
  v_pk_max_i16 v194, v194, 0
  v_pk_max_i16 v195, v195, 0
  s_nop 0
  v_permlane16_swap_b32 v192, v194
  v_permlane16_swap_b32 v193, v195
  buffer_store_dwordx4 v[192:195], v5, s[12:15], s48 offen offset:2048 sc1
  v_pk_fma_f32 v[184:185], v[126:127], v[132:133], v[160:161] op_sel_hi:[0,1,1] neg_lo:[1,0,0] neg_hi:[1,0,0]
  v_pk_fma_f32 v[186:187], v[126:127], v[134:135], v[162:163] op_sel_hi:[0,1,1] neg_lo:[1,0,0] neg_hi:[1,0,0]
  v_pk_fma_f32 v[96:97], v[96:97], v[126:127], v[184:185] op_sel:[0,1,0]
  v_pk_fma_f32 v[98:99], v[98:99], v[126:127], v[186:187] op_sel:[0,1,0]
  v_pk_fma_f32 v[188:189], v[126:127], v[136:137], v[164:165] op_sel_hi:[0,1,1] neg_lo:[1,0,0] neg_hi:[1,0,0]
  v_pk_fma_f32 v[190:191], v[126:127], v[138:139], v[166:167] op_sel_hi:[0,1,1] neg_lo:[1,0,0] neg_hi:[1,0,0]
  v_pk_fma_f32 v[100:101], v[100:101], v[126:127], v[188:189] op_sel:[0,1,0]
  v_pk_fma_f32 v[102:103], v[102:103], v[126:127], v[190:191] op_sel:[0,1,0]
  v_cvt_pk_bf16_f32 v196, v96, v97
  v_cvt_pk_bf16_f32 v197, v98, v99
  v_cvt_pk_bf16_f32 v198, v100, v101
  v_cvt_pk_bf16_f32 v199, v102, v103
  v_pk_max_i16 v196, v196, 0
  v_pk_max_i16 v197, v197, 0
  v_pk_max_i16 v198, v198, 0
  v_pk_max_i16 v199, v199, 0
  s_nop 0
  v_permlane16_swap_b32 v196, v198
  v_permlane16_swap_b32 v197, v199
  buffer_store_dwordx4 v[196:199], v5, s[12:15], s48 offen offset:3072 sc1
  s_add_u32 s48, s48, 8192
  v_pk_fma_f32 v[184:185], v[120:121], v[140:141], v[168:169] op_sel_hi:[0,1,1] neg_lo:[1,0,0] neg_hi:[1,0,0]
  v_pk_fma_f32 v[186:187], v[120:121], v[142:143], v[170:171] op_sel_hi:[0,1,1] neg_lo:[1,0,0] neg_hi:[1,0,0]
  v_pk_fma_f32 v[20:21], v[20:21], v[120:121], v[184:185] op_sel:[0,1,0]
  v_pk_fma_f32 v[22:23], v[22:23], v[120:121], v[186:187] op_sel:[0,1,0]
  v_pk_fma_f32 v[188:189], v[120:121], v[144:145], v[172:173] op_sel_hi:[0,1,1] neg_lo:[1,0,0] neg_hi:[1,0,0]
  v_pk_fma_f32 v[190:191], v[120:121], v[146:147], v[174:175] op_sel_hi:[0,1,1] neg_lo:[1,0,0] neg_hi:[1,0,0]
  v_pk_fma_f32 v[24:25], v[24:25], v[120:121], v[188:189] op_sel:[0,1,0]
  v_pk_fma_f32 v[26:27], v[26:27], v[120:121], v[190:191] op_sel:[0,1,0]
  v_cvt_pk_bf16_f32 v200, v20, v21
  v_cvt_pk_bf16_f32 v201, v22, v23
  v_cvt_pk_bf16_f32 v202, v24, v25
  v_cvt_pk_bf16_f32 v203, v26, v27
  v_pk_max_i16 v200, v200, 0
  v_pk_max_i16 v201, v201, 0
  v_pk_max_i16 v202, v202, 0
  v_pk_max_i16 v203, v203, 0
  s_nop 0
  v_permlane16_swap_b32 v200, v202
  v_permlane16_swap_b32 v201, v203
  buffer_store_dwordx4 v[200:203], v5, s[12:15], s48 offen offset:0 sc1
  v_pk_fma_f32 v[184:185], v[122:123], v[140:141], v[168:169] op_sel_hi:[0,1,1] neg_lo:[1,0,0] neg_hi:[1,0,0]
  v_pk_fma_f32 v[186:187], v[122:123], v[142:143], v[170:171] op_sel_hi:[0,1,1] neg_lo:[1,0,0] neg_hi:[1,0,0]
  v_pk_fma_f32 v[48:49], v[48:49], v[122:123], v[184:185] op_sel:[0,1,0]
  v_pk_fma_f32 v[50:51], v[50:51], v[122:123], v[186:187] op_sel:[0,1,0]
  v_pk_fma_f32 v[188:189], v[122:123], v[144:145], v[172:173] op_sel_hi:[0,1,1] neg_lo:[1,0,0] neg_hi:[1,0,0]
  v_pk_fma_f32 v[190:191], v[122:123], v[146:147], v[174:175] op_sel_hi:[0,1,1] neg_lo:[1,0,0] neg_hi:[1,0,0]
  v_pk_fma_f32 v[52:53], v[52:53], v[122:123], v[188:189] op_sel:[0,1,0]
  v_pk_fma_f32 v[54:55], v[54:55], v[122:123], v[190:191] op_sel:[0,1,0]
  v_cvt_pk_bf16_f32 v204, v48, v49
  v_cvt_pk_bf16_f32 v205, v50, v51
  v_cvt_pk_bf16_f32 v206, v52, v53
  v_cvt_pk_bf16_f32 v207, v54, v55
  v_pk_max_i16 v204, v204, 0
  v_pk_max_i16 v205, v205, 0
  v_pk_max_i16 v206, v206, 0
  v_pk_max_i16 v207, v207, 0
  s_nop 0
  v_permlane16_swap_b32 v204, v206
  v_permlane16_swap_b32 v205, v207
  buffer_store_dwordx4 v[204:207], v5, s[12:15], s48 offen offset:1024 sc1
  v_pk_fma_f32 v[184:185], v[124:125], v[140:141], v[168:169] op_sel_hi:[0,1,1] neg_lo:[1,0,0] neg_hi:[1,0,0]
  v_pk_fma_f32 v[186:187], v[124:125], v[142:143], v[170:171] op_sel_hi:[0,1,1] neg_lo:[1,0,0] neg_hi:[1,0,0]
  v_pk_fma_f32 v[76:77], v[76:77], v[124:125], v[184:185] op_sel:[0,1,0]
  v_pk_fma_f32 v[78:79], v[78:79], v[124:125], v[186:187] op_sel:[0,1,0]
  v_pk_fma_f32 v[188:189], v[124:125], v[144:145], v[172:173] op_sel_hi:[0,1,1] neg_lo:[1,0,0] neg_hi:[1,0,0]
  v_pk_fma_f32 v[190:191], v[124:125], v[146:147], v[174:175] op_sel_hi:[0,1,1] neg_lo:[1,0,0] neg_hi:[1,0,0]
  v_pk_fma_f32 v[80:81], v[80:81], v[124:125], v[188:189] op_sel:[0,1,0]
  v_pk_fma_f32 v[82:83], v[82:83], v[124:125], v[190:191] op_sel:[0,1,0]
  v_cvt_pk_bf16_f32 v192, v76, v77
  v_cvt_pk_bf16_f32 v193, v78, v79
  v_cvt_pk_bf16_f32 v194, v80, v81
  v_cvt_pk_bf16_f32 v195, v82, v83
  v_pk_max_i16 v192, v192, 0
  v_pk_max_i16 v193, v193, 0
  v_pk_max_i16 v194, v194, 0
  v_pk_max_i16 v195, v195, 0
  s_nop 0
  v_permlane16_swap_b32 v192, v194
  v_permlane16_swap_b32 v193, v195
  buffer_store_dwordx4 v[192:195], v5, s[12:15], s48 offen offset:2048 sc1
  v_pk_fma_f32 v[184:185], v[126:127], v[140:141], v[168:169] op_sel_hi:[0,1,1] neg_lo:[1,0,0] neg_hi:[1,0,0]
  v_pk_fma_f32 v[186:187], v[126:127], v[142:143], v[170:171] op_sel_hi:[0,1,1] neg_lo:[1,0,0] neg_hi:[1,0,0]
  v_pk_fma_f32 v[104:105], v[104:105], v[126:127], v[184:185] op_sel:[0,1,0]
  v_pk_fma_f32 v[106:107], v[106:107], v[126:127], v[186:187] op_sel:[0,1,0]
  v_pk_fma_f32 v[188:189], v[126:127], v[144:145], v[172:173] op_sel_hi:[0,1,1] neg_lo:[1,0,0] neg_hi:[1,0,0]
  v_pk_fma_f32 v[190:191], v[126:127], v[146:147], v[174:175] op_sel_hi:[0,1,1] neg_lo:[1,0,0] neg_hi:[1,0,0]
  v_pk_fma_f32 v[108:109], v[108:109], v[126:127], v[188:189] op_sel:[0,1,0]
  v_pk_fma_f32 v[110:111], v[110:111], v[126:127], v[190:191] op_sel:[0,1,0]
  v_cvt_pk_bf16_f32 v196, v104, v105
  v_cvt_pk_bf16_f32 v197, v106, v107
  v_cvt_pk_bf16_f32 v198, v108, v109
  v_cvt_pk_bf16_f32 v199, v110, v111
  v_pk_max_i16 v196, v196, 0
  v_pk_max_i16 v197, v197, 0
  v_pk_max_i16 v198, v198, 0
  v_pk_max_i16 v199, v199, 0
  s_nop 0
  v_permlane16_swap_b32 v196, v198
  v_permlane16_swap_b32 v197, v199
  buffer_store_dwordx4 v[196:199], v5, s[12:15], s48 offen offset:3072 sc1
  s_add_u32 s48, s48, 8192
  v_pk_fma_f32 v[184:185], v[120:121], v[148:149], v[176:177] op_sel_hi:[0,1,1] neg_lo:[1,0,0] neg_hi:[1,0,0]
  v_pk_fma_f32 v[186:187], v[120:121], v[150:151], v[178:179] op_sel_hi:[0,1,1] neg_lo:[1,0,0] neg_hi:[1,0,0]
  v_pk_fma_f32 v[28:29], v[28:29], v[120:121], v[184:185] op_sel:[0,1,0]
  v_pk_fma_f32 v[30:31], v[30:31], v[120:121], v[186:187] op_sel:[0,1,0]
  v_pk_fma_f32 v[188:189], v[120:121], v[152:153], v[180:181] op_sel_hi:[0,1,1] neg_lo:[1,0,0] neg_hi:[1,0,0]
  v_pk_fma_f32 v[190:191], v[120:121], v[154:155], v[182:183] op_sel_hi:[0,1,1] neg_lo:[1,0,0] neg_hi:[1,0,0]
  v_pk_fma_f32 v[32:33], v[32:33], v[120:121], v[188:189] op_sel:[0,1,0]
  v_pk_fma_f32 v[34:35], v[34:35], v[120:121], v[190:191] op_sel:[0,1,0]
  v_cvt_pk_bf16_f32 v200, v28, v29
  v_cvt_pk_bf16_f32 v201, v30, v31
  v_cvt_pk_bf16_f32 v202, v32, v33
  v_cvt_pk_bf16_f32 v203, v34, v35
  v_pk_max_i16 v200, v200, 0
  v_pk_max_i16 v201, v201, 0
  v_pk_max_i16 v202, v202, 0
  v_pk_max_i16 v203, v203, 0
  s_nop 0
  v_permlane16_swap_b32 v200, v202
  v_permlane16_swap_b32 v201, v203
  buffer_store_dwordx4 v[200:203], v5, s[12:15], s48 offen offset:0 sc1
  v_pk_fma_f32 v[184:185], v[122:123], v[148:149], v[176:177] op_sel_hi:[0,1,1] neg_lo:[1,0,0] neg_hi:[1,0,0]
  v_pk_fma_f32 v[186:187], v[122:123], v[150:151], v[178:179] op_sel_hi:[0,1,1] neg_lo:[1,0,0] neg_hi:[1,0,0]
  v_pk_fma_f32 v[56:57], v[56:57], v[122:123], v[184:185] op_sel:[0,1,0]
  v_pk_fma_f32 v[58:59], v[58:59], v[122:123], v[186:187] op_sel:[0,1,0]
  v_pk_fma_f32 v[188:189], v[122:123], v[152:153], v[180:181] op_sel_hi:[0,1,1] neg_lo:[1,0,0] neg_hi:[1,0,0]
  v_pk_fma_f32 v[190:191], v[122:123], v[154:155], v[182:183] op_sel_hi:[0,1,1] neg_lo:[1,0,0] neg_hi:[1,0,0]
  v_pk_fma_f32 v[60:61], v[60:61], v[122:123], v[188:189] op_sel:[0,1,0]
  v_pk_fma_f32 v[62:63], v[62:63], v[122:123], v[190:191] op_sel:[0,1,0]
  v_cvt_pk_bf16_f32 v204, v56, v57
  v_cvt_pk_bf16_f32 v205, v58, v59
  v_cvt_pk_bf16_f32 v206, v60, v61
  v_cvt_pk_bf16_f32 v207, v62, v63
  v_pk_max_i16 v204, v204, 0
  v_pk_max_i16 v205, v205, 0
  v_pk_max_i16 v206, v206, 0
  v_pk_max_i16 v207, v207, 0
  s_nop 0
  v_permlane16_swap_b32 v204, v206
  v_permlane16_swap_b32 v205, v207
  buffer_store_dwordx4 v[204:207], v5, s[12:15], s48 offen offset:1024 sc1
  v_pk_fma_f32 v[184:185], v[124:125], v[148:149], v[176:177] op_sel_hi:[0,1,1] neg_lo:[1,0,0] neg_hi:[1,0,0]
  v_pk_fma_f32 v[186:187], v[124:125], v[150:151], v[178:179] op_sel_hi:[0,1,1] neg_lo:[1,0,0] neg_hi:[1,0,0]
  v_pk_fma_f32 v[84:85], v[84:85], v[124:125], v[184:185] op_sel:[0,1,0]
  v_pk_fma_f32 v[86:87], v[86:87], v[124:125], v[186:187] op_sel:[0,1,0]
  v_pk_fma_f32 v[188:189], v[124:125], v[152:153], v[180:181] op_sel_hi:[0,1,1] neg_lo:[1,0,0] neg_hi:[1,0,0]
  v_pk_fma_f32 v[190:191], v[124:125], v[154:155], v[182:183] op_sel_hi:[0,1,1] neg_lo:[1,0,0] neg_hi:[1,0,0]
  v_pk_fma_f32 v[88:89], v[88:89], v[124:125], v[188:189] op_sel:[0,1,0]
  v_pk_fma_f32 v[90:91], v[90:91], v[124:125], v[190:191] op_sel:[0,1,0]
  v_cvt_pk_bf16_f32 v192, v84, v85
  v_cvt_pk_bf16_f32 v193, v86, v87
  v_cvt_pk_bf16_f32 v194, v88, v89
  v_cvt_pk_bf16_f32 v195, v90, v91
  v_pk_max_i16 v192, v192, 0
  v_pk_max_i16 v193, v193, 0
  v_pk_max_i16 v194, v194, 0
  v_pk_max_i16 v195, v195, 0
  s_nop 0
  v_permlane16_swap_b32 v192, v194
  v_permlane16_swap_b32 v193, v195
  buffer_store_dwordx4 v[192:195], v5, s[12:15], s48 offen offset:2048 sc1
  v_pk_fma_f32 v[184:185], v[126:127], v[148:149], v[176:177] op_sel_hi:[0,1,1] neg_lo:[1,0,0] neg_hi:[1,0,0]
  v_pk_fma_f32 v[186:187], v[126:127], v[150:151], v[178:179] op_sel_hi:[0,1,1] neg_lo:[1,0,0] neg_hi:[1,0,0]
  v_pk_fma_f32 v[112:113], v[112:113], v[126:127], v[184:185] op_sel:[0,1,0]
  v_pk_fma_f32 v[114:115], v[114:115], v[126:127], v[186:187] op_sel:[0,1,0]
  v_pk_fma_f32 v[188:189], v[126:127], v[152:153], v[180:181] op_sel_hi:[0,1,1] neg_lo:[1,0,0] neg_hi:[1,0,0]
  v_pk_fma_f32 v[190:191], v[126:127], v[154:155], v[182:183] op_sel_hi:[0,1,1] neg_lo:[1,0,0] neg_hi:[1,0,0]
  v_pk_fma_f32 v[116:117], v[116:117], v[126:127], v[188:189] op_sel:[0,1,0]
  v_pk_fma_f32 v[118:119], v[118:119], v[126:127], v[190:191] op_sel:[0,1,0]
  v_cvt_pk_bf16_f32 v196, v112, v113
  v_cvt_pk_bf16_f32 v197, v114, v115
  v_cvt_pk_bf16_f32 v198, v116, v117
  v_cvt_pk_bf16_f32 v199, v118, v119
  v_pk_max_i16 v196, v196, 0
  v_pk_max_i16 v197, v197, 0
  v_pk_max_i16 v198, v198, 0
  v_pk_max_i16 v199, v199, 0
  s_nop 0
  v_permlane16_swap_b32 v196, v198
  v_permlane16_swap_b32 v197, v199
  buffer_store_dwordx4 v[196:199], v5, s[12:15], s48 offen offset:3072 sc1
  s_xor_b32 s47, s24, 1
  s_lshl_b32 s47, s47, 2
  s_add_u32 s47, s47, 138288
  v_mov_b32 v184, s47
  s_mov_b32 s33, 0
main_kernel_f1_xwx1:
  ds_read_b32 v185, v184
  s_waitcnt lgkmcnt(0)
  v_readfirstlane_b32 s34, v185
  s_nop 0
  s_cmp_lg_u32 s34, 0
  s_cbranch_scc1 main_kernel_f1_xxx1
  s_add_u32 s33, s33, 1
  s_cmp_lt_u32 s33, 400000
  s_cbranch_scc1 main_kernel_f1_xwx1
main_kernel_f1_xxx1:
  v_xor_b32 v7, 1024, v7
  ds_read_b128 v[184:187], v7
  s_waitcnt lgkmcnt(0)
  v_mov_b32 v200, v184
  v_mov_b32 v201, v185
  v_mov_b32 v202, v212
  v_mov_b32 v203, v213
  s_nop 0
  v_permlane16_swap_b32 v200, v202
  v_permlane16_swap_b32 v201, v203
  buffer_store_dwordx4 v[200:203], v5, s[12:15], s53 offen offset:2048 sc1
  v_mov_b32 v204, v186
  v_mov_b32 v205, v187
  v_mov_b32 v206, v214
  v_mov_b32 v207, v215
  s_nop 0
  v_permlane16_swap_b32 v204, v206
  v_permlane16_swap_b32 v205, v207
  buffer_store_dwordx4 v[204:207], v5, s[12:15], s53 offen offset:3072 sc1
main_kernel_f1_ep2:
  s_add_u32 s35, s25, 56
  s_waitcnt vmcnt(0)
  v_mov_b32 v6, 138256
  v_mov_b32 v7, 1
  s_mov_b64 exec, 1
  ds_add_rtn_u32 v7, v6, v7
  s_waitcnt lgkmcnt(0)
  v_readfirstlane_b32 s32, v7
  s_mov_b64 exec, -1
  s_cmp_lg_u32 s32, 3
  s_cbranch_scc1 main_kernel_sigf1
  s_lshl_b32 s33, s25, 1
  s_lshr_b32 s34, s26, 3
  s_add_u32 s33, s33, s34
  s_lshl_b32 s33, s33, 7
  s_and_b32 s34, s26, 7
  s_lshl_b32 s34, s34, 2
  s_add_u32 s33, s33, s34
  s_add_u32 s33, s33, 206336
  v_mov_b32 v6, s33
  v_mov_b32 v7, 1
  s_mov_b64 exec, 0x1
  buffer_store_dword v7, v6, s[28:31], 0 offen sc1
main_kernel_sigf1:
  s_mov_b64 exec, -1
  s_branch main_kernel_f2_c
main_kernel_f1_l:
  s_and_b32 s36, s2, 7
  s_lshr_b32 s37, s2, 3
  s_and_b32 s38, s36, 3
  s_lshr_b32 s39, s36, 2
  s_and_b32 s40, s37, 3
  s_lshr_b32 s41, s37, 2
  s_mul_i32 s38, s38, 4
  s_add_u32 s26, s38, s40
  s_mul_i32 s39, s39, 8
  s_add_u32 s25, s39, s41
  s_add_u32 s4, s66, 0x2800000
  s_addc_u32 s5, s67, 0
  s_mov_b32 s6, 0x400000
  s_mov_b32 s7, 0x20000
  s_mov_b32 s8, s72
  s_mov_b32 s9, s73
  s_mov_b32 s10, 0x700000
  s_mov_b32 s11, 0x20000
  s_sub_u32 s42, s24, 4
  s_lshl_b32 s43, s25, 7
  s_mul_i32 s44, s42, 32
  s_add_u32 s43, s43, s44
  v_lshrrev_b32 v3, 3, v2
  v_add_u32 v3, s43, v3
  s_mov_b32 s45, 2048
  v_mul_lo_u32 v3, s45, v3
  v_and_b32 v4, 7, v2
  v_lshrrev_b32 v5, 4, v2
  v_xor_b32 v6, 0, v5
  v_xor_b32 v6, v6, v4
  v_lshlrev_b32 v6, 4, v6
  v_add_u32 v6, v6, v3
  v_add_u32 v8, 0, v6
  v_xor_b32 v6, 4, v5
  v_xor_b32 v6, v6, v4
  v_lshlrev_b32 v6, 4, v6
  v_add_u32 v6, v6, v3
  v_add_u32 v9, 16384, v6
  v_xor_b32 v6, 0, v5
  v_xor_b32 v6, v6, v4
  v_lshlrev_b32 v6, 4, v6
  v_add_u32 v6, v6, v3
  v_add_u32 v10, 32768, v6
  v_xor_b32 v6, 4, v5
  v_xor_b32 v6, v6, v4
  v_lshlrev_b32 v6, 4, v6
  v_add_u32 v6, v6, v3
  v_add_u32 v11, 49152, v6
  s_mul_i32 s43, s42, 114688
  s_mul_i32 s44, s26, 448
  s_add_u32 s43, s43, s44
  v_add_u32 v3, 0, v2
  v_mul_u32_u24 v4, 2341, v3
  v_lshrrev_b32 v4, 16, v4
  v_mul_u32_u24 v5, 28, v4
  v_sub_u32 v3, v3, v5
  v_lshrrev_b32 v5, 2, v4
  v_and_b32 v5, 2, v5
  v_xor_b32 v3, v3, v5
  v_lshlrev_b32 v3, 4, v3
  s_mov_b32 s45, 7168
  v_mul_lo_u32 v4, s45, v4
  v_add_u32 v3, v3, v4
  v_add_u32 v12, s43, v3
  v_add_u32 v3, 64, v2
  v_mul_u32_u24 v4, 2341, v3
  v_lshrrev_b32 v4, 16, v4
  v_mul_u32_u24 v5, 28, v4
  v_sub_u32 v3, v3, v5
  v_lshrrev_b32 v5, 2, v4
  v_and_b32 v5, 2, v5
  v_xor_b32 v3, v3, v5
  v_lshlrev_b32 v3, 4, v3
  s_mov_b32 s45, 7168
  v_mul_lo_u32 v4, s45, v4
  v_add_u32 v3, v3, v4
  v_add_u32 v13, s43, v3
  v_add_u32 v3, 128, v2
  v_mul_u32_u24 v4, 2341, v3
  v_lshrrev_b32 v4, 16, v4
  v_mul_u32_u24 v5, 28, v4
  v_sub_u32 v3, v3, v5
  v_lshrrev_b32 v5, 2, v4
  v_and_b32 v5, 2, v5
  v_xor_b32 v3, v3, v5
  v_lshlrev_b32 v3, 4, v3
  s_mov_b32 s45, 7168
  v_mul_lo_u32 v4, s45, v4
  v_add_u32 v3, v3, v4
  v_add_u32 v14, s43, v3
  v_add_u32 v3, 192, v2
  v_mul_u32_u24 v4, 2341, v3
  v_lshrrev_b32 v4, 16, v4
  v_mul_u32_u24 v5, 28, v4
  v_sub_u32 v3, v3, v5
  v_lshrrev_b32 v5, 2, v4
  v_and_b32 v5, 2, v5
  v_xor_b32 v3, v3, v5
  v_lshlrev_b32 v3, 4, v3
  s_mov_b32 s45, 7168
  v_mul_lo_u32 v4, s45, v4
  v_add_u32 v3, v3, v4
  v_add_u32 v15, s43, v3
  v_add_u32 v3, 256, v2
  v_mul_u32_u24 v4, 2341, v3
  v_lshrrev_b32 v4, 16, v4
  v_mul_u32_u24 v5, 28, v4
  v_sub_u32 v3, v3, v5
  v_lshrrev_b32 v5, 2, v4
  v_and_b32 v5, 2, v5
  v_xor_b32 v3, v3, v5
  v_lshlrev_b32 v3, 4, v3
  s_mov_b32 s45, 7168
  v_mul_lo_u32 v4, s45, v4
  v_add_u32 v3, v3, v4
  v_add_u32 v16, s43, v3
  v_add_u32 v3, 320, v2
  v_mul_u32_u24 v4, 2341, v3
  v_lshrrev_b32 v4, 16, v4
  v_mul_u32_u24 v5, 28, v4
  v_sub_u32 v3, v3, v5
  v_lshrrev_b32 v5, 2, v4
  v_and_b32 v5, 2, v5
  v_xor_b32 v3, v3, v5
  v_lshlrev_b32 v3, 4, v3
  s_mov_b32 s45, 7168
  v_mul_lo_u32 v4, s45, v4
  v_add_u32 v3, v3, v4
  v_add_u32 v17, s43, v3
  v_add_u32 v3, 384, v2
  v_mul_u32_u24 v4, 2341, v3
  v_lshrrev_b32 v4, 16, v4
  v_mul_u32_u24 v5, 28, v4
  v_sub_u32 v3, v3, v5
  v_lshrrev_b32 v5, 2, v4
  v_and_b32 v5, 2, v5
  v_xor_b32 v3, v3, v5
  v_lshlrev_b32 v3, 4, v3
  s_mov_b32 s45, 7168
  v_mul_lo_u32 v4, s45, v4
  v_add_u32 v3, v3, v4
  v_add_u32 v18, s43, v3
  s_mul_i32 s46, s42, 4096
  s_mul_i32 s47, s42, 7168
  s_add_u32 s47, s47, 16384
  s_mov_b32 s62, 0
  s_mov_b32 s63, 0
  s_add_u32 s35, s25, 24
  s_cmp_eq_u32 s24, 4
  s_cbranch_scc1 main_kernel_f1_w4a
  s_add_u32 s52, s47, 0
  s_add_u32 s49, s63, 0
  s_add_u32 m0, s52, 0
  s_nop 0
  buffer_load_dwordx4 v12, s[8:11], s49 offen lds
  s_add_u32 m0, s52, 1024
  s_nop 0
  buffer_load_dwordx4 v13, s[8:11], s49 offen lds
  s_add_u32 m0, s52, 2048
  s_nop 0
  buffer_load_dwordx4 v14, s[8:11], s49 offen lds
  s_add_u32 m0, s52, 3072
  s_nop 0
  buffer_load_dwordx4 v15, s[8:11], s49 offen lds
  s_add_u32 m0, s52, 4096
  s_nop 0
  buffer_load_dwordx4 v16, s[8:11], s49 offen lds
  s_add_u32 m0, s52, 5120
  s_nop 0
  buffer_load_dwordx4 v17, s[8:11], s49 offen lds
  s_add_u32 m0, s52, 6144
  s_nop 0
  buffer_load_dwordx4 v18, s[8:11], s49 offen lds
  s_add_u32 s52, s47, 45056
  s_add_u32 s49, s63, 458752
  s_add_u32 m0, s52, 0
  s_nop 0
  buffer_load_dwordx4 v12, s[8:11], s49 offen lds
  s_add_u32 m0, s52, 1024
  s_nop 0
  buffer_load_dwordx4 v13, s[8:11], s49 offen lds
  s_add_u32 m0, s52, 2048
  s_nop 0
  buffer_load_dwordx4 v14, s[8:11], s49 offen lds
  s_add_u32 m0, s52, 3072
  s_nop 0
  buffer_load_dwordx4 v15, s[8:11], s49 offen lds
  s_add_u32 m0, s52, 4096
  s_nop 0
  buffer_load_dwordx4 v16, s[8:11], s49 offen lds
  s_add_u32 m0, s52, 5120
  s_nop 0
  buffer_load_dwordx4 v17, s[8:11], s49 offen lds
  s_add_u32 m0, s52, 6144
  s_nop 0
  buffer_load_dwordx4 v18, s[8:11], s49 offen lds
main_kernel_f1_w4a:
  s_cmp_lg_u32 s24, 4
  s_cbranch_scc1 main_kernel_dwf1
  s_lshl_b32 s34, s25, 2
  s_lshr_b32 s33, s26, 2
  s_add_u32 s34, s34, s33
  s_lshl_b32 s34, s34, 7
  s_add_u32 s34, s34, 173568
  v_lshlrev_b32 v6, 2, v2
  v_add_u32 v6, s34, v6
  s_mov_b32 s33, 0
  s_mov_b64 exec, 0xffff
main_kernel_pollf1:
  buffer_load_dword v7, v6, s[28:31], 0 offen sc1
  s_waitcnt vmcnt(0)
  v_cmp_ne_u32 vcc, 1, v7
  s_nop 0
  s_cmp_eq_u64 vcc, 0
  s_cbranch_scc1 main_kernel_pollxf1
  s_add_u32 s33, s33, 1
  s_cmp_ge_u32 s33, 400000
  s_cbranch_scc1 main_kernel_pollxf1
  s_sleep 2
  s_branch main_kernel_pollf1
main_kernel_pollxf1:
  s_mov_b64 exec, -1
  v_mov_b32 v6, 138276
  v_mov_b32 v7, 1
  ds_write_b32 v6, v7
  s_waitcnt lgkmcnt(0)
  s_branch main_kernel_dwxf1
main_kernel_dwf1:
  v_mov_b32 v6, 138276
  s_mov_b32 s33, 0
main_kernel_dwlf1:
  ds_read_b32 v7, v6
  s_waitcnt lgkmcnt(0)
  v_readfirstlane_b32 s34, v7
  s_nop 0
  s_cmp_lg_u32 s34, 0
  s_cbranch_scc1 main_kernel_dwxf1
  s_add_u32 s33, s33, 1
  s_cmp_ge_u32 s33, 1600000
  s_cbranch_scc1 main_kernel_dwxf1
  s_sleep 1
  s_branch main_kernel_dwlf1
main_kernel_dwxf1:
  s_cmp_lg_u32 s24, 4
  s_cbranch_scc1 main_kernel_f1_w4b
  s_add_u32 s52, s47, 0
  s_add_u32 s49, s63, 0
  s_add_u32 m0, s52, 0
  s_nop 0
  buffer_load_dwordx4 v12, s[8:11], s49 offen lds
  s_add_u32 m0, s52, 1024
  s_nop 0
  buffer_load_dwordx4 v13, s[8:11], s49 offen lds
  s_add_u32 m0, s52, 2048
  s_nop 0
  buffer_load_dwordx4 v14, s[8:11], s49 offen lds
  s_add_u32 m0, s52, 3072
  s_nop 0
  buffer_load_dwordx4 v15, s[8:11], s49 offen lds
  s_add_u32 m0, s52, 4096
  s_nop 0
  buffer_load_dwordx4 v16, s[8:11], s49 offen lds
  s_add_u32 m0, s52, 5120
  s_nop 0
  buffer_load_dwordx4 v17, s[8:11], s49 offen lds
  s_add_u32 m0, s52, 6144
  s_nop 0
  buffer_load_dwordx4 v18, s[8:11], s49 offen lds
  s_add_u32 s52, s47, 45056
  s_add_u32 s49, s63, 458752
  s_add_u32 m0, s52, 0
  s_nop 0
  buffer_load_dwordx4 v12, s[8:11], s49 offen lds
  s_add_u32 m0, s52, 1024
  s_nop 0
  buffer_load_dwordx4 v13, s[8:11], s49 offen lds
  s_add_u32 m0, s52, 2048
  s_nop 0
  buffer_load_dwordx4 v14, s[8:11], s49 offen lds
  s_add_u32 m0, s52, 3072
  s_nop 0
  buffer_load_dwordx4 v15, s[8:11], s49 offen lds
  s_add_u32 m0, s52, 4096
  s_nop 0
  buffer_load_dwordx4 v16, s[8:11], s49 offen lds
  s_add_u32 m0, s52, 5120
  s_nop 0
  buffer_load_dwordx4 v17, s[8:11], s49 offen lds
  s_add_u32 m0, s52, 6144
  s_nop 0
  buffer_load_dwordx4 v18, s[8:11], s49 offen lds
main_kernel_f1_w4b:
  s_add_u32 s51, s46, 0
  s_add_u32 s48, s62, 0
  s_add_u32 m0, s51, 0
  s_nop 0
  buffer_load_dwordx4 v8, s[4:7], s48 offen sc1 lds
  s_add_u32 m0, s51, 1024
  s_nop 0
  buffer_load_dwordx4 v9, s[4:7], s48 offen sc1 lds
  s_add_u32 m0, s51, 2048
  s_nop 0
  buffer_load_dwordx4 v10, s[4:7], s48 offen sc1 lds
  s_add_u32 m0, s51, 3072
  s_nop 0
  buffer_load_dwordx4 v11, s[4:7], s48 offen sc1 lds
  s_add_u32 s51, s46, 45056
  s_add_u32 s48, s62, 128
  s_add_u32 m0, s51, 0
  s_nop 0
  buffer_load_dwordx4 v8, s[4:7], s48 offen sc1 lds
  s_add_u32 m0, s51, 1024
  s_nop 0
  buffer_load_dwordx4 v9, s[4:7], s48 offen sc1 lds
  s_add_u32 m0, s51, 2048
  s_nop 0
  buffer_load_dwordx4 v10, s[4:7], s48 offen sc1 lds
  s_add_u32 m0, s51, 3072
  s_nop 0
  buffer_load_dwordx4 v11, s[4:7], s48 offen sc1 lds
  s_add_u32 s48, s62, 256
  s_add_u32 s49, s63, 917504
  s_mov_b32 s50, 90112
  s_waitcnt vmcnt(4)
  s_barrier
  s_add_u32 s51, s50, s46
  s_add_u32 s52, s50, s47
  s_add_u32 m0, s51, 0
  s_nop 0
  buffer_load_dwordx4 v8, s[4:7], s48 offen sc1 lds
  s_add_u32 m0, s51, 1024
  s_nop 0
  buffer_load_dwordx4 v9, s[4:7], s48 offen sc1 lds
  s_add_u32 m0, s51, 2048
  s_nop 0
  buffer_load_dwordx4 v10, s[4:7], s48 offen sc1 lds
  s_add_u32 m0, s51, 3072
  s_nop 0
  buffer_load_dwordx4 v11, s[4:7], s48 offen sc1 lds
  s_add_u32 m0, s52, 0
  s_nop 0
  buffer_load_dwordx4 v12, s[8:11], s49 offen lds
  s_add_u32 m0, s52, 1024
  s_nop 0
  buffer_load_dwordx4 v13, s[8:11], s49 offen lds
  s_add_u32 m0, s52, 2048
  s_nop 0
  buffer_load_dwordx4 v14, s[8:11], s49 offen lds
  s_add_u32 m0, s52, 3072
  s_nop 0
  buffer_load_dwordx4 v15, s[8:11], s49 offen lds
  s_add_u32 m0, s52, 4096
  s_nop 0
  buffer_load_dwordx4 v16, s[8:11], s49 offen lds
  s_add_u32 m0, s52, 5120
  s_nop 0
  buffer_load_dwordx4 v17, s[8:11], s49 offen lds
  s_add_u32 m0, s52, 6144
  s_nop 0
  buffer_load_dwordx4 v18, s[8:11], s49 offen lds
  s_add_u32 s48, s48, 128
  s_add_u32 s49, s49, 458752
  s_add_u32 s50, s50, 45056
  s_cmp_eq_u32 s50, 135168
  s_cselect_b32 s50, 0, s50
  s_waitcnt vmcnt(11)
  s_barrier
  s_add_u32 s51, s50, s46
  s_add_u32 s52, s50, s47
  s_add_u32 m0, s51, 0
  s_nop 0
  buffer_load_dwordx4 v8, s[4:7], s48 offen sc1 lds
  s_add_u32 m0, s51, 1024
  s_nop 0
  buffer_load_dwordx4 v9, s[4:7], s48 offen sc1 lds
  s_add_u32 m0, s51, 2048
  s_nop 0
  buffer_load_dwordx4 v10, s[4:7], s48 offen sc1 lds
  s_add_u32 m0, s51, 3072
  s_nop 0
  buffer_load_dwordx4 v11, s[4:7], s48 offen sc1 lds
  s_add_u32 m0, s52, 0
  s_nop 0
  buffer_load_dwordx4 v12, s[8:11], s49 offen lds
  s_add_u32 m0, s52, 1024
  s_nop 0
  buffer_load_dwordx4 v13, s[8:11], s49 offen lds
  s_add_u32 m0, s52, 2048
  s_nop 0
  buffer_load_dwordx4 v14, s[8:11], s49 offen lds
  s_add_u32 m0, s52, 3072
  s_nop 0
  buffer_load_dwordx4 v15, s[8:11], s49 offen lds
  s_add_u32 m0, s52, 4096
  s_nop 0
  buffer_load_dwordx4 v16, s[8:11], s49 offen lds
  s_add_u32 m0, s52, 5120
  s_nop 0
  buffer_load_dwordx4 v17, s[8:11], s49 offen lds
  s_add_u32 m0, s52, 6144
  s_nop 0
  buffer_load_dwordx4 v18, s[8:11], s49 offen lds
  s_add_u32 s48, s48, 128
  s_add_u32 s49, s49, 458752
  s_add_u32 s50, s50, 45056
  s_cmp_eq_u32 s50, 135168
  s_cselect_b32 s50, 0, s50
  s_mov_b32 s53, 12
main_kernel_f1_lloop:
  s_waitcnt vmcnt(11)
  s_barrier
  s_add_u32 s51, s50, s46
  s_add_u32 s52, s50, s47
  s_add_u32 m0, s51, 0
  s_nop 0
  buffer_load_dwordx4 v8, s[4:7], s48 offen sc1 lds
  s_add_u32 m0, s51, 1024
  s_nop 0
  buffer_load_dwordx4 v9, s[4:7], s48 offen sc1 lds
  s_add_u32 m0, s51, 2048
  s_nop 0
  buffer_load_dwordx4 v10, s[4:7], s48 offen sc1 lds
  s_add_u32 m0, s51, 3072
  s_nop 0
  buffer_load_dwordx4 v11, s[4:7], s48 offen sc1 lds
  s_add_u32 m0, s52, 0
  s_nop 0
  buffer_load_dwordx4 v12, s[8:11], s49 offen lds
  s_add_u32 m0, s52, 1024
  s_nop 0
  buffer_load_dwordx4 v13, s[8:11], s49 offen lds
  s_add_u32 m0, s52, 2048
  s_nop 0
  buffer_load_dwordx4 v14, s[8:11], s49 offen lds
  s_add_u32 m0, s52, 3072
  s_nop 0
  buffer_load_dwordx4 v15, s[8:11], s49 offen lds
  s_add_u32 m0, s52, 4096
  s_nop 0
  buffer_load_dwordx4 v16, s[8:11], s49 offen lds
  s_add_u32 m0, s52, 5120
  s_nop 0
  buffer_load_dwordx4 v17, s[8:11], s49 offen lds
  s_add_u32 m0, s52, 6144
  s_nop 0
  buffer_load_dwordx4 v18, s[8:11], s49 offen lds
  s_add_u32 s48, s48, 128
  s_add_u32 s49, s49, 458752
  s_add_u32 s50, s50, 45056
  s_cmp_eq_u32 s50, 135168
  s_cselect_b32 s50, 0, s50
  s_sub_u32 s53, s53, 1
  s_cmp_lg_u32 s53, 0
  s_cbranch_scc1 main_kernel_f1_lloop
  s_waitcnt vmcnt(11)
  s_barrier
  s_add_u32 s56, s66, 0x2c00000
  s_addc_u32 s57, s67, 0
  s_mov_b32 s58, 0x80000
  s_mov_b32 s59, 0x20000
  s_add_u32 s60, s66, 0x2d00000
  s_addc_u32 s61, s67, 0
  s_mov_b32 s62, 0x70000
  s_mov_b32 s63, 0x20000
  s_cmp_ge_u32 s42, 2
  s_cbranch_scc1 main_kernel_f1_ubld
  s_lshl_b32 s34, s25, 2
  s_lshr_b32 s33, s26, 2
  s_add_u32 s34, s34, s33
  s_lshl_b32 s34, s34, 7
  s_add_u32 s34, s34, 272896
  v_lshlrev_b32 v6, 2, v2
  v_add_u32 v6, s34, v6
  s_mov_b32 s33, 0
  s_mov_b64 exec, 0xffff
main_kernel_pollf1b:
  buffer_load_dword v7, v6, s[28:31], 0 offen sc1
  s_waitcnt vmcnt(0)
  v_cmp_ne_u32 vcc, 1, v7
  s_nop 0
  s_cmp_eq_u64 vcc, 0
  s_cbranch_scc1 main_kernel_pollxf1b
  s_add_u32 s33, s33, 1
  s_cmp_ge_u32 s33, 400000
  s_cbranch_scc1 main_kernel_pollxf1b
  s_sleep 2
  s_branch main_kernel_pollf1b
main_kernel_pollxf1b:
  s_mov_b64 exec, -1
  s_lshl_b32 s43, s42, 6
  v_add_u32 v3, s43, v2
  s_lshl_b32 s44, s25, 7
  v_add_u32 v4, s44, v3
  v_lshlrev_b32 v4, 3, v4
  s_mov_b32 s45, 0
  buffer_load_dwordx2 v[32:33], v4, s[56:59], s45 offen sc1
  s_mov_b32 s45, 16384
  buffer_load_dwordx2 v[34:35], v4, s[56:59], s45 offen sc1
  s_mov_b32 s45, 32768
  buffer_load_dwordx2 v[36:37], v4, s[56:59], s45 offen sc1
  s_mov_b32 s45, 49152
  buffer_load_dwordx2 v[38:39], v4, s[56:59], s45 offen sc1
  s_mov_b32 s45, 65536
  buffer_load_dwordx2 v[40:41], v4, s[56:59], s45 offen sc1
  s_mov_b32 s45, 81920
  buffer_load_dwordx2 v[42:43], v4, s[56:59], s45 offen sc1
  s_mov_b32 s45, 98304
  buffer_load_dwordx2 v[44:45], v4, s[56:59], s45 offen sc1
  s_mov_b32 s45, 114688
  buffer_load_dwordx2 v[46:47], v4, s[56:59], s45 offen sc1
  s_mov_b32 s45, 131072
  buffer_load_dwordx2 v[48:49], v4, s[56:59], s45 offen sc1
  s_mov_b32 s45, 147456
  buffer_load_dwordx2 v[50:51], v4, s[56:59], s45 offen sc1
  s_mov_b32 s45, 163840
  buffer_load_dwordx2 v[52:53], v4, s[56:59], s45 offen sc1
  s_mov_b32 s45, 180224
  buffer_load_dwordx2 v[54:55], v4, s[56:59], s45 offen sc1
  s_mov_b32 s45, 196608
  buffer_load_dwordx2 v[56:57], v4, s[56:59], s45 offen sc1
  s_mov_b32 s45, 212992
  buffer_load_dwordx2 v[58:59], v4, s[56:59], s45 offen sc1
  s_mov_b32 s45, 229376
  buffer_load_dwordx2 v[60:61], v4, s[56:59], s45 offen sc1
  s_mov_b32 s45, 245760
  buffer_load_dwordx2 v[62:63], v4, s[56:59], s45 offen sc1
  s_mov_b32 s45, 262144
  buffer_load_dwordx2 v[64:65], v4, s[56:59], s45 offen sc1
  s_mov_b32 s45, 278528
  buffer_load_dwordx2 v[66:67], v4, s[56:59], s45 offen sc1
  s_mov_b32 s45, 294912
  buffer_load_dwordx2 v[68:69], v4, s[56:59], s45 offen sc1
  s_mov_b32 s45, 311296
  buffer_load_dwordx2 v[70:71], v4, s[56:59], s45 offen sc1
  s_mov_b32 s45, 327680
  buffer_load_dwordx2 v[72:73], v4, s[56:59], s45 offen sc1
  s_mov_b32 s45, 344064
  buffer_load_dwordx2 v[74:75], v4, s[56:59], s45 offen sc1
  s_mov_b32 s45, 360448
  buffer_load_dwordx2 v[76:77], v4, s[56:59], s45 offen sc1
  s_mov_b32 s45, 376832
  buffer_load_dwordx2 v[78:79], v4, s[56:59], s45 offen sc1
  s_mov_b32 s45, 393216
  buffer_load_dwordx2 v[80:81], v4, s[56:59], s45 offen sc1
  s_mov_b32 s45, 409600
  buffer_load_dwordx2 v[82:83], v4, s[56:59], s45 offen sc1
  s_mov_b32 s45, 425984
  buffer_load_dwordx2 v[84:85], v4, s[56:59], s45 offen sc1
  s_mov_b32 s45, 442368
  buffer_load_dwordx2 v[86:87], v4, s[56:59], s45 offen sc1
  s_mov_b32 s45, 458752
  buffer_load_dwordx2 v[88:89], v4, s[56:59], s45 offen sc1
  s_mov_b32 s45, 475136
  buffer_load_dwordx2 v[90:91], v4, s[56:59], s45 offen sc1
  s_mov_b32 s45, 491520
  buffer_load_dwordx2 v[92:93], v4, s[56:59], s45 offen sc1
  s_mov_b32 s45, 507904
  buffer_load_dwordx2 v[94:95], v4, s[56:59], s45 offen sc1
  s_branch main_kernel_f1_ldd
main_kernel_f1_ubld:
  s_add_u32 s35, s26, 40
  s_lshl_b32 s32, s35, 8
  v_mov_b32 v6, s32
  s_mov_b32 s33, 0
  s_mov_b64 exec, 1
main_kernel_pollf1u:
  buffer_load_dword v7, v6, s[28:31], 0 offen offset:128 sc1
  s_waitcnt vmcnt(0)
  v_cmp_gt_u32 vcc, 16, v7
  s_nop 0
  s_cmp_eq_u64 vcc, 0
  s_cbranch_scc1 main_kernel_pollxf1u
  s_add_u32 s33, s33, 1
  s_cmp_ge_u32 s33, 400000
  s_cbranch_scc1 main_kernel_pollxf1u
  s_sleep 2
  s_branch main_kernel_pollf1u
main_kernel_pollxf1u:
  s_mov_b64 exec, -1
  s_sub_u32 s43, s42, 2
  s_lshl_b32 s43, s43, 6
  v_add_u32 v3, s43, v2
  s_mul_i32 s44, s26, 896
  v_lshlrev_b32 v4, 3, v3
  v_add_u32 v4, s44, v4
  s_mov_b32 s45, 0
  buffer_load_dwordx2 v[32:33], v4, s[60:63], s45 offen sc1
  s_mov_b32 s45, 14336
  buffer_load_dwordx2 v[34:35], v4, s[60:63], s45 offen sc1
  s_mov_b32 s45, 28672
  buffer_load_dwordx2 v[36:37], v4, s[60:63], s45 offen sc1
  s_mov_b32 s45, 43008
  buffer_load_dwordx2 v[38:39], v4, s[60:63], s45 offen sc1
  s_mov_b32 s45, 57344
  buffer_load_dwordx2 v[40:41], v4, s[60:63], s45 offen sc1
  s_mov_b32 s45, 71680
  buffer_load_dwordx2 v[42:43], v4, s[60:63], s45 offen sc1
  s_mov_b32 s45, 86016
  buffer_load_dwordx2 v[44:45], v4, s[60:63], s45 offen sc1
  s_mov_b32 s45, 100352
  buffer_load_dwordx2 v[46:47], v4, s[60:63], s45 offen sc1
  s_mov_b32 s45, 114688
  buffer_load_dwordx2 v[48:49], v4, s[60:63], s45 offen sc1
  s_mov_b32 s45, 129024
  buffer_load_dwordx2 v[50:51], v4, s[60:63], s45 offen sc1
  s_mov_b32 s45, 143360
  buffer_load_dwordx2 v[52:53], v4, s[60:63], s45 offen sc1
  s_mov_b32 s45, 157696
  buffer_load_dwordx2 v[54:55], v4, s[60:63], s45 offen sc1
  s_mov_b32 s45, 172032
  buffer_load_dwordx2 v[56:57], v4, s[60:63], s45 offen sc1
  s_mov_b32 s45, 186368
  buffer_load_dwordx2 v[58:59], v4, s[60:63], s45 offen sc1
  s_mov_b32 s45, 200704
  buffer_load_dwordx2 v[60:61], v4, s[60:63], s45 offen sc1
  s_mov_b32 s45, 215040
  buffer_load_dwordx2 v[62:63], v4, s[60:63], s45 offen sc1
  s_mov_b32 s45, 229376
  buffer_load_dwordx2 v[64:65], v4, s[60:63], s45 offen sc1
  s_mov_b32 s45, 243712
  buffer_load_dwordx2 v[66:67], v4, s[60:63], s45 offen sc1
  s_mov_b32 s45, 258048
  buffer_load_dwordx2 v[68:69], v4, s[60:63], s45 offen sc1
  s_mov_b32 s45, 272384
  buffer_load_dwordx2 v[70:71], v4, s[60:63], s45 offen sc1
  s_mov_b32 s45, 286720
  buffer_load_dwordx2 v[72:73], v4, s[60:63], s45 offen sc1
  s_mov_b32 s45, 301056
  buffer_load_dwordx2 v[74:75], v4, s[60:63], s45 offen sc1
  s_mov_b32 s45, 315392
  buffer_load_dwordx2 v[76:77], v4, s[60:63], s45 offen sc1
  s_mov_b32 s45, 329728
  buffer_load_dwordx2 v[78:79], v4, s[60:63], s45 offen sc1
  s_mov_b32 s45, 344064
  buffer_load_dwordx2 v[80:81], v4, s[60:63], s45 offen sc1
  s_mov_b32 s45, 358400
  buffer_load_dwordx2 v[82:83], v4, s[60:63], s45 offen sc1
  s_mov_b32 s45, 372736
  buffer_load_dwordx2 v[84:85], v4, s[60:63], s45 offen sc1
  s_mov_b32 s45, 387072
  buffer_load_dwordx2 v[86:87], v4, s[60:63], s45 offen sc1
  s_mov_b32 s45, 401408
  buffer_load_dwordx2 v[88:89], v4, s[60:63], s45 offen sc1
  s_mov_b32 s45, 415744
  buffer_load_dwordx2 v[90:91], v4, s[60:63], s45 offen sc1
  s_mov_b32 s45, 430080
  buffer_load_dwordx2 v[92:93], v4, s[60:63], s45 offen sc1
  s_mov_b32 s45, 444416
  buffer_load_dwordx2 v[94:95], v4, s[60:63], s45 offen sc1
main_kernel_f1_ldd:
  s_waitcnt vmcnt(32)
  s_barrier
  s_waitcnt vmcnt(0)
  s_cmp_ge_u32 s42, 2
  s_cbranch_scc1 main_kernel_f1_ubred
  v_add_f32 v32, v32, v34
  v_add_f32 v33, v33, v35
  v_add_f32 v32, v32, v36
  v_add_f32 v33, v33, v37
  v_add_f32 v32, v32, v38
  v_add_f32 v33, v33, v39
  v_add_f32 v32, v32, v40
  v_add_f32 v33, v33, v41
  v_add_f32 v32, v32, v42
  v_add_f32 v33, v33, v43
  v_add_f32 v32, v32, v44
  v_add_f32 v33, v33, v45
  v_add_f32 v32, v32, v46
  v_add_f32 v33, v33, v47
  v_add_f32 v32, v32, v48
  v_add_f32 v33, v33, v49
  v_add_f32 v32, v32, v50
  v_add_f32 v33, v33, v51
  v_add_f32 v32, v32, v52
  v_add_f32 v33, v33, v53
  v_add_f32 v32, v32, v54
  v_add_f32 v33, v33, v55
  v_add_f32 v32, v32, v56
  v_add_f32 v33, v33, v57
  v_add_f32 v32, v32, v58
  v_add_f32 v33, v33, v59
  v_add_f32 v32, v32, v60
  v_add_f32 v33, v33, v61
  v_add_f32 v32, v32, v62
  v_add_f32 v33, v33, v63
  v_add_f32 v32, v32, v64
  v_add_f32 v33, v33, v65
  v_add_f32 v32, v32, v66
  v_add_f32 v33, v33, v67
  v_add_f32 v32, v32, v68
  v_add_f32 v33, v33, v69
  v_add_f32 v32, v32, v70
  v_add_f32 v33, v33, v71
  v_add_f32 v32, v32, v72
  v_add_f32 v33, v33, v73
  v_add_f32 v32, v32, v74
  v_add_f32 v33, v33, v75
  v_add_f32 v32, v32, v76
  v_add_f32 v33, v33, v77
  v_add_f32 v32, v32, v78
  v_add_f32 v33, v33, v79
  v_add_f32 v32, v32, v80
  v_add_f32 v33, v33, v81
  v_add_f32 v32, v32, v82
  v_add_f32 v33, v33, v83
  v_add_f32 v32, v32, v84
  v_add_f32 v33, v33, v85
  v_add_f32 v32, v32, v86
  v_add_f32 v33, v33, v87
  v_add_f32 v32, v32, v88
  v_add_f32 v33, v33, v89
  v_add_f32 v32, v32, v90
  v_add_f32 v33, v33, v91
  v_add_f32 v32, v32, v92
  v_add_f32 v33, v33, v93
  v_add_f32 v32, v32, v94
  v_add_f32 v33, v33, v95
  v_mul_f32 v32, 0x3a800000, v32
  v_mul_f32 v33, 0x3a800000, v33
  v_fma_f32 v33, -v32, v32, v33
  v_max_f32 v33, 0, v33
  v_add_f32 v33, 0x3727c5ac, v33
  v_rsq_f32 v33, v33
  s_nop 0
  v_mul_f32 v32, v32, v33
  v_lshlrev_b32 v4, 3, v3
  v_add_u32 v4, 135168, v4
  ds_write_b64 v4, v[32:33]
  s_branch main_kernel_f1_redd
main_kernel_f1_ubred:
  v_add_f32 v32, v32, v36
  v_add_f32 v33, v33, v37
  v_add_f32 v34, v34, v38
  v_add_f32 v35, v35, v39
  v_add_f32 v32, v32, v40
  v_add_f32 v33, v33, v41
  v_add_f32 v34, v34, v42
  v_add_f32 v35, v35, v43
  v_add_f32 v32, v32, v44
  v_add_f32 v33, v33, v45
  v_add_f32 v34, v34, v46
  v_add_f32 v35, v35, v47
  v_add_f32 v32, v32, v48
  v_add_f32 v33, v33, v49
  v_add_f32 v34, v34, v50
  v_add_f32 v35, v35, v51
  v_add_f32 v32, v32, v52
  v_add_f32 v33, v33, v53
  v_add_f32 v34, v34, v54
  v_add_f32 v35, v35, v55
  v_add_f32 v32, v32, v56
  v_add_f32 v33, v33, v57
  v_add_f32 v34, v34, v58
  v_add_f32 v35, v35, v59
  v_add_f32 v32, v32, v60
  v_add_f32 v33, v33, v61
  v_add_f32 v34, v34, v62
  v_add_f32 v35, v35, v63
  v_add_f32 v32, v32, v64
  v_add_f32 v33, v33, v65
  v_add_f32 v34, v34, v66
  v_add_f32 v35, v35, v67
  v_add_f32 v32, v32, v68
  v_add_f32 v33, v33, v69
  v_add_f32 v34, v34, v70
  v_add_f32 v35, v35, v71
  v_add_f32 v32, v32, v72
  v_add_f32 v33, v33, v73
  v_add_f32 v34, v34, v74
  v_add_f32 v35, v35, v75
  v_add_f32 v32, v32, v76
  v_add_f32 v33, v33, v77
  v_add_f32 v34, v34, v78
  v_add_f32 v35, v35, v79
  v_add_f32 v32, v32, v80
  v_add_f32 v33, v33, v81
  v_add_f32 v34, v34, v82
  v_add_f32 v35, v35, v83
  v_add_f32 v32, v32, v84
  v_add_f32 v33, v33, v85
  v_add_f32 v34, v34, v86
  v_add_f32 v35, v35, v87
  v_add_f32 v32, v32, v88
  v_add_f32 v33, v33, v89
  v_add_f32 v34, v34, v90
  v_add_f32 v35, v35, v91
  v_add_f32 v32, v32, v92
  v_add_f32 v33, v33, v93
  v_add_f32 v34, v34, v94
  v_add_f32 v35, v35, v95
  v_lshlrev_b32 v4, 3, v3
  v_add_u32 v4, 136192, v4
  v_cmp_gt_u32 vcc, 112, v3
  s_nop 0
  s_and_saveexec_b64 s[44:45], vcc
  ds_write_b64 v4, v[32:33]
  ds_write_b64 v4, v[34:35] offset:896
  s_mov_b64 exec, s[44:45]
main_kernel_f1_redd:
  s_waitcnt lgkmcnt(0)
  s_barrier
  s_branch main_kernel_f2_l
main_kernel_f2_c:
  s_and_b32 s36, s2, 7
  s_lshr_b32 s37, s2, 3
  s_and_b32 s27, s36, 1
  s_lshr_b32 s36, s36, 1
  s_and_b32 s26, s37, 7
  s_lshr_b32 s37, s37, 3
  s_lshl_b32 s36, s36, 2
  s_add_u32 s25, s36, s37
  s_lshr_b32 s42, s24, 1
  s_and_b32 s43, s24, 1
  v_and_b32 v3, 15, v2
  v_lshrrev_b32 v4, 4, v2
  s_lshl_b32 s44, s25, 7
  s_lshl_b32 s45, s42, 6
  s_add_u32 s44, s44, s45
  s_mul_i32 s46, s26, 128
  s_mul_i32 s45, s43, 64
  s_add_u32 s46, s46, s45
  s_add_u32 s20, s66, 0x20000
  s_addc_u32 s21, s67, 0
  s_mov_b32 s22, 0x6000
  s_mov_b32 s23, 0x20000
  s_mov_b32 s12, s78
  s_mov_b32 s13, s79
  s_mov_b32 s14, 0x400000
  s_mov_b32 s15, 0x20000
  s_add_u32 s16, s66, 0x1500000
  s_addc_u32 s17, s67, 0
  s_mov_b32 s18, 0x400000
  s_mov_b32 s19, 0x20000
  s_lshl_b32 s47, s27, 5
  s_add_u32 s46, s46, s47
  s_lshl_b32 s47, s25, 4
  s_lshl_b32 s48, s26, 1
  s_add_u32 s47, s47, s48
  s_add_u32 s47, s47, s43
  s_lshl_b32 s47, s47, 2
  s_lshl_b32 s48, s42, 1
  s_add_u32 s47, s47, s48
  s_add_u32 s47, s47, s27
  s_lshl_b32 s47, s47, 12
  v_lshlrev_b32 v5, 4, v2
  buffer_load_dwordx4 v[142:145], v5, s[16:19], s47 offen offset:0 sc1
  buffer_load_dwordx4 v[146:149], v5, s[16:19], s47 offen offset:1024 sc1
  buffer_load_dwordx4 v[150:153], v5, s[16:19], s47 offen offset:2048 sc1
  buffer_load_dwordx4 v[154:157], v5, s[16:19], s47 offen offset:3072 sc1
  v_lshlrev_b32 v6, 4, v4
  s_lshl_b32 s47, s46, 2
  s_add_u32 s47, s47, 20480
  buffer_load_dwordx4 v[158:161], v6, s[20:23], s47 offen offset:0 sc1
  buffer_load_dwordx4 v[162:165], v6, s[20:23], s47 offen offset:64 sc1
  v_lshrrev_b32 v5, 1, v3
  v_xor_b32 v5, v5, v4
  v_and_b32 v5, 7, v5
  v_lshlrev_b32 v5, 4, v5
  s_lshl_b32 s47, s42, 6
  v_add_u32 v6, s47, v3
  v_lshlrev_b32 v6, 7, v6
  v_add_u32 v136, v5, v6
  v_xor_b32 v137, 64, v136
  v_lshrrev_b32 v5, 2, v3
  v_and_b32 v6, 3, v2
  v_lshlrev_b32 v7, 3, v4
  v_add_u32 v7, v7, v5
  v_mul_u32_u24 v7, 256, v7
  v_lshlrev_b32 v6, 3, v6
  v_add_u32 v7, v7, v6
  v_add_u32 v7, 16384, v7
  v_and_b32 v6, 1, v4
  v_lshlrev_b32 v6, 2, v6
  v_or_b32 v5, v5, v6
  s_mul_i32 s47, s43, 4
  s_add_u32 s48, s47, 0
  v_xor_b32 v6, s48, v5
  v_lshlrev_b32 v6, 5, v6
  v_add_u32 v138, v7, v6
  s_add_u32 s48, s47, 1
  v_xor_b32 v6, s48, v5
  v_lshlrev_b32 v6, 5, v6
  v_add_u32 v139, v7, v6
  s_add_u32 s48, s47, 2
  v_xor_b32 v6, s48, v5
  v_lshlrev_b32 v6, 5, v6
  v_add_u32 v140, v7, v6
  s_add_u32 s48, s47, 3
  v_xor_b32 v6, s48, v5
  v_lshlrev_b32 v6, 5, v6
  v_add_u32 v141, v7, v6
  v_mov_b32 v8, 0
  v_mov_b32 v9, 0
  v_mov_b32 v10, 0
  v_mov_b32 v11, 0
  v_mov_b32 v12, 0
  v_mov_b32 v13, 0
  v_mov_b32 v14, 0
  v_mov_b32 v15, 0
  v_mov_b32 v16, 0
  v_mov_b32 v17, 0
  v_mov_b32 v18, 0
  v_mov_b32 v19, 0
  v_mov_b32 v20, 0
  v_mov_b32 v21, 0
  v_mov_b32 v22, 0
  v_mov_b32 v23, 0
  v_mov_b32 v24, 0
  v_mov_b32 v25, 0
  v_mov_b32 v26, 0
  v_mov_b32 v27, 0
  v_mov_b32 v28, 0
  v_mov_b32 v29, 0
  v_mov_b32 v30, 0
  v_mov_b32 v31, 0
  v_mov_b32 v32, 0
  v_mov_b32 v33, 0
  v_mov_b32 v34, 0
  v_mov_b32 v35, 0
  v_mov_b32 v36, 0
  v_mov_b32 v37, 0
  v_mov_b32 v38, 0
  v_mov_b32 v39, 0
  v_mov_b32 v40, 0
  v_mov_b32 v41, 0
  v_mov_b32 v42, 0
  v_mov_b32 v43, 0
  v_mov_b32 v44, 0
  v_mov_b32 v45, 0
  v_mov_b32 v46, 0
  v_mov_b32 v47, 0
  v_mov_b32 v48, 0
  v_mov_b32 v49, 0
  v_mov_b32 v50, 0
  v_mov_b32 v51, 0
  v_mov_b32 v52, 0
  v_mov_b32 v53, 0
  v_mov_b32 v54, 0
  v_mov_b32 v55, 0
  v_mov_b32 v56, 0
  v_mov_b32 v57, 0
  v_mov_b32 v58, 0
  v_mov_b32 v59, 0
  v_mov_b32 v60, 0
  v_mov_b32 v61, 0
  v_mov_b32 v62, 0
  v_mov_b32 v63, 0
  v_mov_b32 v64, 0
  v_mov_b32 v65, 0
  v_mov_b32 v66, 0
  v_mov_b32 v67, 0
  v_mov_b32 v68, 0
  v_mov_b32 v69, 0
  v_mov_b32 v70, 0
  v_mov_b32 v71, 0
  s_mov_b32 s49, 0
  s_mov_b32 s54, 32768
  s_mov_b32 s55, 0xfffe8000
  s_barrier
  ds_read_b128 v[72:75], v136 offset:0
  ds_read_b64_tr_b16 v[88:89], v138 offset:0
  ds_read_b64_tr_b16 v[90:91], v138 offset:1024
  ds_read_b128 v[76:79], v136 offset:2048
  ds_read_b128 v[80:83], v136 offset:4096
  ds_read_b128 v[84:87], v136 offset:6144
  ds_read_b64_tr_b16 v[92:93], v139 offset:0
  ds_read_b64_tr_b16 v[94:95], v139 offset:1024
  ds_read_b64_tr_b16 v[96:97], v140 offset:0
  ds_read_b64_tr_b16 v[98:99], v140 offset:1024
  ds_read_b64_tr_b16 v[100:101], v141 offset:0
  ds_read_b64_tr_b16 v[102:103], v141 offset:1024
  s_mov_b32 s50, 27
.p2align 6
main_kernel_f2_cloop:
  s_waitcnt lgkmcnt(0)
  v_mfma_f32_16x16x32_bf16 v[8:11], v[88:91], v[72:75], v[8:11]
  s_add_u32 s49, s49, 1
  ds_read_b128 v[104:107], v137 offset:0
  v_mfma_f32_16x16x32_bf16 v[12:15], v[92:95], v[72:75], v[12:15]
  s_cmp_eq_u32 s49, 4
  ds_read_b64_tr_b16 v[120:121], v138 offset:8192
  v_mfma_f32_16x16x32_bf16 v[16:19], v[96:99], v[72:75], v[16:19]
  s_cselect_b32 s51, s55, s54
  ds_read_b64_tr_b16 v[122:123], v138 offset:9216
  v_mfma_f32_16x16x32_bf16 v[20:23], v[100:103], v[72:75], v[20:23]
  s_cselect_b32 s49, 0, s49
  ds_read_b128 v[108:111], v137 offset:2048
  v_mfma_f32_16x16x32_bf16 v[24:27], v[88:91], v[76:79], v[24:27]
  ds_read_b128 v[112:115], v137 offset:4096
  v_mfma_f32_16x16x32_bf16 v[28:31], v[92:95], v[76:79], v[28:31]
  ds_read_b128 v[116:119], v137 offset:6144
  v_mfma_f32_16x16x32_bf16 v[32:35], v[96:99], v[76:79], v[32:35]
  ds_read_b64_tr_b16 v[124:125], v139 offset:8192
  v_mfma_f32_16x16x32_bf16 v[36:39], v[100:103], v[76:79], v[36:39]
  ds_read_b64_tr_b16 v[126:127], v139 offset:9216
  v_mfma_f32_16x16x32_bf16 v[40:43], v[88:91], v[80:83], v[40:43]
  ds_read_b64_tr_b16 v[128:129], v140 offset:8192
  v_mfma_f32_16x16x32_bf16 v[44:47], v[92:95], v[80:83], v[44:47]
  ds_read_b64_tr_b16 v[130:131], v140 offset:9216
  v_mfma_f32_16x16x32_bf16 v[48:51], v[96:99], v[80:83], v[48:51]
  ds_read_b64_tr_b16 v[132:133], v141 offset:8192
  v_mfma_f32_16x16x32_bf16 v[52:55], v[100:103], v[80:83], v[52:55]
  ds_read_b64_tr_b16 v[134:135], v141 offset:9216
  v_mfma_f32_16x16x32_bf16 v[56:59], v[88:91], v[84:87], v[56:59]
  v_add_u32 v136, s51, v136
  v_mfma_f32_16x16x32_bf16 v[60:63], v[92:95], v[84:87], v[60:63]
  v_add_u32 v137, s51, v137
  v_mfma_f32_16x16x32_bf16 v[64:67], v[96:99], v[84:87], v[64:67]
  v_add_u32 v138, s51, v138
  v_mfma_f32_16x16x32_bf16 v[68:71], v[100:103], v[84:87], v[68:71]
  v_add_u32 v139, s51, v139
  v_add_u32 v140, s51, v140
  v_add_u32 v141, s51, v141
  s_waitcnt lgkmcnt(0)
  s_barrier
  v_mfma_f32_16x16x32_bf16 v[8:11], v[120:123], v[104:107], v[8:11]
  ds_read_b128 v[72:75], v136 offset:0
  v_mfma_f32_16x16x32_bf16 v[12:15], v[124:127], v[104:107], v[12:15]
  s_sub_u32 s50, s50, 1
  ds_read_b64_tr_b16 v[88:89], v138 offset:0
  v_mfma_f32_16x16x32_bf16 v[16:19], v[128:131], v[104:107], v[16:19]
  s_cmp_lg_u32 s50, 0
  ds_read_b64_tr_b16 v[90:91], v138 offset:1024
  v_mfma_f32_16x16x32_bf16 v[20:23], v[132:135], v[104:107], v[20:23]
  ds_read_b128 v[76:79], v136 offset:2048
  v_mfma_f32_16x16x32_bf16 v[24:27], v[120:123], v[108:111], v[24:27]
  ds_read_b128 v[80:83], v136 offset:4096
  v_mfma_f32_16x16x32_bf16 v[28:31], v[124:127], v[108:111], v[28:31]
  ds_read_b128 v[84:87], v136 offset:6144
  v_mfma_f32_16x16x32_bf16 v[32:35], v[128:131], v[108:111], v[32:35]
  ds_read_b64_tr_b16 v[92:93], v139 offset:0
  v_mfma_f32_16x16x32_bf16 v[36:39], v[132:135], v[108:111], v[36:39]
  ds_read_b64_tr_b16 v[94:95], v139 offset:1024
  v_mfma_f32_16x16x32_bf16 v[40:43], v[120:123], v[112:115], v[40:43]
  ds_read_b64_tr_b16 v[96:97], v140 offset:0
  v_mfma_f32_16x16x32_bf16 v[44:47], v[124:127], v[112:115], v[44:47]
  ds_read_b64_tr_b16 v[98:99], v140 offset:1024
  v_mfma_f32_16x16x32_bf16 v[48:51], v[128:131], v[112:115], v[48:51]
  ds_read_b64_tr_b16 v[100:101], v141 offset:0
  v_mfma_f32_16x16x32_bf16 v[52:55], v[132:135], v[112:115], v[52:55]
  ds_read_b64_tr_b16 v[102:103], v141 offset:1024
  v_mfma_f32_16x16x32_bf16 v[56:59], v[120:123], v[116:119], v[56:59]
  v_mfma_f32_16x16x32_bf16 v[60:63], v[124:127], v[116:119], v[60:63]
  v_mfma_f32_16x16x32_bf16 v[64:67], v[128:131], v[116:119], v[64:67]
  v_mfma_f32_16x16x32_bf16 v[68:71], v[132:135], v[116:119], v[68:71]
  s_cbranch_scc1 main_kernel_f2_cloop
  s_waitcnt lgkmcnt(0)
  v_mfma_f32_16x16x32_bf16 v[8:11], v[88:91], v[72:75], v[8:11]
  ds_read_b128 v[104:107], v137 offset:0
  v_mfma_f32_16x16x32_bf16 v[12:15], v[92:95], v[72:75], v[12:15]
  ds_read_b64_tr_b16 v[120:121], v138 offset:8192
  v_mfma_f32_16x16x32_bf16 v[16:19], v[96:99], v[72:75], v[16:19]
  ds_read_b64_tr_b16 v[122:123], v138 offset:9216
  v_mfma_f32_16x16x32_bf16 v[20:23], v[100:103], v[72:75], v[20:23]
  ds_read_b128 v[108:111], v137 offset:2048
  v_mfma_f32_16x16x32_bf16 v[24:27], v[88:91], v[76:79], v[24:27]
  ds_read_b128 v[112:115], v137 offset:4096
  v_mfma_f32_16x16x32_bf16 v[28:31], v[92:95], v[76:79], v[28:31]
  ds_read_b128 v[116:119], v137 offset:6144
  v_mfma_f32_16x16x32_bf16 v[32:35], v[96:99], v[76:79], v[32:35]
  ds_read_b64_tr_b16 v[124:125], v139 offset:8192
  v_mfma_f32_16x16x32_bf16 v[36:39], v[100:103], v[76:79], v[36:39]
  ds_read_b64_tr_b16 v[126:127], v139 offset:9216
  v_mfma_f32_16x16x32_bf16 v[40:43], v[88:91], v[80:83], v[40:43]
  ds_read_b64_tr_b16 v[128:129], v140 offset:8192
  v_mfma_f32_16x16x32_bf16 v[44:47], v[92:95], v[80:83], v[44:47]
  ds_read_b64_tr_b16 v[130:131], v140 offset:9216
  v_mfma_f32_16x16x32_bf16 v[48:51], v[96:99], v[80:83], v[48:51]
  ds_read_b64_tr_b16 v[132:133], v141 offset:8192
  v_mfma_f32_16x16x32_bf16 v[52:55], v[100:103], v[80:83], v[52:55]
  ds_read_b64_tr_b16 v[134:135], v141 offset:9216
  v_mfma_f32_16x16x32_bf16 v[56:59], v[88:91], v[84:87], v[56:59]
  v_mfma_f32_16x16x32_bf16 v[60:63], v[92:95], v[84:87], v[60:63]
  v_mfma_f32_16x16x32_bf16 v[64:67], v[96:99], v[84:87], v[64:67]
  v_mfma_f32_16x16x32_bf16 v[68:71], v[100:103], v[84:87], v[68:71]
  s_waitcnt lgkmcnt(0)
  s_barrier
  v_mfma_f32_16x16x32_bf16 v[8:11], v[120:123], v[104:107], v[8:11]
  v_mfma_f32_16x16x32_bf16 v[12:15], v[124:127], v[104:107], v[12:15]
  v_mfma_f32_16x16x32_bf16 v[16:19], v[128:131], v[104:107], v[16:19]
  v_mfma_f32_16x16x32_bf16 v[20:23], v[132:135], v[104:107], v[20:23]
  v_mfma_f32_16x16x32_bf16 v[24:27], v[120:123], v[108:111], v[24:27]
  v_mfma_f32_16x16x32_bf16 v[28:31], v[124:127], v[108:111], v[28:31]
  v_mfma_f32_16x16x32_bf16 v[32:35], v[128:131], v[108:111], v[32:35]
  v_mfma_f32_16x16x32_bf16 v[36:39], v[132:135], v[108:111], v[36:39]
  v_mfma_f32_16x16x32_bf16 v[40:43], v[120:123], v[112:115], v[40:43]
  v_mfma_f32_16x16x32_bf16 v[44:47], v[124:127], v[112:115], v[44:47]
  v_mfma_f32_16x16x32_bf16 v[48:51], v[128:131], v[112:115], v[48:51]
  v_mfma_f32_16x16x32_bf16 v[52:55], v[132:135], v[112:115], v[52:55]
  v_mfma_f32_16x16x32_bf16 v[56:59], v[120:123], v[116:119], v[56:59]
  v_mfma_f32_16x16x32_bf16 v[60:63], v[124:127], v[116:119], v[60:63]
  v_mfma_f32_16x16x32_bf16 v[64:67], v[128:131], v[116:119], v[64:67]
  v_mfma_f32_16x16x32_bf16 v[68:71], v[132:135], v[116:119], v[68:71]
  v_and_b32 v5, 1, v4
  v_lshlrev_b32 v5, 5, v5
  v_lshrrev_b32 v6, 1, v4
  v_lshlrev_b32 v6, 4, v6
  v_add_u32 v5, v5, v6
  s_cmp_eq_u32 s27, 0
  s_cbranch_scc1 main_kernel_f2_noswap
  v_swap_b32 v8, v16
  v_swap_b32 v9, v17
  v_swap_b32 v10, v18
  v_swap_b32 v11, v19
  v_swap_b32 v12, v20
  v_swap_b32 v13, v21
  v_swap_b32 v14, v22
  v_swap_b32 v15, v23
  v_swap_b32 v24, v32
  v_swap_b32 v25, v33
  v_swap_b32 v26, v34
  v_swap_b32 v27, v35
  v_swap_b32 v28, v36
  v_swap_b32 v29, v37
  v_swap_b32 v30, v38
  v_swap_b32 v31, v39
  v_swap_b32 v40, v48
  v_swap_b32 v41, v49
  v_swap_b32 v42, v50
  v_swap_b32 v43, v51
  v_swap_b32 v44, v52
  v_swap_b32 v45, v53
  v_swap_b32 v46, v54
  v_swap_b32 v47, v55
  v_swap_b32 v56, v64
  v_swap_b32 v57, v65
  v_swap_b32 v58, v66
  v_swap_b32 v59, v67
  v_swap_b32 v60, v68
  v_swap_b32 v61, v69
  v_swap_b32 v62, v70
  v_swap_b32 v63, v71
main_kernel_f2_noswap:
  s_add_u32 s56, s66, 0x3800000
  s_addc_u32 s57, s67, 0
  s_mov_b32 s58, 0x800000
  s_mov_b32 s59, 0x20000
  s_lshl_b32 s47, s25, 3
  s_add_u32 s47, s47, s26
  s_lshl_b32 s47, s47, 1
  s_xor_b32 s48, s27, 1
  s_add_u32 s48, s48, s47
  s_lshl_b32 s49, s48, 2
  s_add_u32 s49, s49, s24
  s_lshl_b32 s49, s49, 13
  s_add_u32 s52, s47, s27
  s_lshl_b32 s53, s52, 2
  s_add_u32 s53, s53, s24
  s_lshl_b32 s53, s53, 13
  v_lshlrev_b32 v7, 4, v2
  buffer_store_dwordx4 v[16:19], v7, s[56:59], s49 offen offset:0 sc1
  buffer_store_dwordx4 v[20:23], v7, s[56:59], s49 offen offset:1024 sc1
  buffer_store_dwordx4 v[32:35], v7, s[56:59], s49 offen offset:2048 sc1
  buffer_store_dwordx4 v[36:39], v7, s[56:59], s49 offen offset:3072 sc1
  s_add_u32 s49, s49, 4096
  buffer_store_dwordx4 v[48:51], v7, s[56:59], s49 offen offset:0 sc1
  buffer_store_dwordx4 v[52:55], v7, s[56:59], s49 offen offset:1024 sc1
  buffer_store_dwordx4 v[64:67], v7, s[56:59], s49 offen offset:2048 sc1
  buffer_store_dwordx4 v[68:71], v7, s[56:59], s49 offen offset:3072 sc1
  s_waitcnt vmcnt(8)
  v_lshlrev_b32 v104, 16, v142
  v_and_b32 v105, 0xffff0000, v142
  v_lshlrev_b32 v106, 16, v143
  v_and_b32 v107, 0xffff0000, v143
  v_pk_fma_f32 v[8:9], v[8:9], v[158:159], v[104:105]
  v_pk_fma_f32 v[10:11], v[10:11], v[160:161], v[106:107]
  v_lshlrev_b32 v104, 16, v144
  v_and_b32 v105, 0xffff0000, v144
  v_lshlrev_b32 v106, 16, v145
  v_and_b32 v107, 0xffff0000, v145
  v_pk_fma_f32 v[12:13], v[12:13], v[162:163], v[104:105]
  v_pk_fma_f32 v[14:15], v[14:15], v[164:165], v[106:107]
  v_lshlrev_b32 v104, 16, v146
  v_and_b32 v105, 0xffff0000, v146
  v_lshlrev_b32 v106, 16, v147
  v_and_b32 v107, 0xffff0000, v147
  v_pk_fma_f32 v[24:25], v[24:25], v[158:159], v[104:105]
  v_pk_fma_f32 v[26:27], v[26:27], v[160:161], v[106:107]
  v_lshlrev_b32 v104, 16, v148
  v_and_b32 v105, 0xffff0000, v148
  v_lshlrev_b32 v106, 16, v149
  v_and_b32 v107, 0xffff0000, v149
  v_pk_fma_f32 v[28:29], v[28:29], v[162:163], v[104:105]
  v_pk_fma_f32 v[30:31], v[30:31], v[164:165], v[106:107]
  v_lshlrev_b32 v104, 16, v150
  v_and_b32 v105, 0xffff0000, v150
  v_lshlrev_b32 v106, 16, v151
  v_and_b32 v107, 0xffff0000, v151
  v_pk_fma_f32 v[40:41], v[40:41], v[158:159], v[104:105]
  v_pk_fma_f32 v[42:43], v[42:43], v[160:161], v[106:107]
  v_lshlrev_b32 v104, 16, v152
  v_and_b32 v105, 0xffff0000, v152
  v_lshlrev_b32 v106, 16, v153
  v_and_b32 v107, 0xffff0000, v153
  v_pk_fma_f32 v[44:45], v[44:45], v[162:163], v[104:105]
  v_pk_fma_f32 v[46:47], v[46:47], v[164:165], v[106:107]
  v_lshlrev_b32 v104, 16, v154
  v_and_b32 v105, 0xffff0000, v154
  v_lshlrev_b32 v106, 16, v155
  v_and_b32 v107, 0xffff0000, v155
  v_pk_fma_f32 v[56:57], v[56:57], v[158:159], v[104:105]
  v_pk_fma_f32 v[58:59], v[58:59], v[160:161], v[106:107]
  v_lshlrev_b32 v104, 16, v156
  v_and_b32 v105, 0xffff0000, v156
  v_lshlrev_b32 v106, 16, v157
  v_and_b32 v107, 0xffff0000, v157
  v_pk_fma_f32 v[60:61], v[60:61], v[162:163], v[104:105]
  v_pk_fma_f32 v[62:63], v[62:63], v[164:165], v[106:107]
  v_add_u32 v6, s44, v3
  v_lshlrev_b32 v6, 11, v6
  s_lshl_b32 s47, s46, 1
  v_add_u32 v6, s47, v6
  v_add_u32 v5, v5, v6
  s_waitcnt vmcnt(0)
  s_lshl_b32 s48, s48, 7
  s_lshl_b32 s54, s24, 2
  s_add_u32 s48, s48, s54
  s_add_u32 s48, s48, 239104
  v_mov_b32 v6, s48
  v_mov_b32 v249, 1
  s_mov_b64 exec, 1
  buffer_store_dword v249, v6, s[28:31], 0 offen sc1
  s_mov_b64 exec, -1
  s_lshl_b32 s52, s52, 7
  s_add_u32 s52, s52, s54
  s_add_u32 s52, s52, 239104
  v_mov_b32 v6, s52
  s_mov_b32 s33, 0
  s_mov_b64 exec, 1
main_kernel_f2_xpoll:
  buffer_load_dword v249, v6, s[28:31], 0 offen sc1
  s_waitcnt vmcnt(0)
  v_readfirstlane_b32 s34, v249
  s_nop 0
  s_cmp_eq_u32 s34, 1
  s_cbranch_scc1 main_kernel_f2_xdone
  s_add_u32 s33, s33, 1
  s_cmp_lt_u32 s33, 400000
  s_cbranch_scc1 main_kernel_f2_xpoll
main_kernel_f2_xdone:
  s_mov_b64 exec, -1
  buffer_load_dwordx4 v[16:19], v7, s[56:59], s53 offen offset:0 sc1
  buffer_load_dwordx4 v[20:23], v7, s[56:59], s53 offen offset:1024 sc1
  buffer_load_dwordx4 v[32:35], v7, s[56:59], s53 offen offset:2048 sc1
  buffer_load_dwordx4 v[36:39], v7, s[56:59], s53 offen offset:3072 sc1
  s_add_u32 s53, s53, 4096
  buffer_load_dwordx4 v[48:51], v7, s[56:59], s53 offen offset:0 sc1
  buffer_load_dwordx4 v[52:55], v7, s[56:59], s53 offen offset:1024 sc1
  buffer_load_dwordx4 v[64:67], v7, s[56:59], s53 offen offset:2048 sc1
  buffer_load_dwordx4 v[68:71], v7, s[56:59], s53 offen offset:3072 sc1
  s_waitcnt vmcnt(6)
  s_mov_b32 s48, 0
  v_pk_fma_f32 v[8:9], v[16:17], v[158:159], v[8:9]
  v_pk_fma_f32 v[10:11], v[18:19], v[160:161], v[10:11]
  v_pk_fma_f32 v[12:13], v[20:21], v[162:163], v[12:13]
  v_pk_fma_f32 v[14:15], v[22:23], v[164:165], v[14:15]
  v_cvt_pk_bf16_f32 v72, v8, v9
  v_cvt_pk_bf16_f32 v73, v10, v11
  v_cvt_pk_bf16_f32 v74, v12, v13
  v_cvt_pk_bf16_f32 v75, v14, v15
  s_nop 0
  v_permlane16_swap_b32 v72, v74
  v_permlane16_swap_b32 v73, v75
  buffer_store_dwordx4 v[72:75], v5, s[12:15], s48 offen nt
  s_waitcnt vmcnt(5)
  s_mov_b32 s48, 32768
  v_pk_fma_f32 v[24:25], v[32:33], v[158:159], v[24:25]
  v_pk_fma_f32 v[26:27], v[34:35], v[160:161], v[26:27]
  v_pk_fma_f32 v[28:29], v[36:37], v[162:163], v[28:29]
  v_pk_fma_f32 v[30:31], v[38:39], v[164:165], v[30:31]
  v_cvt_pk_bf16_f32 v76, v24, v25
  v_cvt_pk_bf16_f32 v77, v26, v27
  v_cvt_pk_bf16_f32 v78, v28, v29
  v_cvt_pk_bf16_f32 v79, v30, v31
  s_nop 0
  v_permlane16_swap_b32 v76, v78
  v_permlane16_swap_b32 v77, v79
  buffer_store_dwordx4 v[76:79], v5, s[12:15], s48 offen nt
  s_waitcnt vmcnt(4)
  s_mov_b32 s48, 65536
  v_pk_fma_f32 v[40:41], v[48:49], v[158:159], v[40:41]
  v_pk_fma_f32 v[42:43], v[50:51], v[160:161], v[42:43]
  v_pk_fma_f32 v[44:45], v[52:53], v[162:163], v[44:45]
  v_pk_fma_f32 v[46:47], v[54:55], v[164:165], v[46:47]
  v_cvt_pk_bf16_f32 v72, v40, v41
  v_cvt_pk_bf16_f32 v73, v42, v43
  v_cvt_pk_bf16_f32 v74, v44, v45
  v_cvt_pk_bf16_f32 v75, v46, v47
  s_nop 0
  v_permlane16_swap_b32 v72, v74
  v_permlane16_swap_b32 v73, v75
  buffer_store_dwordx4 v[72:75], v5, s[12:15], s48 offen nt
  s_waitcnt vmcnt(3)
  s_mov_b32 s48, 98304
  v_pk_fma_f32 v[56:57], v[64:65], v[158:159], v[56:57]
  v_pk_fma_f32 v[58:59], v[66:67], v[160:161], v[58:59]
  v_pk_fma_f32 v[60:61], v[68:69], v[162:163], v[60:61]
  v_pk_fma_f32 v[62:63], v[70:71], v[164:165], v[62:63]
  v_cvt_pk_bf16_f32 v76, v56, v57
  v_cvt_pk_bf16_f32 v77, v58, v59
  v_cvt_pk_bf16_f32 v78, v60, v61
  v_cvt_pk_bf16_f32 v79, v62, v63
  s_nop 0
  v_permlane16_swap_b32 v76, v78
  v_permlane16_swap_b32 v77, v79
  buffer_store_dwordx4 v[76:79], v5, s[12:15], s48 offen nt
  s_branch main_kernel_fin
main_kernel_f2_l:
  s_and_b32 s36, s2, 7
  s_lshr_b32 s37, s2, 3
  s_and_b32 s27, s36, 1
  s_lshr_b32 s36, s36, 1
  s_and_b32 s26, s37, 7
  s_lshr_b32 s37, s37, 3
  s_lshl_b32 s36, s36, 2
  s_add_u32 s25, s36, s37
  s_add_u32 s4, s66, 0x1900000
  s_addc_u32 s5, s67, 0
  s_mov_b32 s6, 0xe00000
  s_mov_b32 s7, 0x20000
  s_mov_b32 s8, s74
  s_mov_b32 s9, s75
  s_mov_b32 s10, 0x700000
  s_mov_b32 s11, 0x20000
  s_sub_u32 s42, s24, 4
  s_mul_i32 s43, s25, 917504
  s_mul_i32 s44, s42, 2048
  s_add_u32 s43, s43, s44
  v_lshrrev_b32 v3, 3, v2
  v_lshlrev_b32 v3, 6, v3
  v_add_u32 v3, s43, v3
  v_and_b32 v4, 7, v2
  v_lshrrev_b32 v5, 4, v2
  v_xor_b32 v6, 0, v5
  v_xor_b32 v6, v6, v4
  v_lshrrev_b32 v7, 2, v6
  v_lshlrev_b32 v7, 13, v7
  v_and_b32 v6, 3, v6
  v_lshlrev_b32 v6, 4, v6
  v_add3_u32 v6, v6, v7, v3
  v_add_u32 v8, 0, v6
  v_xor_b32 v6, 4, v5
  v_xor_b32 v6, v6, v4
  v_lshrrev_b32 v7, 2, v6
  v_lshlrev_b32 v7, 13, v7
  v_and_b32 v6, 3, v6
  v_lshlrev_b32 v6, 4, v6
  v_add3_u32 v6, v6, v7, v3
  v_add_u32 v9, 512, v6
  v_xor_b32 v6, 0, v5
  v_xor_b32 v6, v6, v4
  v_lshrrev_b32 v7, 2, v6
  v_lshlrev_b32 v7, 13, v7
  v_and_b32 v6, 3, v6
  v_lshlrev_b32 v6, 4, v6
  v_add3_u32 v6, v6, v7, v3
  v_add_u32 v10, 1024, v6
  v_xor_b32 v6, 4, v5
  v_xor_b32 v6, v6, v4
  v_lshrrev_b32 v7, 2, v6
  v_lshlrev_b32 v7, 13, v7
  v_and_b32 v6, 3, v6
  v_lshlrev_b32 v6, 4, v6
  v_add3_u32 v6, v6, v7, v3
  v_add_u32 v11, 1536, v6
  s_mul_i32 s43, s42, 32768
  s_mul_i32 s44, s26, 256
  s_add_u32 s43, s43, s44
  v_add_u32 v3, 0, v2
  v_mul_u32_u24 v4, 4096, v3
  v_lshrrev_b32 v4, 16, v4
  v_mul_u32_u24 v5, 16, v4
  v_sub_u32 v3, v3, v5
  v_and_b32 v5, 3, v4
  v_lshrrev_b32 v6, 1, v4
  v_and_b32 v6, 4, v6
  v_or_b32 v5, v5, v6
  v_lshlrev_b32 v5, 1, v5
  v_xor_b32 v3, v3, v5
  v_lshlrev_b32 v3, 4, v3
  s_mov_b32 s45, 2048
  v_mul_lo_u32 v4, s45, v4
  v_add_u32 v3, v3, v4
  v_add_u32 v12, s43, v3
  v_add_u32 v3, 64, v2
  v_mul_u32_u24 v4, 4096, v3
  v_lshrrev_b32 v4, 16, v4
  v_mul_u32_u24 v5, 16, v4
  v_sub_u32 v3, v3, v5
  v_and_b32 v5, 3, v4
  v_lshrrev_b32 v6, 1, v4
  v_and_b32 v6, 4, v6
  v_or_b32 v5, v5, v6
  v_lshlrev_b32 v5, 1, v5
  v_xor_b32 v3, v3, v5
  v_lshlrev_b32 v3, 4, v3
  s_mov_b32 s45, 2048
  v_mul_lo_u32 v4, s45, v4
  v_add_u32 v3, v3, v4
  v_add_u32 v13, s43, v3
  v_add_u32 v3, 128, v2
  v_mul_u32_u24 v4, 4096, v3
  v_lshrrev_b32 v4, 16, v4
  v_mul_u32_u24 v5, 16, v4
  v_sub_u32 v3, v3, v5
  v_and_b32 v5, 3, v4
  v_lshrrev_b32 v6, 1, v4
  v_and_b32 v6, 4, v6
  v_or_b32 v5, v5, v6
  v_lshlrev_b32 v5, 1, v5
  v_xor_b32 v3, v3, v5
  v_lshlrev_b32 v3, 4, v3
  s_mov_b32 s45, 2048
  v_mul_lo_u32 v4, s45, v4
  v_add_u32 v3, v3, v4
  v_add_u32 v14, s43, v3
  v_add_u32 v3, 192, v2
  v_mul_u32_u24 v4, 4096, v3
  v_lshrrev_b32 v4, 16, v4
  v_mul_u32_u24 v5, 16, v4
  v_sub_u32 v3, v3, v5
  v_and_b32 v5, 3, v4
  v_lshrrev_b32 v6, 1, v4
  v_and_b32 v6, 4, v6
  v_or_b32 v5, v5, v6
  v_lshlrev_b32 v5, 1, v5
  v_xor_b32 v3, v3, v5
  v_lshlrev_b32 v3, 4, v3
  s_mov_b32 s45, 2048
  v_mul_lo_u32 v4, s45, v4
  v_add_u32 v3, v3, v4
  v_add_u32 v15, s43, v3
  s_mul_i32 s46, s42, 4096
  s_mul_i32 s47, s42, 4096
  s_add_u32 s47, s47, 16384
  s_mul_i32 s62, s27, 458752
  s_mul_i32 s63, s27, 3670016
  s_add_u32 s35, s25, 56
  s_cmp_eq_u32 s24, 4
  s_cbranch_scc1 main_kernel_f2_w4a
  s_add_u32 s52, s47, 0
  s_add_u32 s49, s63, 0
  s_add_u32 m0, s52, 0
  s_nop 0
  buffer_load_dwordx4 v12, s[8:11], s49 offen lds
  s_add_u32 m0, s52, 1024
  s_nop 0
  buffer_load_dwordx4 v13, s[8:11], s49 offen lds
  s_add_u32 m0, s52, 2048
  s_nop 0
  buffer_load_dwordx4 v14, s[8:11], s49 offen lds
  s_add_u32 m0, s52, 3072
  s_nop 0
  buffer_load_dwordx4 v15, s[8:11], s49 offen lds
  s_add_u32 s52, s47, 32768
  s_add_u32 s49, s63, 131072
  s_add_u32 m0, s52, 0
  s_nop 0
  buffer_load_dwordx4 v12, s[8:11], s49 offen lds
  s_add_u32 m0, s52, 1024
  s_nop 0
  buffer_load_dwordx4 v13, s[8:11], s49 offen lds
  s_add_u32 m0, s52, 2048
  s_nop 0
  buffer_load_dwordx4 v14, s[8:11], s49 offen lds
  s_add_u32 m0, s52, 3072
  s_nop 0
  buffer_load_dwordx4 v15, s[8:11], s49 offen lds
  s_add_u32 s52, s47, 65536
  s_add_u32 s49, s63, 262144
  s_add_u32 m0, s52, 0
  s_nop 0
  buffer_load_dwordx4 v12, s[8:11], s49 offen lds
  s_add_u32 m0, s52, 1024
  s_nop 0
  buffer_load_dwordx4 v13, s[8:11], s49 offen lds
  s_add_u32 m0, s52, 2048
  s_nop 0
  buffer_load_dwordx4 v14, s[8:11], s49 offen lds
  s_add_u32 m0, s52, 3072
  s_nop 0
  buffer_load_dwordx4 v15, s[8:11], s49 offen lds
main_kernel_f2_w4a:
  s_cmp_lg_u32 s24, 4
  s_cbranch_scc1 main_kernel_dwf2
  s_lshl_b32 s34, s25, 1
  s_add_u32 s34, s34, s27
  s_lshl_b32 s34, s34, 7
  s_add_u32 s34, s34, 206336
  v_lshlrev_b32 v6, 2, v2
  v_add_u32 v6, s34, v6
  s_mov_b32 s33, 0
  s_mov_b64 exec, 0xff
main_kernel_pollf2:
  buffer_load_dword v7, v6, s[28:31], 0 offen sc1
  s_waitcnt vmcnt(0)
  v_cmp_ne_u32 vcc, 1, v7
  s_nop 0
  s_cmp_eq_u64 vcc, 0
  s_cbranch_scc1 main_kernel_pollxf2
  s_add_u32 s33, s33, 1
  s_cmp_ge_u32 s33, 400000
  s_cbranch_scc1 main_kernel_pollxf2
  s_sleep 2
  s_branch main_kernel_pollf2
main_kernel_pollxf2:
  s_mov_b64 exec, -1
  v_mov_b32 v6, 138280
  v_mov_b32 v7, 1
  ds_write_b32 v6, v7
  s_waitcnt lgkmcnt(0)
  s_branch main_kernel_dwxf2
main_kernel_dwf2:
  v_mov_b32 v6, 138280
  s_mov_b32 s33, 0
main_kernel_dwlf2:
  ds_read_b32 v7, v6
  s_waitcnt lgkmcnt(0)
  v_readfirstlane_b32 s34, v7
  s_nop 0
  s_cmp_lg_u32 s34, 0
  s_cbranch_scc1 main_kernel_dwxf2
  s_add_u32 s33, s33, 1
  s_cmp_ge_u32 s33, 1600000
  s_cbranch_scc1 main_kernel_dwxf2
  s_sleep 1
  s_branch main_kernel_dwlf2
main_kernel_dwxf2:
  s_cmp_lg_u32 s24, 4
  s_cbranch_scc1 main_kernel_f2_w4b
  s_add_u32 s52, s47, 0
  s_add_u32 s49, s63, 0
  s_add_u32 m0, s52, 0
  s_nop 0
  buffer_load_dwordx4 v12, s[8:11], s49 offen lds
  s_add_u32 m0, s52, 1024
  s_nop 0
  buffer_load_dwordx4 v13, s[8:11], s49 offen lds
  s_add_u32 m0, s52, 2048
  s_nop 0
  buffer_load_dwordx4 v14, s[8:11], s49 offen lds
  s_add_u32 m0, s52, 3072
  s_nop 0
  buffer_load_dwordx4 v15, s[8:11], s49 offen lds
  s_add_u32 s52, s47, 32768
  s_add_u32 s49, s63, 131072
  s_add_u32 m0, s52, 0
  s_nop 0
  buffer_load_dwordx4 v12, s[8:11], s49 offen lds
  s_add_u32 m0, s52, 1024
  s_nop 0
  buffer_load_dwordx4 v13, s[8:11], s49 offen lds
  s_add_u32 m0, s52, 2048
  s_nop 0
  buffer_load_dwordx4 v14, s[8:11], s49 offen lds
  s_add_u32 m0, s52, 3072
  s_nop 0
  buffer_load_dwordx4 v15, s[8:11], s49 offen lds
  s_add_u32 s52, s47, 65536
  s_add_u32 s49, s63, 262144
  s_add_u32 m0, s52, 0
  s_nop 0
  buffer_load_dwordx4 v12, s[8:11], s49 offen lds
  s_add_u32 m0, s52, 1024
  s_nop 0
  buffer_load_dwordx4 v13, s[8:11], s49 offen lds
  s_add_u32 m0, s52, 2048
  s_nop 0
  buffer_load_dwordx4 v14, s[8:11], s49 offen lds
  s_add_u32 m0, s52, 3072
  s_nop 0
  buffer_load_dwordx4 v15, s[8:11], s49 offen lds
main_kernel_f2_w4b:
  s_add_u32 s51, s46, 0
  s_add_u32 s48, s62, 0
  s_add_u32 m0, s51, 0
  s_nop 0
  buffer_load_dwordx4 v8, s[4:7], s48 offen sc1 lds
  s_add_u32 m0, s51, 1024
  s_nop 0
  buffer_load_dwordx4 v9, s[4:7], s48 offen sc1 lds
  s_add_u32 m0, s51, 2048
  s_nop 0
  buffer_load_dwordx4 v10, s[4:7], s48 offen sc1 lds
  s_add_u32 m0, s51, 3072
  s_nop 0
  buffer_load_dwordx4 v11, s[4:7], s48 offen sc1 lds
  s_add_u32 s51, s46, 32768
  s_add_u32 s48, s62, 16384
  s_add_u32 m0, s51, 0
  s_nop 0
  buffer_load_dwordx4 v8, s[4:7], s48 offen sc1 lds
  s_add_u32 m0, s51, 1024
  s_nop 0
  buffer_load_dwordx4 v9, s[4:7], s48 offen sc1 lds
  s_add_u32 m0, s51, 2048
  s_nop 0
  buffer_load_dwordx4 v10, s[4:7], s48 offen sc1 lds
  s_add_u32 m0, s51, 3072
  s_nop 0
  buffer_load_dwordx4 v11, s[4:7], s48 offen sc1 lds
  s_add_u32 s51, s46, 65536
  s_add_u32 s48, s62, 32768
  s_add_u32 m0, s51, 0
  s_nop 0
  buffer_load_dwordx4 v8, s[4:7], s48 offen sc1 lds
  s_add_u32 m0, s51, 1024
  s_nop 0
  buffer_load_dwordx4 v9, s[4:7], s48 offen sc1 lds
  s_add_u32 m0, s51, 2048
  s_nop 0
  buffer_load_dwordx4 v10, s[4:7], s48 offen sc1 lds
  s_add_u32 m0, s51, 3072
  s_nop 0
  buffer_load_dwordx4 v11, s[4:7], s48 offen sc1 lds
  s_add_u32 s48, s62, 49152
  s_add_u32 s49, s63, 393216
  s_mov_b32 s50, 98304
  s_waitcnt vmcnt(8)
  s_barrier
  s_add_u32 s51, s50, s46
  s_add_u32 s52, s50, s47
  s_add_u32 m0, s51, 0
  s_nop 0
  buffer_load_dwordx4 v8, s[4:7], s48 offen sc1 lds
  s_add_u32 m0, s51, 1024
  s_nop 0
  buffer_load_dwordx4 v9, s[4:7], s48 offen sc1 lds
  s_add_u32 m0, s51, 2048
  s_nop 0
  buffer_load_dwordx4 v10, s[4:7], s48 offen sc1 lds
  s_add_u32 m0, s51, 3072
  s_nop 0
  buffer_load_dwordx4 v11, s[4:7], s48 offen sc1 lds
  s_add_u32 m0, s52, 0
  s_nop 0
  buffer_load_dwordx4 v12, s[8:11], s49 offen lds
  s_add_u32 m0, s52, 1024
  s_nop 0
  buffer_load_dwordx4 v13, s[8:11], s49 offen lds
  s_add_u32 m0, s52, 2048
  s_nop 0
  buffer_load_dwordx4 v14, s[8:11], s49 offen lds
  s_add_u32 m0, s52, 3072
  s_nop 0
  buffer_load_dwordx4 v15, s[8:11], s49 offen lds
  s_add_u32 s48, s48, 16384
  s_add_u32 s49, s49, 131072
  s_add_u32 s50, s50, 32768
  s_cmp_eq_u32 s50, 131072
  s_cselect_b32 s50, 0, s50
  s_waitcnt vmcnt(12)
  s_barrier
  s_add_u32 s51, s50, s46
  s_add_u32 s52, s50, s47
  s_add_u32 m0, s51, 0
  s_nop 0
  buffer_load_dwordx4 v8, s[4:7], s48 offen sc1 lds
  s_add_u32 m0, s51, 1024
  s_nop 0
  buffer_load_dwordx4 v9, s[4:7], s48 offen sc1 lds
  s_add_u32 m0, s51, 2048
  s_nop 0
  buffer_load_dwordx4 v10, s[4:7], s48 offen sc1 lds
  s_add_u32 m0, s51, 3072
  s_nop 0
  buffer_load_dwordx4 v11, s[4:7], s48 offen sc1 lds
  s_add_u32 m0, s52, 0
  s_nop 0
  buffer_load_dwordx4 v12, s[8:11], s49 offen lds
  s_add_u32 m0, s52, 1024
  s_nop 0
  buffer_load_dwordx4 v13, s[8:11], s49 offen lds
  s_add_u32 m0, s52, 2048
  s_nop 0
  buffer_load_dwordx4 v14, s[8:11], s49 offen lds
  s_add_u32 m0, s52, 3072
  s_nop 0
  buffer_load_dwordx4 v15, s[8:11], s49 offen lds
  s_add_u32 s48, s48, 16384
  s_add_u32 s49, s49, 131072
  s_add_u32 s50, s50, 32768
  s_cmp_eq_u32 s50, 131072
  s_cselect_b32 s50, 0, s50
  s_waitcnt vmcnt(16)
  s_barrier
  s_add_u32 s51, s50, s46
  s_add_u32 s52, s50, s47
  s_add_u32 m0, s51, 0
  s_nop 0
  buffer_load_dwordx4 v8, s[4:7], s48 offen sc1 lds
  s_add_u32 m0, s51, 1024
  s_nop 0
  buffer_load_dwordx4 v9, s[4:7], s48 offen sc1 lds
  s_add_u32 m0, s51, 2048
  s_nop 0
  buffer_load_dwordx4 v10, s[4:7], s48 offen sc1 lds
  s_add_u32 m0, s51, 3072
  s_nop 0
  buffer_load_dwordx4 v11, s[4:7], s48 offen sc1 lds
  s_add_u32 m0, s52, 0
  s_nop 0
  buffer_load_dwordx4 v12, s[8:11], s49 offen lds
  s_add_u32 m0, s52, 1024
  s_nop 0
  buffer_load_dwordx4 v13, s[8:11], s49 offen lds
  s_add_u32 m0, s52, 2048
  s_nop 0
  buffer_load_dwordx4 v14, s[8:11], s49 offen lds
  s_add_u32 m0, s52, 3072
  s_nop 0
  buffer_load_dwordx4 v15, s[8:11], s49 offen lds
  s_add_u32 s48, s48, 16384
  s_add_u32 s49, s49, 131072
  s_add_u32 s50, s50, 32768
  s_cmp_eq_u32 s50, 131072
  s_cselect_b32 s50, 0, s50
  s_mov_b32 s53, 22
main_kernel_f2_lloop:
  s_waitcnt vmcnt(16)
  s_barrier
  s_add_u32 s51, s50, s46
  s_add_u32 s52, s50, s47
  s_add_u32 m0, s51, 0
  s_nop 0
  buffer_load_dwordx4 v8, s[4:7], s48 offen sc1 lds
  s_add_u32 m0, s51, 1024
  s_nop 0
  buffer_load_dwordx4 v9, s[4:7], s48 offen sc1 lds
  s_add_u32 m0, s51, 2048
  s_nop 0
  buffer_load_dwordx4 v10, s[4:7], s48 offen sc1 lds
  s_add_u32 m0, s51, 3072
  s_nop 0
  buffer_load_dwordx4 v11, s[4:7], s48 offen sc1 lds
  s_add_u32 m0, s52, 0
  s_nop 0
  buffer_load_dwordx4 v12, s[8:11], s49 offen lds
  s_add_u32 m0, s52, 1024
  s_nop 0
  buffer_load_dwordx4 v13, s[8:11], s49 offen lds
  s_add_u32 m0, s52, 2048
  s_nop 0
  buffer_load_dwordx4 v14, s[8:11], s49 offen lds
  s_add_u32 m0, s52, 3072
  s_nop 0
  buffer_load_dwordx4 v15, s[8:11], s49 offen lds
  s_add_u32 s48, s48, 16384
  s_add_u32 s49, s49, 131072
  s_add_u32 s50, s50, 32768
  s_cmp_eq_u32 s50, 131072
  s_cselect_b32 s50, 0, s50
  s_sub_u32 s53, s53, 1
  s_cmp_lg_u32 s53, 0
  s_cbranch_scc1 main_kernel_f2_lloop
  s_waitcnt vmcnt(16)
  s_barrier
  s_waitcnt vmcnt(8)
  s_barrier
  s_waitcnt vmcnt(0)
  s_barrier
  s_barrier
  s_branch main_kernel_end
main_kernel_fin:
main_kernel_end:
  s_endpgm
.section .rodata,"a"
.p2align 6
.amdhsa_kernel mod_kernel
  .amdhsa_next_free_vgpr 64
  .amdhsa_next_free_sgpr 96
  .amdhsa_accum_offset 64
  .amdhsa_group_segment_fixed_size 0
  .amdhsa_kernarg_size 88
  .amdhsa_user_sgpr_count 2
  .amdhsa_user_sgpr_kernarg_segment_ptr 1
  .amdhsa_system_sgpr_workgroup_id_x 1
.end_amdhsa_kernel
.p2align 6
.amdhsa_kernel main_kernel
  .amdhsa_next_free_vgpr 256
  .amdhsa_next_free_sgpr 100
  .amdhsa_accum_offset 256
  .amdhsa_group_segment_fixed_size 0
  .amdhsa_kernarg_size 88
  .amdhsa_user_sgpr_count 2
  .amdhsa_user_sgpr_kernarg_segment_ptr 1
  .amdhsa_system_sgpr_workgroup_id_x 1
.end_amdhsa_kernel
```
